```python
import torch

def _softmax(x, axis=-1):
    return torch.softmax(x, dim=axis)

def _gelu(x):
    return torch.nn.functional.gelu(x, approximate='tanh')

def _silu(x):
    return torch.nn.functional.silu(x)

def _sigmoid(x):
    return torch.sigmoid(x)

def _layernorm(x, axis=-1, eps=1e-05):
    m = x.mean(dim=axis, keepdim=True)
    v = x.var(dim=axis, keepdim=True, unbiased=False)
    return (x - m) / torch.sqrt(v + eps)

def _scatter_add(tgt, idx, src, axis=0):
    return tgt.clone().index_add_(axis, idx, src)

def _segment_sum(src, seg, n):
    out = torch.zeros((n,) + src.shape[1:], dtype=src.dtype)
    return out.index_add_(0, seg, src)

def _pad(x, pw):
    flat = tuple((v for pair in reversed(pw) for v in pair))
    return torch.nn.functional.pad(x, flat)
kernel_name = 'adaLN_cond__ssm_conv_s4d__swiglu_ffn__prompt'

def setup_inputs():

    _w = lambda a: (lambda t: t.to(torch.bfloat16) if t.is_floating_point() else t)(torch.as_tensor(a))

    def _A_setup():
        Bsz, L, D, N = (1, 2048, 640, 192)
        return {'u': _w((lambda *s: torch.randn(*s, dtype=torch.bfloat16) * 0.05)(Bsz, L, D)), 'log_A_real': _w((lambda *s: torch.randn(*s, dtype=torch.bfloat16) * 3.2)(D, N) * 0.5), 'A_imag': _w((lambda *s: torch.randn(*s, dtype=torch.bfloat16) * 0.1)(D, N) * 3.14), 'C_real': _w((lambda *s: torch.randn(*s, dtype=torch.bfloat16) * 0.4)(D, N) / N ** 0.5), 'C_imag': _w((lambda *s: torch.randn(*s, dtype=torch.bfloat16) * 0.4)(D, N) / N ** 0.5), 'log_dt': _w((lambda *s: torch.randn(*s, dtype=torch.bfloat16) * 0.1)(D) * 0.5 - 4.0), 'D_skip': _w((lambda *s: torch.randn(*s, dtype=torch.bfloat16) * 0.2)(D))}
    _A_in = _A_setup()

    def _B_setup():
        B, S, D, F = (1, 2048, 640, 1536)
        return {'x': _w((lambda *s: torch.randn(*s, dtype=torch.bfloat16) * 0.05)(B, S, D)), 'w_gate': _w((lambda *s: torch.randn(*s, dtype=torch.bfloat16) * 0.05)(D, F)), 'w_up': _w((lambda *s: torch.randn(*s, dtype=torch.bfloat16) * 0.05)(D, F)), 'w_down': _w((lambda *s: torch.randn(*s, dtype=torch.bfloat16) * 0.05)(F, D))}
    _B_in = _B_setup()
    return {'A_u': _A_in['u'], 'A_log_A_real': _A_in['log_A_real'], 'A_A_imag': _A_in['A_imag'], 'A_C_real': _A_in['C_real'], 'A_C_imag': _A_in['C_imag'], 'A_log_dt': _A_in['log_dt'], 'A_D_skip': _A_in['D_skip'], 'B_x': _B_in['x'], 'B_w_gate': _B_in['w_gate'], 'B_w_up': _B_in['w_up'], 'B_w_down': _B_in['w_down'], 'c': _w((lambda *s: torch.randn(*s, dtype=torch.bfloat16) * 0.1)(1, 640) * 8.0), 'w_mod': _w((lambda *s: torch.randn(*s, dtype=torch.bfloat16) * 0.1)(640, 6 * 640) * 640 ** (-0.5) * 8.0)}

def reference(A_u, A_log_A_real, A_A_imag, A_C_real, A_C_imag, A_log_dt, A_D_skip, B_x, B_w_gate, B_w_up, B_w_down, c, w_mod):

    def _A_ref(u, log_A_real, A_imag, C_real, C_imag, log_dt, D_skip):
        L = u.shape[1]
        dt = torch.exp(log_dt)
        A = -torch.exp(log_A_real) + 1j * A_imag
        C = (C_real + 1j * C_imag) * dt[:, None]
        pos = (lambda x, dt: x.to(dt))(torch.arange(L), log_dt.dtype)
        P = torch.exp((A * dt[:, None])[:, :, None] * pos[None, None, :])
        K = 2.0 * torch.einsum('dn,dnl->dl', C, P).real
        L2 = 2 * L
        u_t = (lambda x, *d: x.permute(*d))(u, 0, 2, 1)
        Kf = (lambda x, *a, **k: torch.fft.rfft(x.float(), *a, **k))(K, L2)
        Uf = (lambda x, *a, **k: torch.fft.rfft(x.float(), *a, **k))(u_t, L2)
        y = (lambda x, *a, **k: torch.fft.irfft(x, *a, **k).to(torch.bfloat16))(Uf * Kf[None, :, :], L2)[:, :, :L]
        y = (lambda x, *d: x.permute(*d))(y, 0, 2, 1)
        return y + u * D_skip[None, None, :]

    def _B_ref(x, w_gate, w_up, w_down):
        g = _silu(x @ w_gate)
        u = x @ w_up
        return g * u @ w_down
    x = A_u
    mod = (_silu(c) @ w_mod).reshape(c.shape[0], 6, 1, -1)
    sa, ca, ga, sb, cb, gb = (mod[:, 0].clone(), mod[:, 1].clone(), mod[:, 2].clone(), mod[:, 3].clone(), mod[:, 4].clone(), mod[:, 5].clone())
    h = _layernorm(x, axis=-1) * (1 + ca) + sa
    x = x + ga * _A_ref(h, A_log_A_real, A_A_imag, A_C_real, A_C_imag, A_log_dt, A_D_skip)
    h = _layernorm(x, axis=-1) * (1 + cb) + sb
    x = x + gb * _B_ref(h, B_w_gate, B_w_up, B_w_down)
    return x
```

```asm
; @launch kernel=ka_kernel grid=(253,1,1) block=(256,1,1) lds=87552
; @launch kernel=kb_kernel grid=(256,1,1) block=(256,1,1) lds=105088
; @launch kernel=kd_kernel grid=(256,1,1) block=(256,1,1) lds=145856
; @launch kernel=ke_kernel grid=(256,1,1) block=(256,1,1) lds=102400
.amdgcn_target "amdgcn-amd-amdhsa--gfx950"
.text
.globl ka_kernel
.p2align 8
.type ka_kernel,@function
ka_kernel:
s_getpc_b64 s[4:5]
s_mov_b32 s6, ka_kernel_end-ka_kernel-64
v_lshlrev_b32 v1, 7, v0
v_min_u32 v1, s6, v1
v_mov_b32 v3, s5
v_add_co_u32 v2, vcc, s4, v1
s_nop 1
v_addc_co_u32 v3, vcc, 0, v3, vcc
global_load_dword v250, v[2:3], off
s_cmp_ge_u32 s2, 92
s_cbranch_scc1 KA_KG
s_cmp_ge_u32 s2, 32
s_cbranch_scc0 KA_STATS
s_sub_u32 s2, s2, 32
s_load_dwordx2 s[4:5], s[0:1], 88
s_load_dwordx2 s[6:7], s[0:1], 96
s_load_dwordx2 s[8:9], s[0:1], 120
v_lshrrev_b32 v1, 3, v0
v_and_b32 v2, 7, v0
v_mul_u32_u24 v3, 7680, v1
v_lshl_add_u32 v3, v2, 4, v3
s_lshl_b32 s3, s2, 7
v_add_u32 v3, s3, v3
v_lshlrev_b32 v4, 1, v0
s_waitcnt lgkmcnt(0)
s_mov_b32 s12, s4
s_mov_b32 s13, s5
s_mov_b32 s14, 1280
s_mov_b32 s15, 0x00020000
s_mov_b32 s16, s6
s_mov_b32 s17, s7
s_mov_b32 s18, 4915200
s_mov_b32 s19, 0x00020000
s_mov_b32 s20, s8
s_mov_b32 s21, s9
s_mov_b32 s22, 268435456
s_mov_b32 s23, 0x00020000
buffer_load_ushort v5, v4, s[12:15], 0 offen
buffer_load_ushort v6, v4, s[12:15], 0 offen offset:512
buffer_load_ushort v7, v4, s[12:15], 0 offen offset:1024
s_mov_b32 s24, 0
buffer_load_dwordx4 v[32:35], v3, s[16:19], s24 offen
s_add_u32 s24, s24, 245760
buffer_load_dwordx4 v[36:39], v3, s[16:19], s24 offen
s_add_u32 s24, s24, 245760
buffer_load_dwordx4 v[40:43], v3, s[16:19], s24 offen
s_add_u32 s24, s24, 245760
buffer_load_dwordx4 v[44:47], v3, s[16:19], s24 offen
s_add_u32 s24, s24, 245760
buffer_load_dwordx4 v[48:51], v3, s[16:19], s24 offen
s_add_u32 s24, s24, 245760
buffer_load_dwordx4 v[52:55], v3, s[16:19], s24 offen
s_add_u32 s24, s24, 245760
buffer_load_dwordx4 v[56:59], v3, s[16:19], s24 offen
s_add_u32 s24, s24, 245760
buffer_load_dwordx4 v[60:63], v3, s[16:19], s24 offen
s_add_u32 s24, s24, 245760
buffer_load_dwordx4 v[64:67], v3, s[16:19], s24 offen
s_add_u32 s24, s24, 245760
buffer_load_dwordx4 v[68:71], v3, s[16:19], s24 offen
s_add_u32 s24, s24, 245760
buffer_load_dwordx4 v[72:75], v3, s[16:19], s24 offen
s_add_u32 s24, s24, 245760
buffer_load_dwordx4 v[76:79], v3, s[16:19], s24 offen
s_add_u32 s24, s24, 245760
buffer_load_dwordx4 v[80:83], v3, s[16:19], s24 offen
s_add_u32 s24, s24, 245760
buffer_load_dwordx4 v[84:87], v3, s[16:19], s24 offen
s_add_u32 s24, s24, 245760
buffer_load_dwordx4 v[88:91], v3, s[16:19], s24 offen
s_add_u32 s24, s24, 245760
buffer_load_dwordx4 v[92:95], v3, s[16:19], s24 offen
s_add_u32 s24, s24, 245760
buffer_load_dwordx4 v[96:99], v3, s[16:19], s24 offen
s_add_u32 s24, s24, 245760
buffer_load_dwordx4 v[100:103], v3, s[16:19], s24 offen
s_add_u32 s24, s24, 245760
buffer_load_dwordx4 v[104:107], v3, s[16:19], s24 offen
s_add_u32 s24, s24, 245760
buffer_load_dwordx4 v[108:111], v3, s[16:19], s24 offen
s_waitcnt vmcnt(20)
v_lshlrev_b32 v8, 2, v0
v_lshlrev_b32 v5, 16, v5
v_mul_f32 v9, 0xbfb8aa3b, v5
v_exp_f32 v9, v9
s_nop 0
v_add_f32 v9, 1.0, v9
v_rcp_f32 v9, v9
s_nop 0
v_mul_f32 v9, v5, v9
v_cvt_pk_bf16_f32 v9, v9, v9
v_and_b32 v9, 0xffff0000, v9
ds_write_b32 v8, v9 offset:0
v_lshlrev_b32 v6, 16, v6
v_mul_f32 v9, 0xbfb8aa3b, v6
v_exp_f32 v9, v9
s_nop 0
v_add_f32 v9, 1.0, v9
v_rcp_f32 v9, v9
s_nop 0
v_mul_f32 v9, v6, v9
v_cvt_pk_bf16_f32 v9, v9, v9
v_and_b32 v9, 0xffff0000, v9
ds_write_b32 v8, v9 offset:1024
v_lshlrev_b32 v7, 16, v7
v_mul_f32 v9, 0xbfb8aa3b, v7
v_exp_f32 v9, v9
s_nop 0
v_add_f32 v9, 1.0, v9
v_rcp_f32 v9, v9
s_nop 0
v_mul_f32 v9, v7, v9
v_cvt_pk_bf16_f32 v9, v9, v9
v_and_b32 v9, 0xffff0000, v9
ds_write_b32 v8, v9 offset:2048
s_waitcnt lgkmcnt(0)
s_barrier
v_lshlrev_b32 v9, 2, v1
ds_read_b32 v112, v9 offset:0
ds_read_b32 v113, v9 offset:128
ds_read_b32 v114, v9 offset:256
ds_read_b32 v115, v9 offset:384
ds_read_b32 v116, v9 offset:512
ds_read_b32 v117, v9 offset:640
ds_read_b32 v118, v9 offset:768
ds_read_b32 v119, v9 offset:896
ds_read_b32 v120, v9 offset:1024
ds_read_b32 v121, v9 offset:1152
ds_read_b32 v122, v9 offset:1280
ds_read_b32 v123, v9 offset:1408
ds_read_b32 v124, v9 offset:1536
ds_read_b32 v125, v9 offset:1664
ds_read_b32 v126, v9 offset:1792
ds_read_b32 v127, v9 offset:1920
ds_read_b32 v128, v9 offset:2048
ds_read_b32 v129, v9 offset:2176
ds_read_b32 v130, v9 offset:2304
ds_read_b32 v131, v9 offset:2432
v_mov_b32 v16, 0
v_mov_b32 v17, 0
v_mov_b32 v18, 0
v_mov_b32 v19, 0
v_mov_b32 v20, 0
v_mov_b32 v21, 0
v_mov_b32 v22, 0
v_mov_b32 v23, 0
s_waitcnt lgkmcnt(0)
s_waitcnt vmcnt(19)
v_lshlrev_b32 v10, 16, v32
v_and_b32 v11, 0xffff0000, v32
v_fmac_f32 v16, v10, v112
v_fmac_f32 v17, v11, v112
v_lshlrev_b32 v10, 16, v33
v_and_b32 v11, 0xffff0000, v33
v_fmac_f32 v18, v10, v112
v_fmac_f32 v19, v11, v112
v_lshlrev_b32 v10, 16, v34
v_and_b32 v11, 0xffff0000, v34
v_fmac_f32 v20, v10, v112
v_fmac_f32 v21, v11, v112
v_lshlrev_b32 v10, 16, v35
v_and_b32 v11, 0xffff0000, v35
v_fmac_f32 v22, v10, v112
v_fmac_f32 v23, v11, v112
s_waitcnt vmcnt(18)
v_lshlrev_b32 v10, 16, v36
v_and_b32 v11, 0xffff0000, v36
v_fmac_f32 v16, v10, v113
v_fmac_f32 v17, v11, v113
v_lshlrev_b32 v10, 16, v37
v_and_b32 v11, 0xffff0000, v37
v_fmac_f32 v18, v10, v113
v_fmac_f32 v19, v11, v113
v_lshlrev_b32 v10, 16, v38
v_and_b32 v11, 0xffff0000, v38
v_fmac_f32 v20, v10, v113
v_fmac_f32 v21, v11, v113
v_lshlrev_b32 v10, 16, v39
v_and_b32 v11, 0xffff0000, v39
v_fmac_f32 v22, v10, v113
v_fmac_f32 v23, v11, v113
s_waitcnt vmcnt(17)
v_lshlrev_b32 v10, 16, v40
v_and_b32 v11, 0xffff0000, v40
v_fmac_f32 v16, v10, v114
v_fmac_f32 v17, v11, v114
v_lshlrev_b32 v10, 16, v41
v_and_b32 v11, 0xffff0000, v41
v_fmac_f32 v18, v10, v114
v_fmac_f32 v19, v11, v114
v_lshlrev_b32 v10, 16, v42
v_and_b32 v11, 0xffff0000, v42
v_fmac_f32 v20, v10, v114
v_fmac_f32 v21, v11, v114
v_lshlrev_b32 v10, 16, v43
v_and_b32 v11, 0xffff0000, v43
v_fmac_f32 v22, v10, v114
v_fmac_f32 v23, v11, v114
s_waitcnt vmcnt(16)
v_lshlrev_b32 v10, 16, v44
v_and_b32 v11, 0xffff0000, v44
v_fmac_f32 v16, v10, v115
v_fmac_f32 v17, v11, v115
v_lshlrev_b32 v10, 16, v45
v_and_b32 v11, 0xffff0000, v45
v_fmac_f32 v18, v10, v115
v_fmac_f32 v19, v11, v115
v_lshlrev_b32 v10, 16, v46
v_and_b32 v11, 0xffff0000, v46
v_fmac_f32 v20, v10, v115
v_fmac_f32 v21, v11, v115
v_lshlrev_b32 v10, 16, v47
v_and_b32 v11, 0xffff0000, v47
v_fmac_f32 v22, v10, v115
v_fmac_f32 v23, v11, v115
s_waitcnt vmcnt(15)
v_lshlrev_b32 v10, 16, v48
v_and_b32 v11, 0xffff0000, v48
v_fmac_f32 v16, v10, v116
v_fmac_f32 v17, v11, v116
v_lshlrev_b32 v10, 16, v49
v_and_b32 v11, 0xffff0000, v49
v_fmac_f32 v18, v10, v116
v_fmac_f32 v19, v11, v116
v_lshlrev_b32 v10, 16, v50
v_and_b32 v11, 0xffff0000, v50
v_fmac_f32 v20, v10, v116
v_fmac_f32 v21, v11, v116
v_lshlrev_b32 v10, 16, v51
v_and_b32 v11, 0xffff0000, v51
v_fmac_f32 v22, v10, v116
v_fmac_f32 v23, v11, v116
s_waitcnt vmcnt(14)
v_lshlrev_b32 v10, 16, v52
v_and_b32 v11, 0xffff0000, v52
v_fmac_f32 v16, v10, v117
v_fmac_f32 v17, v11, v117
v_lshlrev_b32 v10, 16, v53
v_and_b32 v11, 0xffff0000, v53
v_fmac_f32 v18, v10, v117
v_fmac_f32 v19, v11, v117
v_lshlrev_b32 v10, 16, v54
v_and_b32 v11, 0xffff0000, v54
v_fmac_f32 v20, v10, v117
v_fmac_f32 v21, v11, v117
v_lshlrev_b32 v10, 16, v55
v_and_b32 v11, 0xffff0000, v55
v_fmac_f32 v22, v10, v117
v_fmac_f32 v23, v11, v117
s_waitcnt vmcnt(13)
v_lshlrev_b32 v10, 16, v56
v_and_b32 v11, 0xffff0000, v56
v_fmac_f32 v16, v10, v118
v_fmac_f32 v17, v11, v118
v_lshlrev_b32 v10, 16, v57
v_and_b32 v11, 0xffff0000, v57
v_fmac_f32 v18, v10, v118
v_fmac_f32 v19, v11, v118
v_lshlrev_b32 v10, 16, v58
v_and_b32 v11, 0xffff0000, v58
v_fmac_f32 v20, v10, v118
v_fmac_f32 v21, v11, v118
v_lshlrev_b32 v10, 16, v59
v_and_b32 v11, 0xffff0000, v59
v_fmac_f32 v22, v10, v118
v_fmac_f32 v23, v11, v118
s_waitcnt vmcnt(12)
v_lshlrev_b32 v10, 16, v60
v_and_b32 v11, 0xffff0000, v60
v_fmac_f32 v16, v10, v119
v_fmac_f32 v17, v11, v119
v_lshlrev_b32 v10, 16, v61
v_and_b32 v11, 0xffff0000, v61
v_fmac_f32 v18, v10, v119
v_fmac_f32 v19, v11, v119
v_lshlrev_b32 v10, 16, v62
v_and_b32 v11, 0xffff0000, v62
v_fmac_f32 v20, v10, v119
v_fmac_f32 v21, v11, v119
v_lshlrev_b32 v10, 16, v63
v_and_b32 v11, 0xffff0000, v63
v_fmac_f32 v22, v10, v119
v_fmac_f32 v23, v11, v119
s_waitcnt vmcnt(11)
v_lshlrev_b32 v10, 16, v64
v_and_b32 v11, 0xffff0000, v64
v_fmac_f32 v16, v10, v120
v_fmac_f32 v17, v11, v120
v_lshlrev_b32 v10, 16, v65
v_and_b32 v11, 0xffff0000, v65
v_fmac_f32 v18, v10, v120
v_fmac_f32 v19, v11, v120
v_lshlrev_b32 v10, 16, v66
v_and_b32 v11, 0xffff0000, v66
v_fmac_f32 v20, v10, v120
v_fmac_f32 v21, v11, v120
v_lshlrev_b32 v10, 16, v67
v_and_b32 v11, 0xffff0000, v67
v_fmac_f32 v22, v10, v120
v_fmac_f32 v23, v11, v120
s_waitcnt vmcnt(10)
v_lshlrev_b32 v10, 16, v68
v_and_b32 v11, 0xffff0000, v68
v_fmac_f32 v16, v10, v121
v_fmac_f32 v17, v11, v121
v_lshlrev_b32 v10, 16, v69
v_and_b32 v11, 0xffff0000, v69
v_fmac_f32 v18, v10, v121
v_fmac_f32 v19, v11, v121
v_lshlrev_b32 v10, 16, v70
v_and_b32 v11, 0xffff0000, v70
v_fmac_f32 v20, v10, v121
v_fmac_f32 v21, v11, v121
v_lshlrev_b32 v10, 16, v71
v_and_b32 v11, 0xffff0000, v71
v_fmac_f32 v22, v10, v121
v_fmac_f32 v23, v11, v121
s_waitcnt vmcnt(9)
v_lshlrev_b32 v10, 16, v72
v_and_b32 v11, 0xffff0000, v72
v_fmac_f32 v16, v10, v122
v_fmac_f32 v17, v11, v122
v_lshlrev_b32 v10, 16, v73
v_and_b32 v11, 0xffff0000, v73
v_fmac_f32 v18, v10, v122
v_fmac_f32 v19, v11, v122
v_lshlrev_b32 v10, 16, v74
v_and_b32 v11, 0xffff0000, v74
v_fmac_f32 v20, v10, v122
v_fmac_f32 v21, v11, v122
v_lshlrev_b32 v10, 16, v75
v_and_b32 v11, 0xffff0000, v75
v_fmac_f32 v22, v10, v122
v_fmac_f32 v23, v11, v122
s_waitcnt vmcnt(8)
v_lshlrev_b32 v10, 16, v76
v_and_b32 v11, 0xffff0000, v76
v_fmac_f32 v16, v10, v123
v_fmac_f32 v17, v11, v123
v_lshlrev_b32 v10, 16, v77
v_and_b32 v11, 0xffff0000, v77
v_fmac_f32 v18, v10, v123
v_fmac_f32 v19, v11, v123
v_lshlrev_b32 v10, 16, v78
v_and_b32 v11, 0xffff0000, v78
v_fmac_f32 v20, v10, v123
v_fmac_f32 v21, v11, v123
v_lshlrev_b32 v10, 16, v79
v_and_b32 v11, 0xffff0000, v79
v_fmac_f32 v22, v10, v123
v_fmac_f32 v23, v11, v123
s_waitcnt vmcnt(7)
v_lshlrev_b32 v10, 16, v80
v_and_b32 v11, 0xffff0000, v80
v_fmac_f32 v16, v10, v124
v_fmac_f32 v17, v11, v124
v_lshlrev_b32 v10, 16, v81
v_and_b32 v11, 0xffff0000, v81
v_fmac_f32 v18, v10, v124
v_fmac_f32 v19, v11, v124
v_lshlrev_b32 v10, 16, v82
v_and_b32 v11, 0xffff0000, v82
v_fmac_f32 v20, v10, v124
v_fmac_f32 v21, v11, v124
v_lshlrev_b32 v10, 16, v83
v_and_b32 v11, 0xffff0000, v83
v_fmac_f32 v22, v10, v124
v_fmac_f32 v23, v11, v124
s_waitcnt vmcnt(6)
v_lshlrev_b32 v10, 16, v84
v_and_b32 v11, 0xffff0000, v84
v_fmac_f32 v16, v10, v125
v_fmac_f32 v17, v11, v125
v_lshlrev_b32 v10, 16, v85
v_and_b32 v11, 0xffff0000, v85
v_fmac_f32 v18, v10, v125
v_fmac_f32 v19, v11, v125
v_lshlrev_b32 v10, 16, v86
v_and_b32 v11, 0xffff0000, v86
v_fmac_f32 v20, v10, v125
v_fmac_f32 v21, v11, v125
v_lshlrev_b32 v10, 16, v87
v_and_b32 v11, 0xffff0000, v87
v_fmac_f32 v22, v10, v125
v_fmac_f32 v23, v11, v125
s_waitcnt vmcnt(5)
v_lshlrev_b32 v10, 16, v88
v_and_b32 v11, 0xffff0000, v88
v_fmac_f32 v16, v10, v126
v_fmac_f32 v17, v11, v126
v_lshlrev_b32 v10, 16, v89
v_and_b32 v11, 0xffff0000, v89
v_fmac_f32 v18, v10, v126
v_fmac_f32 v19, v11, v126
v_lshlrev_b32 v10, 16, v90
v_and_b32 v11, 0xffff0000, v90
v_fmac_f32 v20, v10, v126
v_fmac_f32 v21, v11, v126
v_lshlrev_b32 v10, 16, v91
v_and_b32 v11, 0xffff0000, v91
v_fmac_f32 v22, v10, v126
v_fmac_f32 v23, v11, v126
s_waitcnt vmcnt(4)
v_lshlrev_b32 v10, 16, v92
v_and_b32 v11, 0xffff0000, v92
v_fmac_f32 v16, v10, v127
v_fmac_f32 v17, v11, v127
v_lshlrev_b32 v10, 16, v93
v_and_b32 v11, 0xffff0000, v93
v_fmac_f32 v18, v10, v127
v_fmac_f32 v19, v11, v127
v_lshlrev_b32 v10, 16, v94
v_and_b32 v11, 0xffff0000, v94
v_fmac_f32 v20, v10, v127
v_fmac_f32 v21, v11, v127
v_lshlrev_b32 v10, 16, v95
v_and_b32 v11, 0xffff0000, v95
v_fmac_f32 v22, v10, v127
v_fmac_f32 v23, v11, v127
s_waitcnt vmcnt(3)
v_lshlrev_b32 v10, 16, v96
v_and_b32 v11, 0xffff0000, v96
v_fmac_f32 v16, v10, v128
v_fmac_f32 v17, v11, v128
v_lshlrev_b32 v10, 16, v97
v_and_b32 v11, 0xffff0000, v97
v_fmac_f32 v18, v10, v128
v_fmac_f32 v19, v11, v128
v_lshlrev_b32 v10, 16, v98
v_and_b32 v11, 0xffff0000, v98
v_fmac_f32 v20, v10, v128
v_fmac_f32 v21, v11, v128
v_lshlrev_b32 v10, 16, v99
v_and_b32 v11, 0xffff0000, v99
v_fmac_f32 v22, v10, v128
v_fmac_f32 v23, v11, v128
s_waitcnt vmcnt(2)
v_lshlrev_b32 v10, 16, v100
v_and_b32 v11, 0xffff0000, v100
v_fmac_f32 v16, v10, v129
v_fmac_f32 v17, v11, v129
v_lshlrev_b32 v10, 16, v101
v_and_b32 v11, 0xffff0000, v101
v_fmac_f32 v18, v10, v129
v_fmac_f32 v19, v11, v129
v_lshlrev_b32 v10, 16, v102
v_and_b32 v11, 0xffff0000, v102
v_fmac_f32 v20, v10, v129
v_fmac_f32 v21, v11, v129
v_lshlrev_b32 v10, 16, v103
v_and_b32 v11, 0xffff0000, v103
v_fmac_f32 v22, v10, v129
v_fmac_f32 v23, v11, v129
s_waitcnt vmcnt(1)
v_lshlrev_b32 v10, 16, v104
v_and_b32 v11, 0xffff0000, v104
v_fmac_f32 v16, v10, v130
v_fmac_f32 v17, v11, v130
v_lshlrev_b32 v10, 16, v105
v_and_b32 v11, 0xffff0000, v105
v_fmac_f32 v18, v10, v130
v_fmac_f32 v19, v11, v130
v_lshlrev_b32 v10, 16, v106
v_and_b32 v11, 0xffff0000, v106
v_fmac_f32 v20, v10, v130
v_fmac_f32 v21, v11, v130
v_lshlrev_b32 v10, 16, v107
v_and_b32 v11, 0xffff0000, v107
v_fmac_f32 v22, v10, v130
v_fmac_f32 v23, v11, v130
s_waitcnt vmcnt(0)
v_lshlrev_b32 v10, 16, v108
v_and_b32 v11, 0xffff0000, v108
v_fmac_f32 v16, v10, v131
v_fmac_f32 v17, v11, v131
v_lshlrev_b32 v10, 16, v109
v_and_b32 v11, 0xffff0000, v109
v_fmac_f32 v18, v10, v131
v_fmac_f32 v19, v11, v131
v_lshlrev_b32 v10, 16, v110
v_and_b32 v11, 0xffff0000, v110
v_fmac_f32 v20, v10, v131
v_fmac_f32 v21, v11, v131
v_lshlrev_b32 v10, 16, v111
v_and_b32 v11, 0xffff0000, v111
v_fmac_f32 v22, v10, v131
v_fmac_f32 v23, v11, v131
v_lshlrev_b32 v9, 8, v1
v_lshl_add_u32 v9, v2, 5, v9
ds_write_b128 v9, v[16:19] offset:4096
ds_write_b128 v9, v[20:23] offset:4112
s_waitcnt lgkmcnt(0)
s_barrier
v_cmp_gt_u32 vcc, 64, v0
s_and_saveexec_b64 s[26:27], vcc
s_cbranch_execz MODSK_1
ds_read_b32 v32, v8 offset:4096
ds_read_b32 v33, v8 offset:4352
ds_read_b32 v34, v8 offset:4608
ds_read_b32 v35, v8 offset:4864
ds_read_b32 v36, v8 offset:5120
ds_read_b32 v37, v8 offset:5376
ds_read_b32 v38, v8 offset:5632
ds_read_b32 v39, v8 offset:5888
ds_read_b32 v40, v8 offset:6144
ds_read_b32 v41, v8 offset:6400
ds_read_b32 v42, v8 offset:6656
ds_read_b32 v43, v8 offset:6912
ds_read_b32 v44, v8 offset:7168
ds_read_b32 v45, v8 offset:7424
ds_read_b32 v46, v8 offset:7680
ds_read_b32 v47, v8 offset:7936
ds_read_b32 v48, v8 offset:8192
ds_read_b32 v49, v8 offset:8448
ds_read_b32 v50, v8 offset:8704
ds_read_b32 v51, v8 offset:8960
ds_read_b32 v52, v8 offset:9216
ds_read_b32 v53, v8 offset:9472
ds_read_b32 v54, v8 offset:9728
ds_read_b32 v55, v8 offset:9984
ds_read_b32 v56, v8 offset:10240
ds_read_b32 v57, v8 offset:10496
ds_read_b32 v58, v8 offset:10752
ds_read_b32 v59, v8 offset:11008
ds_read_b32 v60, v8 offset:11264
ds_read_b32 v61, v8 offset:11520
ds_read_b32 v62, v8 offset:11776
ds_read_b32 v63, v8 offset:12032
s_waitcnt lgkmcnt(0)
v_add_f32 v32, v32, v48
v_add_f32 v33, v33, v49
v_add_f32 v34, v34, v50
v_add_f32 v35, v35, v51
v_add_f32 v36, v36, v52
v_add_f32 v37, v37, v53
v_add_f32 v38, v38, v54
v_add_f32 v39, v39, v55
v_add_f32 v40, v40, v56
v_add_f32 v41, v41, v57
v_add_f32 v42, v42, v58
v_add_f32 v43, v43, v59
v_add_f32 v44, v44, v60
v_add_f32 v45, v45, v61
v_add_f32 v46, v46, v62
v_add_f32 v47, v47, v63
v_add_f32 v32, v32, v40
v_add_f32 v33, v33, v41
v_add_f32 v34, v34, v42
v_add_f32 v35, v35, v43
v_add_f32 v36, v36, v44
v_add_f32 v37, v37, v45
v_add_f32 v38, v38, v46
v_add_f32 v39, v39, v47
v_add_f32 v32, v32, v36
v_add_f32 v33, v33, v37
v_add_f32 v34, v34, v38
v_add_f32 v35, v35, v39
v_add_f32 v32, v32, v34
v_add_f32 v33, v33, v35
v_add_f32 v32, v32, v33
v_cvt_pk_bf16_f32 v32, v32, v32
v_and_b32 v32, 0xffff0000, v32
s_lshl_b32 s3, s2, 8
v_add_u32 v9, s3, v8
buffer_store_dword v32, v9, s[20:23], 0 offen offset:0 sc0 sc1
MODSK_1:
s_mov_b64 exec, s[26:27]
s_branch KA_FIN
KA_STATS:
s_load_dwordx2 s[4:5], s[0:1], 0
s_load_dwordx2 s[8:9], s[0:1], 120
s_sub_u32 s26, s2, 0
s_lshl_b32 s26, s26, 6
v_and_b32 v1, 63, v0
v_lshrrev_b32 v2, 6, v0
s_nop 0
v_readfirstlane_b32 s30, v2
v_add_u32 v3, 0, v1
v_mul_u32_u24 v4, 52429, v3
v_lshrrev_b32 v4, 22, v4
v_mul_u32_u24 v5, 80, v4
v_sub_u32 v5, v3, v5
v_lshrrev_b32 v6, 1, v4
v_xor_b32 v5, v5, v6
v_lshlrev_b32 v5, 4, v5
v_mov_b32 v10, v5
v_mul_u32_u24 v15, 1280, v4
v_add_u32 v3, 64, v1
v_mul_u32_u24 v4, 52429, v3
v_lshrrev_b32 v4, 22, v4
v_mul_u32_u24 v5, 80, v4
v_sub_u32 v5, v3, v5
v_lshrrev_b32 v6, 1, v4
v_xor_b32 v5, v5, v6
v_lshlrev_b32 v5, 4, v5
v_mov_b32 v11, v5
v_mul_u32_u24 v16, 1280, v4
v_add_u32 v3, 128, v1
v_mul_u32_u24 v4, 52429, v3
v_lshrrev_b32 v4, 22, v4
v_mul_u32_u24 v5, 80, v4
v_sub_u32 v5, v3, v5
v_lshrrev_b32 v6, 1, v4
v_xor_b32 v5, v5, v6
v_lshlrev_b32 v5, 4, v5
v_mov_b32 v12, v5
v_mul_u32_u24 v17, 1280, v4
v_add_u32 v3, 192, v1
v_mul_u32_u24 v4, 52429, v3
v_lshrrev_b32 v4, 22, v4
v_mul_u32_u24 v5, 80, v4
v_sub_u32 v5, v3, v5
v_lshrrev_b32 v6, 1, v4
v_xor_b32 v5, v5, v6
v_lshlrev_b32 v5, 4, v5
v_mov_b32 v13, v5
v_mul_u32_u24 v18, 1280, v4
v_add_u32 v3, 256, v1
v_mul_u32_u24 v4, 52429, v3
v_lshrrev_b32 v4, 22, v4
v_mul_u32_u24 v5, 80, v4
v_sub_u32 v5, v3, v5
v_lshrrev_b32 v6, 1, v4
v_xor_b32 v5, v5, v6
v_lshlrev_b32 v5, 4, v5
v_mov_b32 v14, v5
v_mul_u32_u24 v19, 1280, v4
s_lshl_b32 s3, s30, 4
s_add_u32 s3, s3, s26
s_mul_i32 s27, s3, 1280
s_mul_i32 s28, s30, 20480
s_and_b32 s36, s30, 1
s_lshl_b32 s36, s36, 7
s_waitcnt lgkmcnt(0)
s_mov_b32 s12, s4
s_mov_b32 s13, s5
s_mov_b32 s14, 2621440
s_mov_b32 s15, 0x00020000
s_mov_b32 s20, s8
s_mov_b32 s21, s9
s_mov_b32 s22, 268435456
s_mov_b32 s23, 0x00020000
s_add_u32 m0, s28, 0
s_add_u32 s29, s36, 0
v_xad_u32 v20, v10, s29, v15
buffer_load_dwordx4 v20, s[12:15], s27 offen lds
s_add_u32 m0, s28, 1024
s_add_u32 s29, s36, 0
v_xad_u32 v21, v11, s29, v16
buffer_load_dwordx4 v21, s[12:15], s27 offen lds
s_add_u32 m0, s28, 2048
s_add_u32 s29, s36, 0
v_xad_u32 v22, v12, s29, v17
buffer_load_dwordx4 v22, s[12:15], s27 offen lds
s_add_u32 m0, s28, 3072
s_add_u32 s29, s36, 0
v_xad_u32 v23, v13, s29, v18
buffer_load_dwordx4 v23, s[12:15], s27 offen lds
s_add_u32 m0, s28, 4096
s_add_u32 s29, s36, 0
v_xad_u32 v20, v14, s29, v19
buffer_load_dwordx4 v20, s[12:15], s27 offen lds
s_add_u32 s27, s27, 5120
s_add_u32 m0, s28, 5120
s_add_u32 s29, s36, 32
v_xad_u32 v21, v10, s29, v15
buffer_load_dwordx4 v21, s[12:15], s27 offen lds
s_add_u32 m0, s28, 6144
s_add_u32 s29, s36, 32
v_xad_u32 v22, v11, s29, v16
buffer_load_dwordx4 v22, s[12:15], s27 offen lds
s_add_u32 m0, s28, 7168
s_add_u32 s29, s36, 32
v_xad_u32 v23, v12, s29, v17
buffer_load_dwordx4 v23, s[12:15], s27 offen lds
s_add_u32 m0, s28, 8192
s_add_u32 s29, s36, 32
v_xad_u32 v20, v13, s29, v18
buffer_load_dwordx4 v20, s[12:15], s27 offen lds
s_add_u32 m0, s28, 9216
s_add_u32 s29, s36, 32
v_xad_u32 v21, v14, s29, v19
buffer_load_dwordx4 v21, s[12:15], s27 offen lds
s_add_u32 s27, s27, 5120
s_add_u32 m0, s28, 10240
s_add_u32 s29, s36, 64
v_xad_u32 v22, v10, s29, v15
buffer_load_dwordx4 v22, s[12:15], s27 offen lds
s_add_u32 m0, s28, 11264
s_add_u32 s29, s36, 64
v_xad_u32 v23, v11, s29, v16
buffer_load_dwordx4 v23, s[12:15], s27 offen lds
s_add_u32 m0, s28, 12288
s_add_u32 s29, s36, 64
v_xad_u32 v20, v12, s29, v17
buffer_load_dwordx4 v20, s[12:15], s27 offen lds
s_add_u32 m0, s28, 13312
s_add_u32 s29, s36, 64
v_xad_u32 v21, v13, s29, v18
buffer_load_dwordx4 v21, s[12:15], s27 offen lds
s_add_u32 m0, s28, 14336
s_add_u32 s29, s36, 64
v_xad_u32 v22, v14, s29, v19
buffer_load_dwordx4 v22, s[12:15], s27 offen lds
s_add_u32 s27, s27, 5120
s_add_u32 m0, s28, 15360
s_add_u32 s29, s36, 96
v_xad_u32 v23, v10, s29, v15
buffer_load_dwordx4 v23, s[12:15], s27 offen lds
s_add_u32 m0, s28, 16384
s_add_u32 s29, s36, 96
v_xad_u32 v20, v11, s29, v16
buffer_load_dwordx4 v20, s[12:15], s27 offen lds
s_add_u32 m0, s28, 17408
s_add_u32 s29, s36, 96
v_xad_u32 v21, v12, s29, v17
buffer_load_dwordx4 v21, s[12:15], s27 offen lds
s_add_u32 m0, s28, 18432
s_add_u32 s29, s36, 96
v_xad_u32 v22, v13, s29, v18
buffer_load_dwordx4 v22, s[12:15], s27 offen lds
s_add_u32 m0, s28, 19456
s_add_u32 s29, s36, 96
v_xad_u32 v23, v14, s29, v19
buffer_load_dwordx4 v23, s[12:15], s27 offen lds
v_and_b32 v6, 31, v1
v_lshrrev_b32 v7, 5, v1
v_lshl_add_u32 v8, v6, 1, v7
v_and_b32 v3, 15, v1
v_lshlrev_b32 v3, 4, v3
v_mul_u32_u24 v4, 1280, v8
v_lshlrev_b32 v7, 14, v7
v_lshl_add_u32 v7, v6, 4, v7
s_mov_b32 s25, 0x3f803f80
v_lshlrev_b32 v9, 3, v8
s_lshl_b32 s3, s26, 3
s_add_u32 s31, s3, 3145728
s_mul_i32 s3, s30, 655360
s_add_u32 s31, s31, s3
v_mov_b32 v24, 0
v_mov_b32 v25, 0
v_mov_b32 v26, 0
v_mov_b32 v27, 0
s_waitcnt vmcnt(0)
s_barrier
s_mul_i32 s33, s30, 20
s_add_u32 s3, s33, 0
s_and_b32 s34, s3, 15
s_lshl_b32 s34, s34, 4
s_and_b32 s35, s3, 0xf0
s_lshl_b32 s35, s35, 4
v_xad_u32 v28, v3, s34, v4
v_add_u32 v28, s35, v28
ds_read_b128 v[32:35], v28
s_add_u32 s3, s33, 1
s_and_b32 s34, s3, 15
s_lshl_b32 s34, s34, 4
s_and_b32 s35, s3, 0xf0
s_lshl_b32 s35, s35, 4
v_xad_u32 v29, v3, s34, v4
v_add_u32 v29, s35, v29
ds_read_b128 v[36:39], v29
s_add_u32 s3, s33, 2
s_and_b32 s34, s3, 15
s_lshl_b32 s34, s34, 4
s_and_b32 s35, s3, 0xf0
s_lshl_b32 s35, s35, 4
v_xad_u32 v30, v3, s34, v4
v_add_u32 v30, s35, v30
ds_read_b128 v[40:43], v30
s_add_u32 s3, s33, 3
s_and_b32 s34, s3, 15
s_lshl_b32 s34, s34, 4
s_and_b32 s35, s3, 0xf0
s_lshl_b32 s35, s35, 4
v_xad_u32 v31, v3, s34, v4
v_add_u32 v31, s35, v31
ds_read_b128 v[44:47], v31
s_add_u32 s3, s33, 4
s_and_b32 s34, s3, 15
s_lshl_b32 s34, s34, 4
s_and_b32 s35, s3, 0xf0
s_lshl_b32 s35, s35, 4
v_xad_u32 v28, v3, s34, v4
v_add_u32 v28, s35, v28
ds_read_b128 v[48:51], v28
s_add_u32 s3, s33, 5
s_and_b32 s34, s3, 15
s_lshl_b32 s34, s34, 4
s_and_b32 s35, s3, 0xf0
s_lshl_b32 s35, s35, 4
v_xad_u32 v29, v3, s34, v4
v_add_u32 v29, s35, v29
ds_read_b128 v[52:55], v29
s_add_u32 s3, s33, 6
s_and_b32 s34, s3, 15
s_lshl_b32 s34, s34, 4
s_and_b32 s35, s3, 0xf0
s_lshl_b32 s35, s35, 4
v_xad_u32 v30, v3, s34, v4
v_add_u32 v30, s35, v30
ds_read_b128 v[56:59], v30
s_add_u32 s3, s33, 7
s_and_b32 s34, s3, 15
s_lshl_b32 s34, s34, 4
s_and_b32 s35, s3, 0xf0
s_lshl_b32 s35, s35, 4
v_xad_u32 v31, v3, s34, v4
v_add_u32 v31, s35, v31
ds_read_b128 v[60:63], v31
s_add_u32 s3, s33, 8
s_and_b32 s34, s3, 15
s_lshl_b32 s34, s34, 4
s_and_b32 s35, s3, 0xf0
s_lshl_b32 s35, s35, 4
v_xad_u32 v28, v3, s34, v4
v_add_u32 v28, s35, v28
ds_read_b128 v[64:67], v28
s_add_u32 s3, s33, 9
s_and_b32 s34, s3, 15
s_lshl_b32 s34, s34, 4
s_and_b32 s35, s3, 0xf0
s_lshl_b32 s35, s35, 4
v_xad_u32 v29, v3, s34, v4
v_add_u32 v29, s35, v29
ds_read_b128 v[68:71], v29
s_add_u32 s3, s33, 10
s_and_b32 s34, s3, 15
s_lshl_b32 s34, s34, 4
s_and_b32 s35, s3, 0xf0
s_lshl_b32 s35, s35, 4
v_xad_u32 v30, v3, s34, v4
v_add_u32 v30, s35, v30
ds_read_b128 v[72:75], v30
s_add_u32 s3, s33, 11
s_and_b32 s34, s3, 15
s_lshl_b32 s34, s34, 4
s_and_b32 s35, s3, 0xf0
s_lshl_b32 s35, s35, 4
v_xad_u32 v31, v3, s34, v4
v_add_u32 v31, s35, v31
ds_read_b128 v[76:79], v31
s_add_u32 s3, s33, 12
s_and_b32 s34, s3, 15
s_lshl_b32 s34, s34, 4
s_and_b32 s35, s3, 0xf0
s_lshl_b32 s35, s35, 4
v_xad_u32 v28, v3, s34, v4
v_add_u32 v28, s35, v28
ds_read_b128 v[80:83], v28
s_add_u32 s3, s33, 13
s_and_b32 s34, s3, 15
s_lshl_b32 s34, s34, 4
s_and_b32 s35, s3, 0xf0
s_lshl_b32 s35, s35, 4
v_xad_u32 v29, v3, s34, v4
v_add_u32 v29, s35, v29
ds_read_b128 v[84:87], v29
s_add_u32 s3, s33, 14
s_and_b32 s34, s3, 15
s_lshl_b32 s34, s34, 4
s_and_b32 s35, s3, 0xf0
s_lshl_b32 s35, s35, 4
v_xad_u32 v30, v3, s34, v4
v_add_u32 v30, s35, v30
ds_read_b128 v[88:91], v30
s_add_u32 s3, s33, 15
s_and_b32 s34, s3, 15
s_lshl_b32 s34, s34, 4
s_and_b32 s35, s3, 0xf0
s_lshl_b32 s35, s35, 4
v_xad_u32 v31, v3, s34, v4
v_add_u32 v31, s35, v31
ds_read_b128 v[92:95], v31
s_add_u32 s3, s33, 16
s_and_b32 s34, s3, 15
s_lshl_b32 s34, s34, 4
s_and_b32 s35, s3, 0xf0
s_lshl_b32 s35, s35, 4
v_xad_u32 v28, v3, s34, v4
v_add_u32 v28, s35, v28
ds_read_b128 v[96:99], v28
s_add_u32 s3, s33, 17
s_and_b32 s34, s3, 15
s_lshl_b32 s34, s34, 4
s_and_b32 s35, s3, 0xf0
s_lshl_b32 s35, s35, 4
v_xad_u32 v29, v3, s34, v4
v_add_u32 v29, s35, v29
ds_read_b128 v[100:103], v29
s_add_u32 s3, s33, 18
s_and_b32 s34, s3, 15
s_lshl_b32 s34, s34, 4
s_and_b32 s35, s3, 0xf0
s_lshl_b32 s35, s35, 4
v_xad_u32 v30, v3, s34, v4
v_add_u32 v30, s35, v30
ds_read_b128 v[104:107], v30
s_add_u32 s3, s33, 19
s_and_b32 s34, s3, 15
s_lshl_b32 s34, s34, 4
s_and_b32 s35, s3, 0xf0
s_lshl_b32 s35, s35, 4
v_xad_u32 v31, v3, s34, v4
v_add_u32 v31, s35, v31
ds_read_b128 v[108:111], v31
s_waitcnt lgkmcnt(15)
v_dot2_f32_bf16 v24, v32, s25, v24
v_dot2_f32_bf16 v26, v32, v32, v26
v_dot2_f32_bf16 v25, v33, s25, v25
v_dot2_f32_bf16 v27, v33, v33, v27
v_dot2_f32_bf16 v24, v34, s25, v24
v_dot2_f32_bf16 v26, v34, v34, v26
v_dot2_f32_bf16 v25, v35, s25, v25
v_dot2_f32_bf16 v27, v35, v35, v27
v_permlane32_swap_b32 v32, v34
v_permlane32_swap_b32 v33, v35
buffer_store_dwordx4 v[32:35], v7, s[20:23], s31 offen sc0 sc1
s_add_u32 s31, s31, 32768
s_waitcnt lgkmcnt(15)
v_dot2_f32_bf16 v24, v36, s25, v24
v_dot2_f32_bf16 v26, v36, v36, v26
v_dot2_f32_bf16 v25, v37, s25, v25
v_dot2_f32_bf16 v27, v37, v37, v27
v_dot2_f32_bf16 v24, v38, s25, v24
v_dot2_f32_bf16 v26, v38, v38, v26
v_dot2_f32_bf16 v25, v39, s25, v25
v_dot2_f32_bf16 v27, v39, v39, v27
v_permlane32_swap_b32 v36, v38
v_permlane32_swap_b32 v37, v39
buffer_store_dwordx4 v[36:39], v7, s[20:23], s31 offen sc0 sc1
s_add_u32 s31, s31, 32768
s_waitcnt lgkmcnt(15)
v_dot2_f32_bf16 v24, v40, s25, v24
v_dot2_f32_bf16 v26, v40, v40, v26
v_dot2_f32_bf16 v25, v41, s25, v25
v_dot2_f32_bf16 v27, v41, v41, v27
v_dot2_f32_bf16 v24, v42, s25, v24
v_dot2_f32_bf16 v26, v42, v42, v26
v_dot2_f32_bf16 v25, v43, s25, v25
v_dot2_f32_bf16 v27, v43, v43, v27
v_permlane32_swap_b32 v40, v42
v_permlane32_swap_b32 v41, v43
buffer_store_dwordx4 v[40:43], v7, s[20:23], s31 offen sc0 sc1
s_add_u32 s31, s31, 32768
s_waitcnt lgkmcnt(15)
v_dot2_f32_bf16 v24, v44, s25, v24
v_dot2_f32_bf16 v26, v44, v44, v26
v_dot2_f32_bf16 v25, v45, s25, v25
v_dot2_f32_bf16 v27, v45, v45, v27
v_dot2_f32_bf16 v24, v46, s25, v24
v_dot2_f32_bf16 v26, v46, v46, v26
v_dot2_f32_bf16 v25, v47, s25, v25
v_dot2_f32_bf16 v27, v47, v47, v27
v_permlane32_swap_b32 v44, v46
v_permlane32_swap_b32 v45, v47
buffer_store_dwordx4 v[44:47], v7, s[20:23], s31 offen sc0 sc1
s_add_u32 s31, s31, 32768
s_waitcnt lgkmcnt(15)
v_dot2_f32_bf16 v24, v48, s25, v24
v_dot2_f32_bf16 v26, v48, v48, v26
v_dot2_f32_bf16 v25, v49, s25, v25
v_dot2_f32_bf16 v27, v49, v49, v27
v_dot2_f32_bf16 v24, v50, s25, v24
v_dot2_f32_bf16 v26, v50, v50, v26
v_dot2_f32_bf16 v25, v51, s25, v25
v_dot2_f32_bf16 v27, v51, v51, v27
v_permlane32_swap_b32 v48, v50
v_permlane32_swap_b32 v49, v51
buffer_store_dwordx4 v[48:51], v7, s[20:23], s31 offen sc0 sc1
s_add_u32 s31, s31, 32768
s_waitcnt lgkmcnt(14)
v_dot2_f32_bf16 v24, v52, s25, v24
v_dot2_f32_bf16 v26, v52, v52, v26
v_dot2_f32_bf16 v25, v53, s25, v25
v_dot2_f32_bf16 v27, v53, v53, v27
v_dot2_f32_bf16 v24, v54, s25, v24
v_dot2_f32_bf16 v26, v54, v54, v26
v_dot2_f32_bf16 v25, v55, s25, v25
v_dot2_f32_bf16 v27, v55, v55, v27
v_permlane32_swap_b32 v52, v54
v_permlane32_swap_b32 v53, v55
buffer_store_dwordx4 v[52:55], v7, s[20:23], s31 offen sc0 sc1
s_add_u32 s31, s31, 32768
s_waitcnt lgkmcnt(13)
v_dot2_f32_bf16 v24, v56, s25, v24
v_dot2_f32_bf16 v26, v56, v56, v26
v_dot2_f32_bf16 v25, v57, s25, v25
v_dot2_f32_bf16 v27, v57, v57, v27
v_dot2_f32_bf16 v24, v58, s25, v24
v_dot2_f32_bf16 v26, v58, v58, v26
v_dot2_f32_bf16 v25, v59, s25, v25
v_dot2_f32_bf16 v27, v59, v59, v27
v_permlane32_swap_b32 v56, v58
v_permlane32_swap_b32 v57, v59
buffer_store_dwordx4 v[56:59], v7, s[20:23], s31 offen sc0 sc1
s_add_u32 s31, s31, 32768
s_waitcnt lgkmcnt(12)
v_dot2_f32_bf16 v24, v60, s25, v24
v_dot2_f32_bf16 v26, v60, v60, v26
v_dot2_f32_bf16 v25, v61, s25, v25
v_dot2_f32_bf16 v27, v61, v61, v27
v_dot2_f32_bf16 v24, v62, s25, v24
v_dot2_f32_bf16 v26, v62, v62, v26
v_dot2_f32_bf16 v25, v63, s25, v25
v_dot2_f32_bf16 v27, v63, v63, v27
v_permlane32_swap_b32 v60, v62
v_permlane32_swap_b32 v61, v63
buffer_store_dwordx4 v[60:63], v7, s[20:23], s31 offen sc0 sc1
s_add_u32 s31, s31, 32768
s_waitcnt lgkmcnt(11)
v_dot2_f32_bf16 v24, v64, s25, v24
v_dot2_f32_bf16 v26, v64, v64, v26
v_dot2_f32_bf16 v25, v65, s25, v25
v_dot2_f32_bf16 v27, v65, v65, v27
v_dot2_f32_bf16 v24, v66, s25, v24
v_dot2_f32_bf16 v26, v66, v66, v26
v_dot2_f32_bf16 v25, v67, s25, v25
v_dot2_f32_bf16 v27, v67, v67, v27
v_permlane32_swap_b32 v64, v66
v_permlane32_swap_b32 v65, v67
buffer_store_dwordx4 v[64:67], v7, s[20:23], s31 offen sc0 sc1
s_add_u32 s31, s31, 32768
s_waitcnt lgkmcnt(10)
v_dot2_f32_bf16 v24, v68, s25, v24
v_dot2_f32_bf16 v26, v68, v68, v26
v_dot2_f32_bf16 v25, v69, s25, v25
v_dot2_f32_bf16 v27, v69, v69, v27
v_dot2_f32_bf16 v24, v70, s25, v24
v_dot2_f32_bf16 v26, v70, v70, v26
v_dot2_f32_bf16 v25, v71, s25, v25
v_dot2_f32_bf16 v27, v71, v71, v27
v_permlane32_swap_b32 v68, v70
v_permlane32_swap_b32 v69, v71
buffer_store_dwordx4 v[68:71], v7, s[20:23], s31 offen sc0 sc1
s_add_u32 s31, s31, 32768
s_waitcnt lgkmcnt(9)
v_dot2_f32_bf16 v24, v72, s25, v24
v_dot2_f32_bf16 v26, v72, v72, v26
v_dot2_f32_bf16 v25, v73, s25, v25
v_dot2_f32_bf16 v27, v73, v73, v27
v_dot2_f32_bf16 v24, v74, s25, v24
v_dot2_f32_bf16 v26, v74, v74, v26
v_dot2_f32_bf16 v25, v75, s25, v25
v_dot2_f32_bf16 v27, v75, v75, v27
v_permlane32_swap_b32 v72, v74
v_permlane32_swap_b32 v73, v75
buffer_store_dwordx4 v[72:75], v7, s[20:23], s31 offen sc0 sc1
s_add_u32 s31, s31, 32768
s_waitcnt lgkmcnt(8)
v_dot2_f32_bf16 v24, v76, s25, v24
v_dot2_f32_bf16 v26, v76, v76, v26
v_dot2_f32_bf16 v25, v77, s25, v25
v_dot2_f32_bf16 v27, v77, v77, v27
v_dot2_f32_bf16 v24, v78, s25, v24
v_dot2_f32_bf16 v26, v78, v78, v26
v_dot2_f32_bf16 v25, v79, s25, v25
v_dot2_f32_bf16 v27, v79, v79, v27
v_permlane32_swap_b32 v76, v78
v_permlane32_swap_b32 v77, v79
buffer_store_dwordx4 v[76:79], v7, s[20:23], s31 offen sc0 sc1
s_add_u32 s31, s31, 32768
s_waitcnt lgkmcnt(7)
v_dot2_f32_bf16 v24, v80, s25, v24
v_dot2_f32_bf16 v26, v80, v80, v26
v_dot2_f32_bf16 v25, v81, s25, v25
v_dot2_f32_bf16 v27, v81, v81, v27
v_dot2_f32_bf16 v24, v82, s25, v24
v_dot2_f32_bf16 v26, v82, v82, v26
v_dot2_f32_bf16 v25, v83, s25, v25
v_dot2_f32_bf16 v27, v83, v83, v27
v_permlane32_swap_b32 v80, v82
v_permlane32_swap_b32 v81, v83
buffer_store_dwordx4 v[80:83], v7, s[20:23], s31 offen sc0 sc1
s_add_u32 s31, s31, 32768
s_waitcnt lgkmcnt(6)
v_dot2_f32_bf16 v24, v84, s25, v24
v_dot2_f32_bf16 v26, v84, v84, v26
v_dot2_f32_bf16 v25, v85, s25, v25
v_dot2_f32_bf16 v27, v85, v85, v27
v_dot2_f32_bf16 v24, v86, s25, v24
v_dot2_f32_bf16 v26, v86, v86, v26
v_dot2_f32_bf16 v25, v87, s25, v25
v_dot2_f32_bf16 v27, v87, v87, v27
v_permlane32_swap_b32 v84, v86
v_permlane32_swap_b32 v85, v87
buffer_store_dwordx4 v[84:87], v7, s[20:23], s31 offen sc0 sc1
s_add_u32 s31, s31, 32768
s_waitcnt lgkmcnt(5)
v_dot2_f32_bf16 v24, v88, s25, v24
v_dot2_f32_bf16 v26, v88, v88, v26
v_dot2_f32_bf16 v25, v89, s25, v25
v_dot2_f32_bf16 v27, v89, v89, v27
v_dot2_f32_bf16 v24, v90, s25, v24
v_dot2_f32_bf16 v26, v90, v90, v26
v_dot2_f32_bf16 v25, v91, s25, v25
v_dot2_f32_bf16 v27, v91, v91, v27
v_permlane32_swap_b32 v88, v90
v_permlane32_swap_b32 v89, v91
buffer_store_dwordx4 v[88:91], v7, s[20:23], s31 offen sc0 sc1
s_add_u32 s31, s31, 32768
s_waitcnt lgkmcnt(4)
v_dot2_f32_bf16 v24, v92, s25, v24
v_dot2_f32_bf16 v26, v92, v92, v26
v_dot2_f32_bf16 v25, v93, s25, v25
v_dot2_f32_bf16 v27, v93, v93, v27
v_dot2_f32_bf16 v24, v94, s25, v24
v_dot2_f32_bf16 v26, v94, v94, v26
v_dot2_f32_bf16 v25, v95, s25, v25
v_dot2_f32_bf16 v27, v95, v95, v27
v_permlane32_swap_b32 v92, v94
v_permlane32_swap_b32 v93, v95
buffer_store_dwordx4 v[92:95], v7, s[20:23], s31 offen sc0 sc1
s_add_u32 s31, s31, 32768
s_waitcnt lgkmcnt(3)
v_dot2_f32_bf16 v24, v96, s25, v24
v_dot2_f32_bf16 v26, v96, v96, v26
v_dot2_f32_bf16 v25, v97, s25, v25
v_dot2_f32_bf16 v27, v97, v97, v27
v_dot2_f32_bf16 v24, v98, s25, v24
v_dot2_f32_bf16 v26, v98, v98, v26
v_dot2_f32_bf16 v25, v99, s25, v25
v_dot2_f32_bf16 v27, v99, v99, v27
v_permlane32_swap_b32 v96, v98
v_permlane32_swap_b32 v97, v99
buffer_store_dwordx4 v[96:99], v7, s[20:23], s31 offen sc0 sc1
s_add_u32 s31, s31, 32768
s_waitcnt lgkmcnt(2)
v_dot2_f32_bf16 v24, v100, s25, v24
v_dot2_f32_bf16 v26, v100, v100, v26
v_dot2_f32_bf16 v25, v101, s25, v25
v_dot2_f32_bf16 v27, v101, v101, v27
v_dot2_f32_bf16 v24, v102, s25, v24
v_dot2_f32_bf16 v26, v102, v102, v26
v_dot2_f32_bf16 v25, v103, s25, v25
v_dot2_f32_bf16 v27, v103, v103, v27
v_permlane32_swap_b32 v100, v102
v_permlane32_swap_b32 v101, v103
buffer_store_dwordx4 v[100:103], v7, s[20:23], s31 offen sc0 sc1
s_add_u32 s31, s31, 32768
s_waitcnt lgkmcnt(1)
v_dot2_f32_bf16 v24, v104, s25, v24
v_dot2_f32_bf16 v26, v104, v104, v26
v_dot2_f32_bf16 v25, v105, s25, v25
v_dot2_f32_bf16 v27, v105, v105, v27
v_dot2_f32_bf16 v24, v106, s25, v24
v_dot2_f32_bf16 v26, v106, v106, v26
v_dot2_f32_bf16 v25, v107, s25, v25
v_dot2_f32_bf16 v27, v107, v107, v27
v_permlane32_swap_b32 v104, v106
v_permlane32_swap_b32 v105, v107
buffer_store_dwordx4 v[104:107], v7, s[20:23], s31 offen sc0 sc1
s_add_u32 s31, s31, 32768
s_waitcnt lgkmcnt(0)
v_dot2_f32_bf16 v24, v108, s25, v24
v_dot2_f32_bf16 v26, v108, v108, v26
v_dot2_f32_bf16 v25, v109, s25, v25
v_dot2_f32_bf16 v27, v109, v109, v27
v_dot2_f32_bf16 v24, v110, s25, v24
v_dot2_f32_bf16 v26, v110, v110, v26
v_dot2_f32_bf16 v25, v111, s25, v25
v_dot2_f32_bf16 v27, v111, v111, v27
v_permlane32_swap_b32 v108, v110
v_permlane32_swap_b32 v109, v111
buffer_store_dwordx4 v[108:111], v7, s[20:23], s31 offen sc0 sc1
s_add_u32 s31, s31, 32768
s_nop 2
v_add_f32 v24, v24, v25
v_add_f32 v25, v26, v27
v_lshlrev_b32 v5, 3, v0
v_add_u32 v5, 81920, v5
ds_write_b64 v5, v[24:25]
s_waitcnt lgkmcnt(0)
s_barrier
s_cmp_lg_u32 s30, 0
s_cbranch_scc1 STX_2
ds_read_b64 v[32:33], v5 offset:0
ds_read_b64 v[34:35], v5 offset:512
ds_read_b64 v[36:37], v5 offset:1024
ds_read_b64 v[38:39], v5 offset:1536
s_waitcnt lgkmcnt(0)
v_add_f32 v32, v32, v34
v_add_f32 v33, v33, v35
v_add_f32 v36, v36, v38
v_add_f32 v37, v37, v39
v_add_f32 v32, v32, v36
v_add_f32 v33, v33, v37
v_mul_f32 v32, 0x3acccccd, v32
v_mul_f32 v33, 0x3acccccd, v33
v_fma_f32 v33, -v32, v32, v33
v_max_f32 v33, 0, v33
v_cvt_pk_bf16_f32 v33, v33, v33
v_and_b32 v33, 0xffff0000, v33
v_add_f32 v33, 0x3727c5ac, v33
v_cvt_pk_bf16_f32 v33, v33, v33
v_and_b32 v33, 0xffff0000, v33
v_sqrt_f32 v33, v33
s_nop 0
v_cvt_pk_bf16_f32 v33, v33, v33
v_and_b32 v33, 0xffff0000, v33
v_rcp_f32 v34, v33
s_nop 0
v_fma_f32 v35, -v33, v34, 1.0
v_fma_f32 v34, v35, v34, v34
v_cvt_pk_bf16_f32 v32, v32, v32
v_and_b32 v32, 0xffff0000, v32
v_mul_f32 v35, -v32, v34
s_lshl_b32 s3, s26, 3
s_add_u32 s3, s3, 16384
buffer_store_dwordx2 v[34:35], v9, s[20:23], s3 offen sc0 sc1
STX_2:
s_branch KA_FIN
KA_KG:
s_cmp_ge_u32 s2, 253
s_cbranch_scc1 KA_END
s_cmp_eq_u32 s2, 252
s_cbranch_scc1 KA_CPF
s_load_dwordx2 s[8:9], s[0:1], 120
s_load_dwordx4 s[36:39], s[0:1], 8
s_load_dwordx4 s[40:43], s[0:1], 24
s_load_dwordx2 s[44:45], s[0:1], 40
s_load_dwordx4 s[4:7], s[0:1], 64
s_load_dwordx2 s[10:11], s[0:1], 80
v_and_b32 v1, 63, v0
v_lshrrev_b32 v2, 6, v0
s_nop 0
v_readfirstlane_b32 s30, v2
s_sub_u32 s31, s2, 92
s_lshl_b32 s31, s31, 2
s_add_u32 s31, s31, s30
s_waitcnt lgkmcnt(0)
s_mov_b32 s20, s8
s_mov_b32 s21, s9
s_mov_b32 s22, 268435456
s_mov_b32 s23, 0x00020000
s_mov_b32 s48, s36
s_mov_b32 s49, s37
s_mov_b32 s50, 245760
s_mov_b32 s51, 0x00020000
s_mov_b32 s52, s38
s_mov_b32 s53, s39
s_mov_b32 s54, 245760
s_mov_b32 s55, 0x00020000
s_mov_b32 s56, s40
s_mov_b32 s57, s41
s_mov_b32 s58, 245760
s_mov_b32 s59, 0x00020000
s_mov_b32 s60, s42
s_mov_b32 s61, s43
s_mov_b32 s62, 245760
s_mov_b32 s63, 0x00020000
s_mov_b32 s64, s44
s_mov_b32 s65, s45
s_mov_b32 s66, 1280
s_mov_b32 s67, 0x00020000
s_mul_i32 s3, s31, 384
v_lshlrev_b32 v3, 1, v1
v_add_u32 v3, s3, v3
s_lshl_b32 s3, s31, 1
v_mov_b32 v4, s3
buffer_load_ushort v196, v4, s[64:67], 0 offen
buffer_load_ushort v184, v3, s[48:51], 0 offen offset:0
buffer_load_ushort v185, v3, s[52:55], 0 offen offset:0
buffer_load_ushort v186, v3, s[56:59], 0 offen offset:0
buffer_load_ushort v187, v3, s[60:63], 0 offen offset:0
buffer_load_ushort v188, v3, s[48:51], 0 offen offset:128
buffer_load_ushort v189, v3, s[52:55], 0 offen offset:128
buffer_load_ushort v190, v3, s[56:59], 0 offen offset:128
buffer_load_ushort v191, v3, s[60:63], 0 offen offset:128
buffer_load_ushort v192, v3, s[48:51], 0 offen offset:256
buffer_load_ushort v193, v3, s[52:55], 0 offen offset:256
buffer_load_ushort v194, v3, s[56:59], 0 offen offset:256
buffer_load_ushort v195, v3, s[60:63], 0 offen offset:256
s_waitcnt vmcnt(0)
v_lshlrev_b32 v196, 16, v196
v_mul_f32 v8, 0x3fb8aa3b, v196
v_exp_f32 v8, v8
s_nop 0
v_cvt_pk_bf16_f32 v8, v8, v8
v_and_b32 v8, 0xffff0000, v8
v_add_f32 v9, v8, v8
s_mul_i32 s33, s30, 16320
s_mov_b32 m0, s33
v_and_b32 v10, 31, v1
v_mul_u32_u24 v10, 272, v10
v_lshrrev_b32 v11, 5, v1
v_lshl_add_u32 v10, v11, 4, v10
v_add_u32 v10, s33, v10
v_lshlrev_b32 v184, 16, v184
v_lshlrev_b32 v185, 16, v185
v_lshlrev_b32 v186, 16, v186
v_lshlrev_b32 v187, 16, v187
v_mul_f32 v12, 0x3fb8aa3b, v184
v_exp_f32 v12, v12
s_nop 0
v_cvt_pk_bf16_f32 v12, v12, v12
v_and_b32 v12, 0xffff0000, v12
v_mul_f32 v12, v12, v8
v_mul_f32 v12, 0xbfb8aa3b, v12
v_mul_f32 v13, v185, v8
v_mul_f32 v13, 0x3e22f983, v13
v_mul_f32 v14, v186, v9
v_mul_f32 v15, v187, v9
v_exp_f32 v16, v12
v_fract_f32 v17, v13
v_cos_f32 v18, v17
v_sin_f32 v19, v17
v_mul_f32 v18, v18, v16
v_mul_f32 v19, v19, v16
v_mul_f32 v16, 0x41000000, v12
v_mul_f32 v17, 0x41000000, v13
v_exp_f32 v16, v16
v_fract_f32 v17, v17
v_cos_f32 v20, v17
v_sin_f32 v21, v17
v_mul_f32 v20, v20, v16
v_mul_f32 v21, v21, v16
v_mul_f32 v16, 0x43800000, v12
v_mul_f32 v17, 0x43800000, v13
v_exp_f32 v16, v16
v_fract_f32 v17, v17
v_cos_f32 v22, v17
v_sin_f32 v23, v17
v_mul_f32 v22, v22, v16
v_mul_f32 v23, v23, v16
v_pk_mul_f32 v[24:25], v[18:19], v[18:19] op_sel:[0,0] op_sel_hi:[1,0]
s_nop 0
v_pk_fma_f32 v[24:25], v[18:19], v[18:19], v[24:25] op_sel:[1,1,0] op_sel_hi:[0,1,1] neg_lo:[1,0,0]
s_nop 0
v_pk_mul_f32 v[26:27], v[24:25], v[24:25] op_sel:[0,0] op_sel_hi:[1,0]
s_nop 0
v_pk_fma_f32 v[26:27], v[24:25], v[24:25], v[26:27] op_sel:[1,1,0] op_sel_hi:[0,1,1] neg_lo:[1,0,0]
v_pk_mul_f32 v[28:29], v[20:21], v[20:21] op_sel:[0,0] op_sel_hi:[1,0]
s_nop 0
v_pk_fma_f32 v[28:29], v[20:21], v[20:21], v[28:29] op_sel:[1,1,0] op_sel_hi:[0,1,1] neg_lo:[1,0,0]
v_pk_mul_f32 v[30:31], v[22:23], v[22:23] op_sel:[0,0] op_sel_hi:[1,0]
s_nop 0
v_pk_fma_f32 v[30:31], v[22:23], v[22:23], v[30:31] op_sel:[1,1,0] op_sel_hi:[0,1,1] neg_lo:[1,0,0]
s_nop 0
v_pk_mul_f32 v[32:33], v[30:31], v[30:31] op_sel:[0,0] op_sel_hi:[1,0]
s_nop 0
v_pk_fma_f32 v[32:33], v[30:31], v[30:31], v[32:33] op_sel:[1,1,0] op_sel_hi:[0,1,1] neg_lo:[1,0,0]
v_mov_b32 v34, 1.0
v_mov_b32 v35, 0
v_cvt_pk_bf16_f32 v70, v34, v35
ds_write_addtid_b32 v70 offset:7616
v_cvt_pk_bf16_f32 v71, v20, v21
ds_write_addtid_b32 v71 offset:7888
v_pk_mul_f32 v[36:37], v[20:21], v[28:29] op_sel:[0,0] op_sel_hi:[1,0]
s_nop 0
v_pk_fma_f32 v[36:37], v[20:21], v[28:29], v[36:37] op_sel:[1,1,0] op_sel_hi:[0,1,1] neg_lo:[1,0,0]
v_mov_b32 v34, v28
v_mov_b32 v35, v29
v_cvt_pk_bf16_f32 v72, v34, v35
ds_write_addtid_b32 v72 offset:8160
v_cvt_pk_bf16_f32 v73, v36, v37
ds_write_addtid_b32 v73 offset:8432
v_cvt_pk_bf16_f32 v60, v14, -v15
ds_write_addtid_b32 v60 offset:0
v_pk_mul_f32 v[42:43], v[14:15], v[18:19] op_sel:[0,0] op_sel_hi:[1,0]
s_nop 0
v_pk_fma_f32 v[42:43], v[14:15], v[18:19], v[42:43] op_sel:[1,1,0] op_sel_hi:[0,1,1] neg_lo:[1,0,0]
s_nop 0
v_cvt_pk_bf16_f32 v61, v42, -v43
ds_write_addtid_b32 v61 offset:272
v_pk_mul_f32 v[44:45], v[14:15], v[24:25] op_sel:[0,0] op_sel_hi:[1,0]
s_nop 0
v_pk_fma_f32 v[44:45], v[14:15], v[24:25], v[44:45] op_sel:[1,1,0] op_sel_hi:[0,1,1] neg_lo:[1,0,0]
s_nop 0
v_cvt_pk_bf16_f32 v62, v44, -v45
ds_write_addtid_b32 v62 offset:544
v_pk_mul_f32 v[46:47], v[42:43], v[24:25] op_sel:[0,0] op_sel_hi:[1,0]
s_nop 0
v_pk_fma_f32 v[46:47], v[42:43], v[24:25], v[46:47] op_sel:[1,1,0] op_sel_hi:[0,1,1] neg_lo:[1,0,0]
s_nop 0
v_cvt_pk_bf16_f32 v63, v46, -v47
ds_write_addtid_b32 v63 offset:816
v_pk_mul_f32 v[48:49], v[44:45], v[24:25] op_sel:[0,0] op_sel_hi:[1,0]
s_nop 0
v_pk_fma_f32 v[48:49], v[44:45], v[24:25], v[48:49] op_sel:[1,1,0] op_sel_hi:[0,1,1] neg_lo:[1,0,0]
s_nop 0
v_cvt_pk_bf16_f32 v60, v48, -v49
ds_write_addtid_b32 v60 offset:2176
v_pk_mul_f32 v[38:39], v[34:35], v[28:29] op_sel:[0,0] op_sel_hi:[1,0]
s_nop 0
v_pk_fma_f32 v[38:39], v[34:35], v[28:29], v[38:39] op_sel:[1,1,0] op_sel_hi:[0,1,1] neg_lo:[1,0,0]
v_pk_mul_f32 v[40:41], v[36:37], v[28:29] op_sel:[0,0] op_sel_hi:[1,0]
s_nop 0
v_pk_fma_f32 v[40:41], v[36:37], v[28:29], v[40:41] op_sel:[1,1,0] op_sel_hi:[0,1,1] neg_lo:[1,0,0]
v_cvt_pk_bf16_f32 v74, v38, v39
ds_write_addtid_b32 v74 offset:8704
v_cvt_pk_bf16_f32 v75, v40, v41
ds_write_addtid_b32 v75 offset:8976
v_pk_mul_f32 v[34:35], v[38:39], v[28:29] op_sel:[0,0] op_sel_hi:[1,0]
s_nop 0
v_pk_fma_f32 v[34:35], v[38:39], v[28:29], v[34:35] op_sel:[1,1,0] op_sel_hi:[0,1,1] neg_lo:[1,0,0]
v_pk_mul_f32 v[36:37], v[40:41], v[28:29] op_sel:[0,0] op_sel_hi:[1,0]
s_nop 0
v_pk_fma_f32 v[36:37], v[40:41], v[28:29], v[36:37] op_sel:[1,1,0] op_sel_hi:[0,1,1] neg_lo:[1,0,0]
v_cvt_pk_bf16_f32 v76, v34, v35
ds_write_addtid_b32 v76 offset:9248
v_cvt_pk_bf16_f32 v77, v36, v37
ds_write_addtid_b32 v77 offset:9520
v_pk_mul_f32 v[42:43], v[46:47], v[24:25] op_sel:[0,0] op_sel_hi:[1,0]
s_nop 0
v_pk_fma_f32 v[42:43], v[46:47], v[24:25], v[42:43] op_sel:[1,1,0] op_sel_hi:[0,1,1] neg_lo:[1,0,0]
s_nop 0
v_cvt_pk_bf16_f32 v61, v42, -v43
ds_write_addtid_b32 v61 offset:2448
v_pk_mul_f32 v[44:45], v[48:49], v[24:25] op_sel:[0,0] op_sel_hi:[1,0]
s_nop 0
v_pk_fma_f32 v[44:45], v[48:49], v[24:25], v[44:45] op_sel:[1,1,0] op_sel_hi:[0,1,1] neg_lo:[1,0,0]
s_nop 0
v_cvt_pk_bf16_f32 v62, v44, -v45
ds_write_addtid_b32 v62 offset:2720
v_pk_mul_f32 v[46:47], v[42:43], v[24:25] op_sel:[0,0] op_sel_hi:[1,0]
s_nop 0
v_pk_fma_f32 v[46:47], v[42:43], v[24:25], v[46:47] op_sel:[1,1,0] op_sel_hi:[0,1,1] neg_lo:[1,0,0]
s_nop 0
v_cvt_pk_bf16_f32 v63, v46, -v47
ds_write_addtid_b32 v63 offset:2992
v_pk_mul_f32 v[38:39], v[34:35], v[28:29] op_sel:[0,0] op_sel_hi:[1,0]
s_nop 0
v_pk_fma_f32 v[38:39], v[34:35], v[28:29], v[38:39] op_sel:[1,1,0] op_sel_hi:[0,1,1] neg_lo:[1,0,0]
v_pk_mul_f32 v[40:41], v[36:37], v[28:29] op_sel:[0,0] op_sel_hi:[1,0]
s_nop 0
v_pk_fma_f32 v[40:41], v[36:37], v[28:29], v[40:41] op_sel:[1,1,0] op_sel_hi:[0,1,1] neg_lo:[1,0,0]
v_cvt_pk_bf16_f32 v70, v38, v39
ds_write_addtid_b32 v70 offset:9792
v_cvt_pk_bf16_f32 v71, v40, v41
ds_write_addtid_b32 v71 offset:10064
v_pk_mul_f32 v[34:35], v[38:39], v[28:29] op_sel:[0,0] op_sel_hi:[1,0]
s_nop 0
v_pk_fma_f32 v[34:35], v[38:39], v[28:29], v[34:35] op_sel:[1,1,0] op_sel_hi:[0,1,1] neg_lo:[1,0,0]
v_pk_mul_f32 v[36:37], v[40:41], v[28:29] op_sel:[0,0] op_sel_hi:[1,0]
s_nop 0
v_pk_fma_f32 v[36:37], v[40:41], v[28:29], v[36:37] op_sel:[1,1,0] op_sel_hi:[0,1,1] neg_lo:[1,0,0]
v_cvt_pk_bf16_f32 v72, v34, v35
ds_write_addtid_b32 v72 offset:10336
v_cvt_pk_bf16_f32 v73, v36, v37
ds_write_addtid_b32 v73 offset:10608
v_pk_mul_f32 v[50:51], v[14:15], v[22:23] op_sel:[0,0] op_sel_hi:[1,0]
s_nop 0
v_pk_fma_f32 v[50:51], v[14:15], v[22:23], v[50:51] op_sel:[1,1,0] op_sel_hi:[0,1,1] neg_lo:[1,0,0]
s_nop 0
v_cvt_pk_bf16_f32 v60, v50, -v51
ds_write_addtid_b32 v60 offset:4352
v_pk_mul_f32 v[52:53], v[14:15], v[30:31] op_sel:[0,0] op_sel_hi:[1,0]
s_nop 0
v_pk_fma_f32 v[52:53], v[14:15], v[30:31], v[52:53] op_sel:[1,1,0] op_sel_hi:[0,1,1] neg_lo:[1,0,0]
s_nop 0
v_cvt_pk_bf16_f32 v61, v52, -v53
ds_write_addtid_b32 v61 offset:6800
v_pk_mul_f32 v[56:57], v[14:15], v[32:33] op_sel:[0,0] op_sel_hi:[1,0]
s_nop 0
v_pk_fma_f32 v[56:57], v[14:15], v[32:33], v[56:57] op_sel:[1,1,0] op_sel_hi:[0,1,1] neg_lo:[1,0,0]
s_nop 0
v_cvt_pk_bf16_f32 v64, v56, -v57
ds_write_addtid_b32 v64 offset:3264
v_pk_mul_f32 v[42:43], v[50:51], v[24:25] op_sel:[0,0] op_sel_hi:[1,0]
s_nop 0
v_pk_fma_f32 v[42:43], v[50:51], v[24:25], v[42:43] op_sel:[1,1,0] op_sel_hi:[0,1,1] neg_lo:[1,0,0]
s_nop 0
v_cvt_pk_bf16_f32 v61, v42, -v43
ds_write_addtid_b32 v61 offset:4624
v_pk_mul_f32 v[54:55], v[52:53], v[22:23] op_sel:[0,0] op_sel_hi:[1,0]
s_nop 0
v_pk_fma_f32 v[54:55], v[52:53], v[22:23], v[54:55] op_sel:[1,1,0] op_sel_hi:[0,1,1] neg_lo:[1,0,0]
s_nop 0
v_cvt_pk_bf16_f32 v64, v54, -v55
ds_write_addtid_b32 v64 offset:1088
v_pk_mul_f32 v[38:39], v[34:35], v[28:29] op_sel:[0,0] op_sel_hi:[1,0]
s_nop 0
v_pk_fma_f32 v[38:39], v[34:35], v[28:29], v[38:39] op_sel:[1,1,0] op_sel_hi:[0,1,1] neg_lo:[1,0,0]
v_pk_mul_f32 v[40:41], v[36:37], v[28:29] op_sel:[0,0] op_sel_hi:[1,0]
s_nop 0
v_pk_fma_f32 v[40:41], v[36:37], v[28:29], v[40:41] op_sel:[1,1,0] op_sel_hi:[0,1,1] neg_lo:[1,0,0]
v_cvt_pk_bf16_f32 v74, v38, v39
ds_write_addtid_b32 v74 offset:10880
v_cvt_pk_bf16_f32 v75, v40, v41
ds_write_addtid_b32 v75 offset:11152
v_pk_mul_f32 v[34:35], v[38:39], v[28:29] op_sel:[0,0] op_sel_hi:[1,0]
s_nop 0
v_pk_fma_f32 v[34:35], v[38:39], v[28:29], v[34:35] op_sel:[1,1,0] op_sel_hi:[0,1,1] neg_lo:[1,0,0]
v_pk_mul_f32 v[36:37], v[40:41], v[28:29] op_sel:[0,0] op_sel_hi:[1,0]
s_nop 0
v_pk_fma_f32 v[36:37], v[40:41], v[28:29], v[36:37] op_sel:[1,1,0] op_sel_hi:[0,1,1] neg_lo:[1,0,0]
v_cvt_pk_bf16_f32 v76, v34, v35
ds_write_addtid_b32 v76 offset:11424
v_cvt_pk_bf16_f32 v77, v36, v37
ds_write_addtid_b32 v77 offset:11696
v_pk_mul_f32 v[44:45], v[42:43], v[24:25] op_sel:[0,0] op_sel_hi:[1,0]
s_nop 0
v_pk_fma_f32 v[44:45], v[42:43], v[24:25], v[44:45] op_sel:[1,1,0] op_sel_hi:[0,1,1] neg_lo:[1,0,0]
s_nop 0
v_cvt_pk_bf16_f32 v62, v44, -v45
ds_write_addtid_b32 v62 offset:4896
v_pk_mul_f32 v[46:47], v[52:53], v[26:27] op_sel:[0,0] op_sel_hi:[1,0]
s_nop 0
v_pk_fma_f32 v[46:47], v[52:53], v[26:27], v[46:47] op_sel:[1,1,0] op_sel_hi:[0,1,1] neg_lo:[1,0,0]
s_nop 0
v_cvt_pk_bf16_f32 v62, v46, -v47
ds_write_addtid_b32 v62 offset:7072
v_pk_mul_f32 v[48:49], v[54:55], v[26:27] op_sel:[0,0] op_sel_hi:[1,0]
s_nop 0
v_pk_fma_f32 v[48:49], v[54:55], v[26:27], v[48:49] op_sel:[1,1,0] op_sel_hi:[0,1,1] neg_lo:[1,0,0]
s_nop 0
v_cvt_pk_bf16_f32 v65, v48, -v49
ds_write_addtid_b32 v65 offset:1360
v_pk_mul_f32 v[42:43], v[44:45], v[24:25] op_sel:[0,0] op_sel_hi:[1,0]
s_nop 0
v_pk_fma_f32 v[42:43], v[44:45], v[24:25], v[42:43] op_sel:[1,1,0] op_sel_hi:[0,1,1] neg_lo:[1,0,0]
s_nop 0
v_cvt_pk_bf16_f32 v63, v42, -v43
ds_write_addtid_b32 v63 offset:5168
v_pk_mul_f32 v[38:39], v[34:35], v[28:29] op_sel:[0,0] op_sel_hi:[1,0]
s_nop 0
v_pk_fma_f32 v[38:39], v[34:35], v[28:29], v[38:39] op_sel:[1,1,0] op_sel_hi:[0,1,1] neg_lo:[1,0,0]
v_pk_mul_f32 v[40:41], v[36:37], v[28:29] op_sel:[0,0] op_sel_hi:[1,0]
s_nop 0
v_pk_fma_f32 v[40:41], v[36:37], v[28:29], v[40:41] op_sel:[1,1,0] op_sel_hi:[0,1,1] neg_lo:[1,0,0]
v_cvt_pk_bf16_f32 v70, v38, v39
ds_write_addtid_b32 v70 offset:11968
v_cvt_pk_bf16_f32 v71, v40, v41
ds_write_addtid_b32 v71 offset:12240
v_pk_mul_f32 v[34:35], v[38:39], v[28:29] op_sel:[0,0] op_sel_hi:[1,0]
s_nop 0
v_pk_fma_f32 v[34:35], v[38:39], v[28:29], v[34:35] op_sel:[1,1,0] op_sel_hi:[0,1,1] neg_lo:[1,0,0]
v_pk_mul_f32 v[36:37], v[40:41], v[28:29] op_sel:[0,0] op_sel_hi:[1,0]
s_nop 0
v_pk_fma_f32 v[36:37], v[40:41], v[28:29], v[36:37] op_sel:[1,1,0] op_sel_hi:[0,1,1] neg_lo:[1,0,0]
v_cvt_pk_bf16_f32 v72, v34, v35
ds_write_addtid_b32 v72 offset:12512
v_cvt_pk_bf16_f32 v73, v36, v37
ds_write_addtid_b32 v73 offset:12784
v_pk_mul_f32 v[44:45], v[46:47], v[26:27] op_sel:[0,0] op_sel_hi:[1,0]
s_nop 0
v_pk_fma_f32 v[44:45], v[46:47], v[26:27], v[44:45] op_sel:[1,1,0] op_sel_hi:[0,1,1] neg_lo:[1,0,0]
s_nop 0
v_cvt_pk_bf16_f32 v63, v44, -v45
ds_write_addtid_b32 v63 offset:7344
v_pk_mul_f32 v[46:47], v[48:49], v[26:27] op_sel:[0,0] op_sel_hi:[1,0]
s_nop 0
v_pk_fma_f32 v[46:47], v[48:49], v[26:27], v[46:47] op_sel:[1,1,0] op_sel_hi:[0,1,1] neg_lo:[1,0,0]
s_nop 0
v_cvt_pk_bf16_f32 v66, v46, -v47
ds_write_addtid_b32 v66 offset:1632
v_pk_mul_f32 v[48:49], v[42:43], v[24:25] op_sel:[0,0] op_sel_hi:[1,0]
s_nop 0
v_pk_fma_f32 v[48:49], v[42:43], v[24:25], v[48:49] op_sel:[1,1,0] op_sel_hi:[0,1,1] neg_lo:[1,0,0]
s_nop 0
v_cvt_pk_bf16_f32 v60, v48, -v49
ds_write_addtid_b32 v60 offset:6528
v_pk_mul_f32 v[38:39], v[34:35], v[28:29] op_sel:[0,0] op_sel_hi:[1,0]
s_nop 0
v_pk_fma_f32 v[38:39], v[34:35], v[28:29], v[38:39] op_sel:[1,1,0] op_sel_hi:[0,1,1] neg_lo:[1,0,0]
v_pk_mul_f32 v[40:41], v[36:37], v[28:29] op_sel:[0,0] op_sel_hi:[1,0]
s_nop 0
v_pk_fma_f32 v[40:41], v[36:37], v[28:29], v[40:41] op_sel:[1,1,0] op_sel_hi:[0,1,1] neg_lo:[1,0,0]
v_cvt_pk_bf16_f32 v74, v38, v39
ds_write_addtid_b32 v74 offset:13056
v_cvt_pk_bf16_f32 v75, v40, v41
ds_write_addtid_b32 v75 offset:13328
v_pk_mul_f32 v[34:35], v[38:39], v[28:29] op_sel:[0,0] op_sel_hi:[1,0]
s_nop 0
v_pk_fma_f32 v[34:35], v[38:39], v[28:29], v[34:35] op_sel:[1,1,0] op_sel_hi:[0,1,1] neg_lo:[1,0,0]
v_pk_mul_f32 v[36:37], v[40:41], v[28:29] op_sel:[0,0] op_sel_hi:[1,0]
s_nop 0
v_pk_fma_f32 v[36:37], v[40:41], v[28:29], v[36:37] op_sel:[1,1,0] op_sel_hi:[0,1,1] neg_lo:[1,0,0]
v_cvt_pk_bf16_f32 v76, v34, v35
ds_write_addtid_b32 v76 offset:13600
v_cvt_pk_bf16_f32 v77, v36, v37
ds_write_addtid_b32 v77 offset:13872
v_pk_mul_f32 v[42:43], v[56:57], v[20:21] op_sel:[0,0] op_sel_hi:[1,0]
s_nop 0
v_pk_fma_f32 v[42:43], v[56:57], v[20:21], v[42:43] op_sel:[1,1,0] op_sel_hi:[0,1,1] neg_lo:[1,0,0]
s_nop 0
v_cvt_pk_bf16_f32 v65, v42, -v43
ds_write_addtid_b32 v65 offset:3536
v_pk_mul_f32 v[50:51], v[56:57], v[22:23] op_sel:[0,0] op_sel_hi:[1,0]
s_nop 0
v_pk_fma_f32 v[50:51], v[56:57], v[22:23], v[50:51] op_sel:[1,1,0] op_sel_hi:[0,1,1] neg_lo:[1,0,0]
s_nop 0
v_cvt_pk_bf16_f32 v66, v50, -v51
ds_write_addtid_b32 v66 offset:3808
v_pk_mul_f32 v[52:53], v[56:57], v[30:31] op_sel:[0,0] op_sel_hi:[1,0]
s_nop 0
v_pk_fma_f32 v[52:53], v[56:57], v[30:31], v[52:53] op_sel:[1,1,0] op_sel_hi:[0,1,1] neg_lo:[1,0,0]
s_nop 0
v_cvt_pk_bf16_f32 v64, v52, -v53
ds_write_addtid_b32 v64 offset:5440
v_pk_mul_f32 v[38:39], v[34:35], v[28:29] op_sel:[0,0] op_sel_hi:[1,0]
s_nop 0
v_pk_fma_f32 v[38:39], v[34:35], v[28:29], v[38:39] op_sel:[1,1,0] op_sel_hi:[0,1,1] neg_lo:[1,0,0]
v_pk_mul_f32 v[40:41], v[36:37], v[28:29] op_sel:[0,0] op_sel_hi:[1,0]
s_nop 0
v_pk_fma_f32 v[40:41], v[36:37], v[28:29], v[40:41] op_sel:[1,1,0] op_sel_hi:[0,1,1] neg_lo:[1,0,0]
v_cvt_pk_bf16_f32 v70, v38, v39
ds_write_addtid_b32 v70 offset:14144
v_cvt_pk_bf16_f32 v71, v40, v41
ds_write_addtid_b32 v71 offset:14416
v_pk_mul_f32 v[34:35], v[38:39], v[28:29] op_sel:[0,0] op_sel_hi:[1,0]
s_nop 0
v_pk_fma_f32 v[34:35], v[38:39], v[28:29], v[34:35] op_sel:[1,1,0] op_sel_hi:[0,1,1] neg_lo:[1,0,0]
v_pk_mul_f32 v[36:37], v[40:41], v[28:29] op_sel:[0,0] op_sel_hi:[1,0]
s_nop 0
v_pk_fma_f32 v[36:37], v[40:41], v[28:29], v[36:37] op_sel:[1,1,0] op_sel_hi:[0,1,1] neg_lo:[1,0,0]
v_cvt_pk_bf16_f32 v72, v34, v35
ds_write_addtid_b32 v72 offset:14688
v_cvt_pk_bf16_f32 v73, v36, v37
ds_write_addtid_b32 v73 offset:14960
v_pk_mul_f32 v[42:43], v[50:51], v[20:21] op_sel:[0,0] op_sel_hi:[1,0]
s_nop 0
v_pk_fma_f32 v[42:43], v[50:51], v[20:21], v[42:43] op_sel:[1,1,0] op_sel_hi:[0,1,1] neg_lo:[1,0,0]
s_nop 0
v_cvt_pk_bf16_f32 v67, v42, -v43
ds_write_addtid_b32 v67 offset:4080
v_pk_mul_f32 v[44:45], v[52:53], v[20:21] op_sel:[0,0] op_sel_hi:[1,0]
s_nop 0
v_pk_fma_f32 v[44:45], v[52:53], v[20:21], v[44:45] op_sel:[1,1,0] op_sel_hi:[0,1,1] neg_lo:[1,0,0]
s_nop 0
v_cvt_pk_bf16_f32 v65, v44, -v45
ds_write_addtid_b32 v65 offset:5712
v_pk_mul_f32 v[54:55], v[52:53], v[22:23] op_sel:[0,0] op_sel_hi:[1,0]
s_nop 0
v_pk_fma_f32 v[54:55], v[52:53], v[22:23], v[54:55] op_sel:[1,1,0] op_sel_hi:[0,1,1] neg_lo:[1,0,0]
s_nop 0
v_cvt_pk_bf16_f32 v66, v54, -v55
ds_write_addtid_b32 v66 offset:5984
v_pk_mul_f32 v[38:39], v[34:35], v[28:29] op_sel:[0,0] op_sel_hi:[1,0]
s_nop 0
v_pk_fma_f32 v[38:39], v[34:35], v[28:29], v[38:39] op_sel:[1,1,0] op_sel_hi:[0,1,1] neg_lo:[1,0,0]
v_pk_mul_f32 v[40:41], v[36:37], v[28:29] op_sel:[0,0] op_sel_hi:[1,0]
s_nop 0
v_pk_fma_f32 v[40:41], v[36:37], v[28:29], v[40:41] op_sel:[1,1,0] op_sel_hi:[0,1,1] neg_lo:[1,0,0]
v_cvt_pk_bf16_f32 v74, v38, v39
ds_write_addtid_b32 v74 offset:15232
v_cvt_pk_bf16_f32 v75, v40, v41
ds_write_addtid_b32 v75 offset:15504
v_pk_mul_f32 v[34:35], v[38:39], v[28:29] op_sel:[0,0] op_sel_hi:[1,0]
s_nop 0
v_pk_fma_f32 v[34:35], v[38:39], v[28:29], v[34:35] op_sel:[1,1,0] op_sel_hi:[0,1,1] neg_lo:[1,0,0]
v_pk_mul_f32 v[36:37], v[40:41], v[28:29] op_sel:[0,0] op_sel_hi:[1,0]
s_nop 0
v_pk_fma_f32 v[36:37], v[40:41], v[28:29], v[36:37] op_sel:[1,1,0] op_sel_hi:[0,1,1] neg_lo:[1,0,0]
v_cvt_pk_bf16_f32 v76, v34, v35
ds_write_addtid_b32 v76 offset:15776
v_cvt_pk_bf16_f32 v77, v36, v37
ds_write_addtid_b32 v77 offset:16048
v_pk_mul_f32 v[42:43], v[54:55], v[20:21] op_sel:[0,0] op_sel_hi:[1,0]
s_nop 0
v_pk_fma_f32 v[42:43], v[54:55], v[20:21], v[42:43] op_sel:[1,1,0] op_sel_hi:[0,1,1] neg_lo:[1,0,0]
s_nop 0
v_cvt_pk_bf16_f32 v67, v42, -v43
ds_write_addtid_b32 v67 offset:6256
ds_read_b128 v[64:67], v10 offset:0
ds_read_b128 v[68:71], v10 offset:7616
ds_read_b128 v[72:75], v10 offset:32
ds_read_b128 v[76:79], v10 offset:7648
ds_read_b128 v[80:83], v10 offset:64
ds_read_b128 v[84:87], v10 offset:7680
ds_read_b128 v[88:91], v10 offset:96
ds_read_b128 v[92:95], v10 offset:7712
ds_read_b128 v[96:99], v10 offset:128
ds_read_b128 v[100:103], v10 offset:7744
ds_read_b128 v[104:107], v10 offset:160
ds_read_b128 v[108:111], v10 offset:7776
ds_read_b128 v[112:115], v10 offset:192
ds_read_b128 v[116:119], v10 offset:7808
ds_read_b128 v[120:123], v10 offset:224
ds_read_b128 v[124:127], v10 offset:7840
v_lshlrev_b32 v5, 4, v1
s_mul_i32 s3, s31, 3072
v_add_u32 v5, s3, v5
s_mov_b32 s12, s4
s_mov_b32 s13, s5
s_mov_b32 s14, 1966080
s_mov_b32 s15, 0x00020000
s_mov_b32 s16, s6
s_mov_b32 s17, s7
s_mov_b32 s18, 1966080
s_mov_b32 s19, 0x00020000
s_mov_b32 s68, s10
s_mov_b32 s69, s11
s_mov_b32 s70, 1966080
s_mov_b32 s71, 0x00020000
buffer_load_dwordx4 v[200:203], v5, s[12:15], 0 offen offset:0
buffer_load_dwordx4 v[212:215], v5, s[16:19], 0 offen offset:0
buffer_load_dwordx4 v[224:227], v5, s[68:71], 0 offen offset:0
buffer_load_dwordx4 v[204:207], v5, s[12:15], 0 offen offset:1024
buffer_load_dwordx4 v[216:219], v5, s[16:19], 0 offen offset:1024
buffer_load_dwordx4 v[228:231], v5, s[68:71], 0 offen offset:1024
buffer_load_dwordx4 v[208:211], v5, s[12:15], 0 offen offset:2048
buffer_load_dwordx4 v[220:223], v5, s[16:19], 0 offen offset:2048
buffer_load_dwordx4 v[232:235], v5, s[68:71], 0 offen offset:2048
v_lshlrev_b32 v188, 16, v188
v_lshlrev_b32 v189, 16, v189
v_lshlrev_b32 v190, 16, v190
v_lshlrev_b32 v191, 16, v191
v_mul_f32 v12, 0x3fb8aa3b, v188
v_exp_f32 v12, v12
s_nop 0
v_cvt_pk_bf16_f32 v12, v12, v12
v_and_b32 v12, 0xffff0000, v12
s_waitcnt lgkmcnt(14)
v_mfma_f32_32x32x16_bf16 v[128:143], v[64:67], v[68:71], 0
v_mul_f32 v12, v12, v8
v_mul_f32 v12, 0xbfb8aa3b, v12
v_mul_f32 v13, v189, v8
v_mul_f32 v13, 0x3e22f983, v13
s_waitcnt lgkmcnt(12)
v_mfma_f32_32x32x16_bf16 v[128:143], v[72:75], v[76:79], v[128:143]
v_mul_f32 v14, v190, v9
v_mul_f32 v15, v191, v9
v_exp_f32 v16, v12
v_fract_f32 v17, v13
s_waitcnt lgkmcnt(10)
v_mfma_f32_32x32x16_bf16 v[128:143], v[80:83], v[84:87], v[128:143]
v_cos_f32 v18, v17
v_sin_f32 v19, v17
v_mul_f32 v18, v18, v16
v_mul_f32 v19, v19, v16
s_waitcnt lgkmcnt(8)
v_mfma_f32_32x32x16_bf16 v[128:143], v[88:91], v[92:95], v[128:143]
v_mul_f32 v16, 0x41000000, v12
v_mul_f32 v17, 0x41000000, v13
v_exp_f32 v16, v16
v_fract_f32 v17, v17
s_waitcnt lgkmcnt(6)
v_mfma_f32_32x32x16_bf16 v[128:143], v[96:99], v[100:103], v[128:143]
v_cos_f32 v20, v17
v_sin_f32 v21, v17
v_mul_f32 v20, v20, v16
v_mul_f32 v21, v21, v16
s_waitcnt lgkmcnt(4)
v_mfma_f32_32x32x16_bf16 v[128:143], v[104:107], v[108:111], v[128:143]
v_mul_f32 v16, 0x43800000, v12
v_mul_f32 v17, 0x43800000, v13
v_exp_f32 v16, v16
v_fract_f32 v17, v17
s_waitcnt lgkmcnt(2)
v_mfma_f32_32x32x16_bf16 v[128:143], v[112:115], v[116:119], v[128:143]
v_cos_f32 v22, v17
v_sin_f32 v23, v17
v_mul_f32 v22, v22, v16
v_mul_f32 v23, v23, v16
s_waitcnt lgkmcnt(0)
v_mfma_f32_32x32x16_bf16 v[128:143], v[120:123], v[124:127], v[128:143]
v_pk_mul_f32 v[24:25], v[18:19], v[18:19] op_sel:[0,0] op_sel_hi:[1,0]
s_nop 0
v_pk_fma_f32 v[24:25], v[18:19], v[18:19], v[24:25] op_sel:[1,1,0] op_sel_hi:[0,1,1] neg_lo:[1,0,0]
s_nop 0
v_pk_mul_f32 v[26:27], v[24:25], v[24:25] op_sel:[0,0] op_sel_hi:[1,0]
s_nop 0
v_pk_fma_f32 v[26:27], v[24:25], v[24:25], v[26:27] op_sel:[1,1,0] op_sel_hi:[0,1,1] neg_lo:[1,0,0]
v_pk_mul_f32 v[28:29], v[20:21], v[20:21] op_sel:[0,0] op_sel_hi:[1,0]
s_nop 0
v_pk_fma_f32 v[28:29], v[20:21], v[20:21], v[28:29] op_sel:[1,1,0] op_sel_hi:[0,1,1] neg_lo:[1,0,0]
v_pk_mul_f32 v[30:31], v[22:23], v[22:23] op_sel:[0,0] op_sel_hi:[1,0]
s_nop 0
v_pk_fma_f32 v[30:31], v[22:23], v[22:23], v[30:31] op_sel:[1,1,0] op_sel_hi:[0,1,1] neg_lo:[1,0,0]
s_nop 0
v_pk_mul_f32 v[32:33], v[30:31], v[30:31] op_sel:[0,0] op_sel_hi:[1,0]
s_nop 0
v_pk_fma_f32 v[32:33], v[30:31], v[30:31], v[32:33] op_sel:[1,1,0] op_sel_hi:[0,1,1] neg_lo:[1,0,0]
v_mov_b32 v34, 1.0
v_mov_b32 v35, 0
v_cvt_pk_bf16_f32 v70, v34, v35
ds_write_addtid_b32 v70 offset:7616
v_cvt_pk_bf16_f32 v71, v20, v21
ds_write_addtid_b32 v71 offset:7888
v_pk_mul_f32 v[36:37], v[20:21], v[28:29] op_sel:[0,0] op_sel_hi:[1,0]
s_nop 0
v_pk_fma_f32 v[36:37], v[20:21], v[28:29], v[36:37] op_sel:[1,1,0] op_sel_hi:[0,1,1] neg_lo:[1,0,0]
v_mov_b32 v34, v28
v_mov_b32 v35, v29
v_cvt_pk_bf16_f32 v72, v34, v35
ds_write_addtid_b32 v72 offset:8160
v_cvt_pk_bf16_f32 v73, v36, v37
ds_write_addtid_b32 v73 offset:8432
v_cvt_pk_bf16_f32 v60, v14, -v15
ds_write_addtid_b32 v60 offset:0
v_pk_mul_f32 v[42:43], v[14:15], v[18:19] op_sel:[0,0] op_sel_hi:[1,0]
s_nop 0
v_pk_fma_f32 v[42:43], v[14:15], v[18:19], v[42:43] op_sel:[1,1,0] op_sel_hi:[0,1,1] neg_lo:[1,0,0]
s_nop 0
v_cvt_pk_bf16_f32 v61, v42, -v43
ds_write_addtid_b32 v61 offset:272
v_pk_mul_f32 v[44:45], v[14:15], v[24:25] op_sel:[0,0] op_sel_hi:[1,0]
s_nop 0
v_pk_fma_f32 v[44:45], v[14:15], v[24:25], v[44:45] op_sel:[1,1,0] op_sel_hi:[0,1,1] neg_lo:[1,0,0]
s_nop 0
v_cvt_pk_bf16_f32 v62, v44, -v45
ds_write_addtid_b32 v62 offset:544
v_pk_mul_f32 v[46:47], v[42:43], v[24:25] op_sel:[0,0] op_sel_hi:[1,0]
s_nop 0
v_pk_fma_f32 v[46:47], v[42:43], v[24:25], v[46:47] op_sel:[1,1,0] op_sel_hi:[0,1,1] neg_lo:[1,0,0]
s_nop 0
v_cvt_pk_bf16_f32 v63, v46, -v47
ds_write_addtid_b32 v63 offset:816
v_pk_mul_f32 v[48:49], v[44:45], v[24:25] op_sel:[0,0] op_sel_hi:[1,0]
s_nop 0
v_pk_fma_f32 v[48:49], v[44:45], v[24:25], v[48:49] op_sel:[1,1,0] op_sel_hi:[0,1,1] neg_lo:[1,0,0]
s_nop 0
v_cvt_pk_bf16_f32 v60, v48, -v49
ds_write_addtid_b32 v60 offset:2176
v_pk_mul_f32 v[38:39], v[34:35], v[28:29] op_sel:[0,0] op_sel_hi:[1,0]
s_nop 0
v_pk_fma_f32 v[38:39], v[34:35], v[28:29], v[38:39] op_sel:[1,1,0] op_sel_hi:[0,1,1] neg_lo:[1,0,0]
v_pk_mul_f32 v[40:41], v[36:37], v[28:29] op_sel:[0,0] op_sel_hi:[1,0]
s_nop 0
v_pk_fma_f32 v[40:41], v[36:37], v[28:29], v[40:41] op_sel:[1,1,0] op_sel_hi:[0,1,1] neg_lo:[1,0,0]
v_cvt_pk_bf16_f32 v74, v38, v39
ds_write_addtid_b32 v74 offset:8704
v_cvt_pk_bf16_f32 v75, v40, v41
ds_write_addtid_b32 v75 offset:8976
v_pk_mul_f32 v[34:35], v[38:39], v[28:29] op_sel:[0,0] op_sel_hi:[1,0]
s_nop 0
v_pk_fma_f32 v[34:35], v[38:39], v[28:29], v[34:35] op_sel:[1,1,0] op_sel_hi:[0,1,1] neg_lo:[1,0,0]
v_pk_mul_f32 v[36:37], v[40:41], v[28:29] op_sel:[0,0] op_sel_hi:[1,0]
s_nop 0
v_pk_fma_f32 v[36:37], v[40:41], v[28:29], v[36:37] op_sel:[1,1,0] op_sel_hi:[0,1,1] neg_lo:[1,0,0]
v_cvt_pk_bf16_f32 v76, v34, v35
ds_write_addtid_b32 v76 offset:9248
v_cvt_pk_bf16_f32 v77, v36, v37
ds_write_addtid_b32 v77 offset:9520
v_pk_mul_f32 v[42:43], v[46:47], v[24:25] op_sel:[0,0] op_sel_hi:[1,0]
s_nop 0
v_pk_fma_f32 v[42:43], v[46:47], v[24:25], v[42:43] op_sel:[1,1,0] op_sel_hi:[0,1,1] neg_lo:[1,0,0]
s_nop 0
v_cvt_pk_bf16_f32 v61, v42, -v43
ds_write_addtid_b32 v61 offset:2448
v_pk_mul_f32 v[44:45], v[48:49], v[24:25] op_sel:[0,0] op_sel_hi:[1,0]
s_nop 0
v_pk_fma_f32 v[44:45], v[48:49], v[24:25], v[44:45] op_sel:[1,1,0] op_sel_hi:[0,1,1] neg_lo:[1,0,0]
s_nop 0
v_cvt_pk_bf16_f32 v62, v44, -v45
ds_write_addtid_b32 v62 offset:2720
v_pk_mul_f32 v[46:47], v[42:43], v[24:25] op_sel:[0,0] op_sel_hi:[1,0]
s_nop 0
v_pk_fma_f32 v[46:47], v[42:43], v[24:25], v[46:47] op_sel:[1,1,0] op_sel_hi:[0,1,1] neg_lo:[1,0,0]
s_nop 0
v_cvt_pk_bf16_f32 v63, v46, -v47
ds_write_addtid_b32 v63 offset:2992
v_pk_mul_f32 v[38:39], v[34:35], v[28:29] op_sel:[0,0] op_sel_hi:[1,0]
s_nop 0
v_pk_fma_f32 v[38:39], v[34:35], v[28:29], v[38:39] op_sel:[1,1,0] op_sel_hi:[0,1,1] neg_lo:[1,0,0]
v_pk_mul_f32 v[40:41], v[36:37], v[28:29] op_sel:[0,0] op_sel_hi:[1,0]
s_nop 0
v_pk_fma_f32 v[40:41], v[36:37], v[28:29], v[40:41] op_sel:[1,1,0] op_sel_hi:[0,1,1] neg_lo:[1,0,0]
v_cvt_pk_bf16_f32 v70, v38, v39
ds_write_addtid_b32 v70 offset:9792
v_cvt_pk_bf16_f32 v71, v40, v41
ds_write_addtid_b32 v71 offset:10064
v_pk_mul_f32 v[34:35], v[38:39], v[28:29] op_sel:[0,0] op_sel_hi:[1,0]
s_nop 0
v_pk_fma_f32 v[34:35], v[38:39], v[28:29], v[34:35] op_sel:[1,1,0] op_sel_hi:[0,1,1] neg_lo:[1,0,0]
v_pk_mul_f32 v[36:37], v[40:41], v[28:29] op_sel:[0,0] op_sel_hi:[1,0]
s_nop 0
v_pk_fma_f32 v[36:37], v[40:41], v[28:29], v[36:37] op_sel:[1,1,0] op_sel_hi:[0,1,1] neg_lo:[1,0,0]
v_cvt_pk_bf16_f32 v72, v34, v35
ds_write_addtid_b32 v72 offset:10336
v_cvt_pk_bf16_f32 v73, v36, v37
ds_write_addtid_b32 v73 offset:10608
v_pk_mul_f32 v[50:51], v[14:15], v[22:23] op_sel:[0,0] op_sel_hi:[1,0]
s_nop 0
v_pk_fma_f32 v[50:51], v[14:15], v[22:23], v[50:51] op_sel:[1,1,0] op_sel_hi:[0,1,1] neg_lo:[1,0,0]
s_nop 0
v_cvt_pk_bf16_f32 v60, v50, -v51
ds_write_addtid_b32 v60 offset:4352
v_pk_mul_f32 v[52:53], v[14:15], v[30:31] op_sel:[0,0] op_sel_hi:[1,0]
s_nop 0
v_pk_fma_f32 v[52:53], v[14:15], v[30:31], v[52:53] op_sel:[1,1,0] op_sel_hi:[0,1,1] neg_lo:[1,0,0]
s_nop 0
v_cvt_pk_bf16_f32 v61, v52, -v53
ds_write_addtid_b32 v61 offset:6800
v_pk_mul_f32 v[56:57], v[14:15], v[32:33] op_sel:[0,0] op_sel_hi:[1,0]
s_nop 0
v_pk_fma_f32 v[56:57], v[14:15], v[32:33], v[56:57] op_sel:[1,1,0] op_sel_hi:[0,1,1] neg_lo:[1,0,0]
s_nop 0
v_cvt_pk_bf16_f32 v64, v56, -v57
ds_write_addtid_b32 v64 offset:3264
v_pk_mul_f32 v[42:43], v[50:51], v[24:25] op_sel:[0,0] op_sel_hi:[1,0]
s_nop 0
v_pk_fma_f32 v[42:43], v[50:51], v[24:25], v[42:43] op_sel:[1,1,0] op_sel_hi:[0,1,1] neg_lo:[1,0,0]
s_nop 0
v_cvt_pk_bf16_f32 v61, v42, -v43
ds_write_addtid_b32 v61 offset:4624
v_pk_mul_f32 v[54:55], v[52:53], v[22:23] op_sel:[0,0] op_sel_hi:[1,0]
s_nop 0
v_pk_fma_f32 v[54:55], v[52:53], v[22:23], v[54:55] op_sel:[1,1,0] op_sel_hi:[0,1,1] neg_lo:[1,0,0]
s_nop 0
v_cvt_pk_bf16_f32 v64, v54, -v55
ds_write_addtid_b32 v64 offset:1088
v_pk_mul_f32 v[38:39], v[34:35], v[28:29] op_sel:[0,0] op_sel_hi:[1,0]
s_nop 0
v_pk_fma_f32 v[38:39], v[34:35], v[28:29], v[38:39] op_sel:[1,1,0] op_sel_hi:[0,1,1] neg_lo:[1,0,0]
v_pk_mul_f32 v[40:41], v[36:37], v[28:29] op_sel:[0,0] op_sel_hi:[1,0]
s_nop 0
v_pk_fma_f32 v[40:41], v[36:37], v[28:29], v[40:41] op_sel:[1,1,0] op_sel_hi:[0,1,1] neg_lo:[1,0,0]
v_cvt_pk_bf16_f32 v74, v38, v39
ds_write_addtid_b32 v74 offset:10880
v_cvt_pk_bf16_f32 v75, v40, v41
ds_write_addtid_b32 v75 offset:11152
v_pk_mul_f32 v[34:35], v[38:39], v[28:29] op_sel:[0,0] op_sel_hi:[1,0]
s_nop 0
v_pk_fma_f32 v[34:35], v[38:39], v[28:29], v[34:35] op_sel:[1,1,0] op_sel_hi:[0,1,1] neg_lo:[1,0,0]
v_pk_mul_f32 v[36:37], v[40:41], v[28:29] op_sel:[0,0] op_sel_hi:[1,0]
s_nop 0
v_pk_fma_f32 v[36:37], v[40:41], v[28:29], v[36:37] op_sel:[1,1,0] op_sel_hi:[0,1,1] neg_lo:[1,0,0]
v_cvt_pk_bf16_f32 v76, v34, v35
ds_write_addtid_b32 v76 offset:11424
v_cvt_pk_bf16_f32 v77, v36, v37
ds_write_addtid_b32 v77 offset:11696
v_pk_mul_f32 v[44:45], v[42:43], v[24:25] op_sel:[0,0] op_sel_hi:[1,0]
s_nop 0
v_pk_fma_f32 v[44:45], v[42:43], v[24:25], v[44:45] op_sel:[1,1,0] op_sel_hi:[0,1,1] neg_lo:[1,0,0]
s_nop 0
v_cvt_pk_bf16_f32 v62, v44, -v45
ds_write_addtid_b32 v62 offset:4896
v_pk_mul_f32 v[46:47], v[52:53], v[26:27] op_sel:[0,0] op_sel_hi:[1,0]
s_nop 0
v_pk_fma_f32 v[46:47], v[52:53], v[26:27], v[46:47] op_sel:[1,1,0] op_sel_hi:[0,1,1] neg_lo:[1,0,0]
s_nop 0
v_cvt_pk_bf16_f32 v62, v46, -v47
ds_write_addtid_b32 v62 offset:7072
v_pk_mul_f32 v[48:49], v[54:55], v[26:27] op_sel:[0,0] op_sel_hi:[1,0]
s_nop 0
v_pk_fma_f32 v[48:49], v[54:55], v[26:27], v[48:49] op_sel:[1,1,0] op_sel_hi:[0,1,1] neg_lo:[1,0,0]
s_nop 0
v_cvt_pk_bf16_f32 v65, v48, -v49
ds_write_addtid_b32 v65 offset:1360
v_pk_mul_f32 v[42:43], v[44:45], v[24:25] op_sel:[0,0] op_sel_hi:[1,0]
s_nop 0
v_pk_fma_f32 v[42:43], v[44:45], v[24:25], v[42:43] op_sel:[1,1,0] op_sel_hi:[0,1,1] neg_lo:[1,0,0]
s_nop 0
v_cvt_pk_bf16_f32 v63, v42, -v43
ds_write_addtid_b32 v63 offset:5168
v_pk_mul_f32 v[38:39], v[34:35], v[28:29] op_sel:[0,0] op_sel_hi:[1,0]
s_nop 0
v_pk_fma_f32 v[38:39], v[34:35], v[28:29], v[38:39] op_sel:[1,1,0] op_sel_hi:[0,1,1] neg_lo:[1,0,0]
v_pk_mul_f32 v[40:41], v[36:37], v[28:29] op_sel:[0,0] op_sel_hi:[1,0]
s_nop 0
v_pk_fma_f32 v[40:41], v[36:37], v[28:29], v[40:41] op_sel:[1,1,0] op_sel_hi:[0,1,1] neg_lo:[1,0,0]
v_cvt_pk_bf16_f32 v70, v38, v39
ds_write_addtid_b32 v70 offset:11968
v_cvt_pk_bf16_f32 v71, v40, v41
ds_write_addtid_b32 v71 offset:12240
v_pk_mul_f32 v[34:35], v[38:39], v[28:29] op_sel:[0,0] op_sel_hi:[1,0]
s_nop 0
v_pk_fma_f32 v[34:35], v[38:39], v[28:29], v[34:35] op_sel:[1,1,0] op_sel_hi:[0,1,1] neg_lo:[1,0,0]
v_pk_mul_f32 v[36:37], v[40:41], v[28:29] op_sel:[0,0] op_sel_hi:[1,0]
s_nop 0
v_pk_fma_f32 v[36:37], v[40:41], v[28:29], v[36:37] op_sel:[1,1,0] op_sel_hi:[0,1,1] neg_lo:[1,0,0]
v_cvt_pk_bf16_f32 v72, v34, v35
ds_write_addtid_b32 v72 offset:12512
v_cvt_pk_bf16_f32 v73, v36, v37
ds_write_addtid_b32 v73 offset:12784
v_pk_mul_f32 v[44:45], v[46:47], v[26:27] op_sel:[0,0] op_sel_hi:[1,0]
s_nop 0
v_pk_fma_f32 v[44:45], v[46:47], v[26:27], v[44:45] op_sel:[1,1,0] op_sel_hi:[0,1,1] neg_lo:[1,0,0]
s_nop 0
v_cvt_pk_bf16_f32 v63, v44, -v45
ds_write_addtid_b32 v63 offset:7344
v_pk_mul_f32 v[46:47], v[48:49], v[26:27] op_sel:[0,0] op_sel_hi:[1,0]
s_nop 0
v_pk_fma_f32 v[46:47], v[48:49], v[26:27], v[46:47] op_sel:[1,1,0] op_sel_hi:[0,1,1] neg_lo:[1,0,0]
s_nop 0
v_cvt_pk_bf16_f32 v66, v46, -v47
ds_write_addtid_b32 v66 offset:1632
v_pk_mul_f32 v[48:49], v[42:43], v[24:25] op_sel:[0,0] op_sel_hi:[1,0]
s_nop 0
v_pk_fma_f32 v[48:49], v[42:43], v[24:25], v[48:49] op_sel:[1,1,0] op_sel_hi:[0,1,1] neg_lo:[1,0,0]
s_nop 0
v_cvt_pk_bf16_f32 v60, v48, -v49
ds_write_addtid_b32 v60 offset:6528
v_pk_mul_f32 v[38:39], v[34:35], v[28:29] op_sel:[0,0] op_sel_hi:[1,0]
s_nop 0
v_pk_fma_f32 v[38:39], v[34:35], v[28:29], v[38:39] op_sel:[1,1,0] op_sel_hi:[0,1,1] neg_lo:[1,0,0]
v_pk_mul_f32 v[40:41], v[36:37], v[28:29] op_sel:[0,0] op_sel_hi:[1,0]
s_nop 0
v_pk_fma_f32 v[40:41], v[36:37], v[28:29], v[40:41] op_sel:[1,1,0] op_sel_hi:[0,1,1] neg_lo:[1,0,0]
v_cvt_pk_bf16_f32 v74, v38, v39
ds_write_addtid_b32 v74 offset:13056
v_cvt_pk_bf16_f32 v75, v40, v41
ds_write_addtid_b32 v75 offset:13328
v_pk_mul_f32 v[34:35], v[38:39], v[28:29] op_sel:[0,0] op_sel_hi:[1,0]
s_nop 0
v_pk_fma_f32 v[34:35], v[38:39], v[28:29], v[34:35] op_sel:[1,1,0] op_sel_hi:[0,1,1] neg_lo:[1,0,0]
v_pk_mul_f32 v[36:37], v[40:41], v[28:29] op_sel:[0,0] op_sel_hi:[1,0]
s_nop 0
v_pk_fma_f32 v[36:37], v[40:41], v[28:29], v[36:37] op_sel:[1,1,0] op_sel_hi:[0,1,1] neg_lo:[1,0,0]
v_cvt_pk_bf16_f32 v76, v34, v35
ds_write_addtid_b32 v76 offset:13600
v_cvt_pk_bf16_f32 v77, v36, v37
ds_write_addtid_b32 v77 offset:13872
v_pk_mul_f32 v[42:43], v[56:57], v[20:21] op_sel:[0,0] op_sel_hi:[1,0]
s_nop 0
v_pk_fma_f32 v[42:43], v[56:57], v[20:21], v[42:43] op_sel:[1,1,0] op_sel_hi:[0,1,1] neg_lo:[1,0,0]
s_nop 0
v_cvt_pk_bf16_f32 v65, v42, -v43
ds_write_addtid_b32 v65 offset:3536
v_pk_mul_f32 v[50:51], v[56:57], v[22:23] op_sel:[0,0] op_sel_hi:[1,0]
s_nop 0
v_pk_fma_f32 v[50:51], v[56:57], v[22:23], v[50:51] op_sel:[1,1,0] op_sel_hi:[0,1,1] neg_lo:[1,0,0]
s_nop 0
v_cvt_pk_bf16_f32 v66, v50, -v51
ds_write_addtid_b32 v66 offset:3808
v_pk_mul_f32 v[52:53], v[56:57], v[30:31] op_sel:[0,0] op_sel_hi:[1,0]
s_nop 0
v_pk_fma_f32 v[52:53], v[56:57], v[30:31], v[52:53] op_sel:[1,1,0] op_sel_hi:[0,1,1] neg_lo:[1,0,0]
s_nop 0
v_cvt_pk_bf16_f32 v64, v52, -v53
ds_write_addtid_b32 v64 offset:5440
v_pk_mul_f32 v[38:39], v[34:35], v[28:29] op_sel:[0,0] op_sel_hi:[1,0]
s_nop 0
v_pk_fma_f32 v[38:39], v[34:35], v[28:29], v[38:39] op_sel:[1,1,0] op_sel_hi:[0,1,1] neg_lo:[1,0,0]
v_pk_mul_f32 v[40:41], v[36:37], v[28:29] op_sel:[0,0] op_sel_hi:[1,0]
s_nop 0
v_pk_fma_f32 v[40:41], v[36:37], v[28:29], v[40:41] op_sel:[1,1,0] op_sel_hi:[0,1,1] neg_lo:[1,0,0]
v_cvt_pk_bf16_f32 v70, v38, v39
ds_write_addtid_b32 v70 offset:14144
v_cvt_pk_bf16_f32 v71, v40, v41
ds_write_addtid_b32 v71 offset:14416
v_pk_mul_f32 v[34:35], v[38:39], v[28:29] op_sel:[0,0] op_sel_hi:[1,0]
s_nop 0
v_pk_fma_f32 v[34:35], v[38:39], v[28:29], v[34:35] op_sel:[1,1,0] op_sel_hi:[0,1,1] neg_lo:[1,0,0]
v_pk_mul_f32 v[36:37], v[40:41], v[28:29] op_sel:[0,0] op_sel_hi:[1,0]
s_nop 0
v_pk_fma_f32 v[36:37], v[40:41], v[28:29], v[36:37] op_sel:[1,1,0] op_sel_hi:[0,1,1] neg_lo:[1,0,0]
v_cvt_pk_bf16_f32 v72, v34, v35
ds_write_addtid_b32 v72 offset:14688
v_cvt_pk_bf16_f32 v73, v36, v37
ds_write_addtid_b32 v73 offset:14960
v_pk_mul_f32 v[42:43], v[50:51], v[20:21] op_sel:[0,0] op_sel_hi:[1,0]
s_nop 0
v_pk_fma_f32 v[42:43], v[50:51], v[20:21], v[42:43] op_sel:[1,1,0] op_sel_hi:[0,1,1] neg_lo:[1,0,0]
s_nop 0
v_cvt_pk_bf16_f32 v67, v42, -v43
ds_write_addtid_b32 v67 offset:4080
v_pk_mul_f32 v[44:45], v[52:53], v[20:21] op_sel:[0,0] op_sel_hi:[1,0]
s_nop 0
v_pk_fma_f32 v[44:45], v[52:53], v[20:21], v[44:45] op_sel:[1,1,0] op_sel_hi:[0,1,1] neg_lo:[1,0,0]
s_nop 0
v_cvt_pk_bf16_f32 v65, v44, -v45
ds_write_addtid_b32 v65 offset:5712
v_pk_mul_f32 v[54:55], v[52:53], v[22:23] op_sel:[0,0] op_sel_hi:[1,0]
s_nop 0
v_pk_fma_f32 v[54:55], v[52:53], v[22:23], v[54:55] op_sel:[1,1,0] op_sel_hi:[0,1,1] neg_lo:[1,0,0]
s_nop 0
v_cvt_pk_bf16_f32 v66, v54, -v55
ds_write_addtid_b32 v66 offset:5984
v_pk_mul_f32 v[38:39], v[34:35], v[28:29] op_sel:[0,0] op_sel_hi:[1,0]
s_nop 0
v_pk_fma_f32 v[38:39], v[34:35], v[28:29], v[38:39] op_sel:[1,1,0] op_sel_hi:[0,1,1] neg_lo:[1,0,0]
v_pk_mul_f32 v[40:41], v[36:37], v[28:29] op_sel:[0,0] op_sel_hi:[1,0]
s_nop 0
v_pk_fma_f32 v[40:41], v[36:37], v[28:29], v[40:41] op_sel:[1,1,0] op_sel_hi:[0,1,1] neg_lo:[1,0,0]
v_cvt_pk_bf16_f32 v74, v38, v39
ds_write_addtid_b32 v74 offset:15232
v_cvt_pk_bf16_f32 v75, v40, v41
ds_write_addtid_b32 v75 offset:15504
v_pk_mul_f32 v[34:35], v[38:39], v[28:29] op_sel:[0,0] op_sel_hi:[1,0]
s_nop 0
v_pk_fma_f32 v[34:35], v[38:39], v[28:29], v[34:35] op_sel:[1,1,0] op_sel_hi:[0,1,1] neg_lo:[1,0,0]
v_pk_mul_f32 v[36:37], v[40:41], v[28:29] op_sel:[0,0] op_sel_hi:[1,0]
s_nop 0
v_pk_fma_f32 v[36:37], v[40:41], v[28:29], v[36:37] op_sel:[1,1,0] op_sel_hi:[0,1,1] neg_lo:[1,0,0]
v_cvt_pk_bf16_f32 v76, v34, v35
ds_write_addtid_b32 v76 offset:15776
v_cvt_pk_bf16_f32 v77, v36, v37
ds_write_addtid_b32 v77 offset:16048
v_pk_mul_f32 v[42:43], v[54:55], v[20:21] op_sel:[0,0] op_sel_hi:[1,0]
s_nop 0
v_pk_fma_f32 v[42:43], v[54:55], v[20:21], v[42:43] op_sel:[1,1,0] op_sel_hi:[0,1,1] neg_lo:[1,0,0]
s_nop 0
v_cvt_pk_bf16_f32 v67, v42, -v43
ds_write_addtid_b32 v67 offset:6256
ds_read_b128 v[64:67], v10 offset:0
ds_read_b128 v[68:71], v10 offset:7616
ds_read_b128 v[72:75], v10 offset:32
ds_read_b128 v[76:79], v10 offset:7648
ds_read_b128 v[80:83], v10 offset:64
ds_read_b128 v[84:87], v10 offset:7680
ds_read_b128 v[88:91], v10 offset:96
ds_read_b128 v[92:95], v10 offset:7712
ds_read_b128 v[96:99], v10 offset:128
ds_read_b128 v[100:103], v10 offset:7744
ds_read_b128 v[104:107], v10 offset:160
ds_read_b128 v[108:111], v10 offset:7776
ds_read_b128 v[112:115], v10 offset:192
ds_read_b128 v[116:119], v10 offset:7808
ds_read_b128 v[120:123], v10 offset:224
ds_read_b128 v[124:127], v10 offset:7840
v_lshlrev_b32 v192, 16, v192
v_lshlrev_b32 v193, 16, v193
v_lshlrev_b32 v194, 16, v194
v_lshlrev_b32 v195, 16, v195
v_mul_f32 v12, 0x3fb8aa3b, v192
v_exp_f32 v12, v12
s_nop 0
v_cvt_pk_bf16_f32 v12, v12, v12
v_and_b32 v12, 0xffff0000, v12
s_waitcnt lgkmcnt(14)
v_mfma_f32_32x32x16_bf16 v[128:143], v[64:67], v[68:71], v[128:143]
v_mul_f32 v12, v12, v8
v_mul_f32 v12, 0xbfb8aa3b, v12
v_mul_f32 v13, v193, v8
v_mul_f32 v13, 0x3e22f983, v13
s_waitcnt lgkmcnt(12)
v_mfma_f32_32x32x16_bf16 v[128:143], v[72:75], v[76:79], v[128:143]
v_mul_f32 v14, v194, v9
v_mul_f32 v15, v195, v9
v_exp_f32 v16, v12
v_fract_f32 v17, v13
s_waitcnt lgkmcnt(10)
v_mfma_f32_32x32x16_bf16 v[128:143], v[80:83], v[84:87], v[128:143]
v_cos_f32 v18, v17
v_sin_f32 v19, v17
v_mul_f32 v18, v18, v16
v_mul_f32 v19, v19, v16
s_waitcnt lgkmcnt(8)
v_mfma_f32_32x32x16_bf16 v[128:143], v[88:91], v[92:95], v[128:143]
v_mul_f32 v16, 0x41000000, v12
v_mul_f32 v17, 0x41000000, v13
v_exp_f32 v16, v16
v_fract_f32 v17, v17
s_waitcnt lgkmcnt(6)
v_mfma_f32_32x32x16_bf16 v[128:143], v[96:99], v[100:103], v[128:143]
v_cos_f32 v20, v17
v_sin_f32 v21, v17
v_mul_f32 v20, v20, v16
v_mul_f32 v21, v21, v16
s_waitcnt lgkmcnt(4)
v_mfma_f32_32x32x16_bf16 v[128:143], v[104:107], v[108:111], v[128:143]
v_mul_f32 v16, 0x43800000, v12
v_mul_f32 v17, 0x43800000, v13
v_exp_f32 v16, v16
v_fract_f32 v17, v17
s_waitcnt lgkmcnt(2)
v_mfma_f32_32x32x16_bf16 v[128:143], v[112:115], v[116:119], v[128:143]
v_cos_f32 v22, v17
v_sin_f32 v23, v17
v_mul_f32 v22, v22, v16
v_mul_f32 v23, v23, v16
s_waitcnt lgkmcnt(0)
v_mfma_f32_32x32x16_bf16 v[128:143], v[120:123], v[124:127], v[128:143]
v_pk_mul_f32 v[24:25], v[18:19], v[18:19] op_sel:[0,0] op_sel_hi:[1,0]
s_nop 0
v_pk_fma_f32 v[24:25], v[18:19], v[18:19], v[24:25] op_sel:[1,1,0] op_sel_hi:[0,1,1] neg_lo:[1,0,0]
s_nop 0
v_pk_mul_f32 v[26:27], v[24:25], v[24:25] op_sel:[0,0] op_sel_hi:[1,0]
s_nop 0
v_pk_fma_f32 v[26:27], v[24:25], v[24:25], v[26:27] op_sel:[1,1,0] op_sel_hi:[0,1,1] neg_lo:[1,0,0]
v_pk_mul_f32 v[28:29], v[20:21], v[20:21] op_sel:[0,0] op_sel_hi:[1,0]
s_nop 0
v_pk_fma_f32 v[28:29], v[20:21], v[20:21], v[28:29] op_sel:[1,1,0] op_sel_hi:[0,1,1] neg_lo:[1,0,0]
v_pk_mul_f32 v[30:31], v[22:23], v[22:23] op_sel:[0,0] op_sel_hi:[1,0]
s_nop 0
v_pk_fma_f32 v[30:31], v[22:23], v[22:23], v[30:31] op_sel:[1,1,0] op_sel_hi:[0,1,1] neg_lo:[1,0,0]
s_nop 0
v_pk_mul_f32 v[32:33], v[30:31], v[30:31] op_sel:[0,0] op_sel_hi:[1,0]
s_nop 0
v_pk_fma_f32 v[32:33], v[30:31], v[30:31], v[32:33] op_sel:[1,1,0] op_sel_hi:[0,1,1] neg_lo:[1,0,0]
v_mov_b32 v34, 1.0
v_mov_b32 v35, 0
v_cvt_pk_bf16_f32 v70, v34, v35
ds_write_addtid_b32 v70 offset:7616
v_cvt_pk_bf16_f32 v71, v20, v21
ds_write_addtid_b32 v71 offset:7888
v_pk_mul_f32 v[36:37], v[20:21], v[28:29] op_sel:[0,0] op_sel_hi:[1,0]
s_nop 0
v_pk_fma_f32 v[36:37], v[20:21], v[28:29], v[36:37] op_sel:[1,1,0] op_sel_hi:[0,1,1] neg_lo:[1,0,0]
v_mov_b32 v34, v28
v_mov_b32 v35, v29
v_cvt_pk_bf16_f32 v72, v34, v35
ds_write_addtid_b32 v72 offset:8160
v_cvt_pk_bf16_f32 v73, v36, v37
ds_write_addtid_b32 v73 offset:8432
v_cvt_pk_bf16_f32 v60, v14, -v15
ds_write_addtid_b32 v60 offset:0
v_pk_mul_f32 v[42:43], v[14:15], v[18:19] op_sel:[0,0] op_sel_hi:[1,0]
s_nop 0
v_pk_fma_f32 v[42:43], v[14:15], v[18:19], v[42:43] op_sel:[1,1,0] op_sel_hi:[0,1,1] neg_lo:[1,0,0]
s_nop 0
v_cvt_pk_bf16_f32 v61, v42, -v43
ds_write_addtid_b32 v61 offset:272
v_pk_mul_f32 v[44:45], v[14:15], v[24:25] op_sel:[0,0] op_sel_hi:[1,0]
s_nop 0
v_pk_fma_f32 v[44:45], v[14:15], v[24:25], v[44:45] op_sel:[1,1,0] op_sel_hi:[0,1,1] neg_lo:[1,0,0]
s_nop 0
v_cvt_pk_bf16_f32 v62, v44, -v45
ds_write_addtid_b32 v62 offset:544
v_pk_mul_f32 v[46:47], v[42:43], v[24:25] op_sel:[0,0] op_sel_hi:[1,0]
s_nop 0
v_pk_fma_f32 v[46:47], v[42:43], v[24:25], v[46:47] op_sel:[1,1,0] op_sel_hi:[0,1,1] neg_lo:[1,0,0]
s_nop 0
v_cvt_pk_bf16_f32 v63, v46, -v47
ds_write_addtid_b32 v63 offset:816
v_pk_mul_f32 v[48:49], v[44:45], v[24:25] op_sel:[0,0] op_sel_hi:[1,0]
s_nop 0
v_pk_fma_f32 v[48:49], v[44:45], v[24:25], v[48:49] op_sel:[1,1,0] op_sel_hi:[0,1,1] neg_lo:[1,0,0]
s_nop 0
v_cvt_pk_bf16_f32 v60, v48, -v49
ds_write_addtid_b32 v60 offset:2176
v_pk_mul_f32 v[38:39], v[34:35], v[28:29] op_sel:[0,0] op_sel_hi:[1,0]
s_nop 0
v_pk_fma_f32 v[38:39], v[34:35], v[28:29], v[38:39] op_sel:[1,1,0] op_sel_hi:[0,1,1] neg_lo:[1,0,0]
v_pk_mul_f32 v[40:41], v[36:37], v[28:29] op_sel:[0,0] op_sel_hi:[1,0]
s_nop 0
v_pk_fma_f32 v[40:41], v[36:37], v[28:29], v[40:41] op_sel:[1,1,0] op_sel_hi:[0,1,1] neg_lo:[1,0,0]
v_cvt_pk_bf16_f32 v74, v38, v39
ds_write_addtid_b32 v74 offset:8704
v_cvt_pk_bf16_f32 v75, v40, v41
ds_write_addtid_b32 v75 offset:8976
v_pk_mul_f32 v[34:35], v[38:39], v[28:29] op_sel:[0,0] op_sel_hi:[1,0]
s_nop 0
v_pk_fma_f32 v[34:35], v[38:39], v[28:29], v[34:35] op_sel:[1,1,0] op_sel_hi:[0,1,1] neg_lo:[1,0,0]
v_pk_mul_f32 v[36:37], v[40:41], v[28:29] op_sel:[0,0] op_sel_hi:[1,0]
s_nop 0
v_pk_fma_f32 v[36:37], v[40:41], v[28:29], v[36:37] op_sel:[1,1,0] op_sel_hi:[0,1,1] neg_lo:[1,0,0]
v_cvt_pk_bf16_f32 v76, v34, v35
ds_write_addtid_b32 v76 offset:9248
v_cvt_pk_bf16_f32 v77, v36, v37
ds_write_addtid_b32 v77 offset:9520
v_pk_mul_f32 v[42:43], v[46:47], v[24:25] op_sel:[0,0] op_sel_hi:[1,0]
s_nop 0
v_pk_fma_f32 v[42:43], v[46:47], v[24:25], v[42:43] op_sel:[1,1,0] op_sel_hi:[0,1,1] neg_lo:[1,0,0]
s_nop 0
v_cvt_pk_bf16_f32 v61, v42, -v43
ds_write_addtid_b32 v61 offset:2448
v_pk_mul_f32 v[44:45], v[48:49], v[24:25] op_sel:[0,0] op_sel_hi:[1,0]
s_nop 0
v_pk_fma_f32 v[44:45], v[48:49], v[24:25], v[44:45] op_sel:[1,1,0] op_sel_hi:[0,1,1] neg_lo:[1,0,0]
s_nop 0
v_cvt_pk_bf16_f32 v62, v44, -v45
ds_write_addtid_b32 v62 offset:2720
v_pk_mul_f32 v[46:47], v[42:43], v[24:25] op_sel:[0,0] op_sel_hi:[1,0]
s_nop 0
v_pk_fma_f32 v[46:47], v[42:43], v[24:25], v[46:47] op_sel:[1,1,0] op_sel_hi:[0,1,1] neg_lo:[1,0,0]
s_nop 0
v_cvt_pk_bf16_f32 v63, v46, -v47
ds_write_addtid_b32 v63 offset:2992
v_pk_mul_f32 v[38:39], v[34:35], v[28:29] op_sel:[0,0] op_sel_hi:[1,0]
s_nop 0
v_pk_fma_f32 v[38:39], v[34:35], v[28:29], v[38:39] op_sel:[1,1,0] op_sel_hi:[0,1,1] neg_lo:[1,0,0]
v_pk_mul_f32 v[40:41], v[36:37], v[28:29] op_sel:[0,0] op_sel_hi:[1,0]
s_nop 0
v_pk_fma_f32 v[40:41], v[36:37], v[28:29], v[40:41] op_sel:[1,1,0] op_sel_hi:[0,1,1] neg_lo:[1,0,0]
v_cvt_pk_bf16_f32 v70, v38, v39
ds_write_addtid_b32 v70 offset:9792
v_cvt_pk_bf16_f32 v71, v40, v41
ds_write_addtid_b32 v71 offset:10064
v_pk_mul_f32 v[34:35], v[38:39], v[28:29] op_sel:[0,0] op_sel_hi:[1,0]
s_nop 0
v_pk_fma_f32 v[34:35], v[38:39], v[28:29], v[34:35] op_sel:[1,1,0] op_sel_hi:[0,1,1] neg_lo:[1,0,0]
v_pk_mul_f32 v[36:37], v[40:41], v[28:29] op_sel:[0,0] op_sel_hi:[1,0]
s_nop 0
v_pk_fma_f32 v[36:37], v[40:41], v[28:29], v[36:37] op_sel:[1,1,0] op_sel_hi:[0,1,1] neg_lo:[1,0,0]
v_cvt_pk_bf16_f32 v72, v34, v35
ds_write_addtid_b32 v72 offset:10336
v_cvt_pk_bf16_f32 v73, v36, v37
ds_write_addtid_b32 v73 offset:10608
v_pk_mul_f32 v[50:51], v[14:15], v[22:23] op_sel:[0,0] op_sel_hi:[1,0]
s_nop 0
v_pk_fma_f32 v[50:51], v[14:15], v[22:23], v[50:51] op_sel:[1,1,0] op_sel_hi:[0,1,1] neg_lo:[1,0,0]
s_nop 0
v_cvt_pk_bf16_f32 v60, v50, -v51
ds_write_addtid_b32 v60 offset:4352
v_pk_mul_f32 v[52:53], v[14:15], v[30:31] op_sel:[0,0] op_sel_hi:[1,0]
s_nop 0
v_pk_fma_f32 v[52:53], v[14:15], v[30:31], v[52:53] op_sel:[1,1,0] op_sel_hi:[0,1,1] neg_lo:[1,0,0]
s_nop 0
v_cvt_pk_bf16_f32 v61, v52, -v53
ds_write_addtid_b32 v61 offset:6800
v_pk_mul_f32 v[56:57], v[14:15], v[32:33] op_sel:[0,0] op_sel_hi:[1,0]
s_nop 0
v_pk_fma_f32 v[56:57], v[14:15], v[32:33], v[56:57] op_sel:[1,1,0] op_sel_hi:[0,1,1] neg_lo:[1,0,0]
s_nop 0
v_cvt_pk_bf16_f32 v64, v56, -v57
ds_write_addtid_b32 v64 offset:3264
v_pk_mul_f32 v[42:43], v[50:51], v[24:25] op_sel:[0,0] op_sel_hi:[1,0]
s_nop 0
v_pk_fma_f32 v[42:43], v[50:51], v[24:25], v[42:43] op_sel:[1,1,0] op_sel_hi:[0,1,1] neg_lo:[1,0,0]
s_nop 0
v_cvt_pk_bf16_f32 v61, v42, -v43
ds_write_addtid_b32 v61 offset:4624
v_pk_mul_f32 v[54:55], v[52:53], v[22:23] op_sel:[0,0] op_sel_hi:[1,0]
s_nop 0
v_pk_fma_f32 v[54:55], v[52:53], v[22:23], v[54:55] op_sel:[1,1,0] op_sel_hi:[0,1,1] neg_lo:[1,0,0]
s_nop 0
v_cvt_pk_bf16_f32 v64, v54, -v55
ds_write_addtid_b32 v64 offset:1088
v_pk_mul_f32 v[38:39], v[34:35], v[28:29] op_sel:[0,0] op_sel_hi:[1,0]
s_nop 0
v_pk_fma_f32 v[38:39], v[34:35], v[28:29], v[38:39] op_sel:[1,1,0] op_sel_hi:[0,1,1] neg_lo:[1,0,0]
v_pk_mul_f32 v[40:41], v[36:37], v[28:29] op_sel:[0,0] op_sel_hi:[1,0]
s_nop 0
v_pk_fma_f32 v[40:41], v[36:37], v[28:29], v[40:41] op_sel:[1,1,0] op_sel_hi:[0,1,1] neg_lo:[1,0,0]
v_cvt_pk_bf16_f32 v74, v38, v39
ds_write_addtid_b32 v74 offset:10880
v_cvt_pk_bf16_f32 v75, v40, v41
ds_write_addtid_b32 v75 offset:11152
v_pk_mul_f32 v[34:35], v[38:39], v[28:29] op_sel:[0,0] op_sel_hi:[1,0]
s_nop 0
v_pk_fma_f32 v[34:35], v[38:39], v[28:29], v[34:35] op_sel:[1,1,0] op_sel_hi:[0,1,1] neg_lo:[1,0,0]
v_pk_mul_f32 v[36:37], v[40:41], v[28:29] op_sel:[0,0] op_sel_hi:[1,0]
s_nop 0
v_pk_fma_f32 v[36:37], v[40:41], v[28:29], v[36:37] op_sel:[1,1,0] op_sel_hi:[0,1,1] neg_lo:[1,0,0]
v_cvt_pk_bf16_f32 v76, v34, v35
ds_write_addtid_b32 v76 offset:11424
v_cvt_pk_bf16_f32 v77, v36, v37
ds_write_addtid_b32 v77 offset:11696
v_pk_mul_f32 v[44:45], v[42:43], v[24:25] op_sel:[0,0] op_sel_hi:[1,0]
s_nop 0
v_pk_fma_f32 v[44:45], v[42:43], v[24:25], v[44:45] op_sel:[1,1,0] op_sel_hi:[0,1,1] neg_lo:[1,0,0]
s_nop 0
v_cvt_pk_bf16_f32 v62, v44, -v45
ds_write_addtid_b32 v62 offset:4896
v_pk_mul_f32 v[46:47], v[52:53], v[26:27] op_sel:[0,0] op_sel_hi:[1,0]
s_nop 0
v_pk_fma_f32 v[46:47], v[52:53], v[26:27], v[46:47] op_sel:[1,1,0] op_sel_hi:[0,1,1] neg_lo:[1,0,0]
s_nop 0
v_cvt_pk_bf16_f32 v62, v46, -v47
ds_write_addtid_b32 v62 offset:7072
v_pk_mul_f32 v[48:49], v[54:55], v[26:27] op_sel:[0,0] op_sel_hi:[1,0]
s_nop 0
v_pk_fma_f32 v[48:49], v[54:55], v[26:27], v[48:49] op_sel:[1,1,0] op_sel_hi:[0,1,1] neg_lo:[1,0,0]
s_nop 0
v_cvt_pk_bf16_f32 v65, v48, -v49
ds_write_addtid_b32 v65 offset:1360
v_pk_mul_f32 v[42:43], v[44:45], v[24:25] op_sel:[0,0] op_sel_hi:[1,0]
s_nop 0
v_pk_fma_f32 v[42:43], v[44:45], v[24:25], v[42:43] op_sel:[1,1,0] op_sel_hi:[0,1,1] neg_lo:[1,0,0]
s_nop 0
v_cvt_pk_bf16_f32 v63, v42, -v43
ds_write_addtid_b32 v63 offset:5168
v_pk_mul_f32 v[38:39], v[34:35], v[28:29] op_sel:[0,0] op_sel_hi:[1,0]
s_nop 0
v_pk_fma_f32 v[38:39], v[34:35], v[28:29], v[38:39] op_sel:[1,1,0] op_sel_hi:[0,1,1] neg_lo:[1,0,0]
v_pk_mul_f32 v[40:41], v[36:37], v[28:29] op_sel:[0,0] op_sel_hi:[1,0]
s_nop 0
v_pk_fma_f32 v[40:41], v[36:37], v[28:29], v[40:41] op_sel:[1,1,0] op_sel_hi:[0,1,1] neg_lo:[1,0,0]
v_cvt_pk_bf16_f32 v70, v38, v39
ds_write_addtid_b32 v70 offset:11968
v_cvt_pk_bf16_f32 v71, v40, v41
ds_write_addtid_b32 v71 offset:12240
v_pk_mul_f32 v[34:35], v[38:39], v[28:29] op_sel:[0,0] op_sel_hi:[1,0]
s_nop 0
v_pk_fma_f32 v[34:35], v[38:39], v[28:29], v[34:35] op_sel:[1,1,0] op_sel_hi:[0,1,1] neg_lo:[1,0,0]
v_pk_mul_f32 v[36:37], v[40:41], v[28:29] op_sel:[0,0] op_sel_hi:[1,0]
s_nop 0
v_pk_fma_f32 v[36:37], v[40:41], v[28:29], v[36:37] op_sel:[1,1,0] op_sel_hi:[0,1,1] neg_lo:[1,0,0]
v_cvt_pk_bf16_f32 v72, v34, v35
ds_write_addtid_b32 v72 offset:12512
v_cvt_pk_bf16_f32 v73, v36, v37
ds_write_addtid_b32 v73 offset:12784
v_pk_mul_f32 v[44:45], v[46:47], v[26:27] op_sel:[0,0] op_sel_hi:[1,0]
s_nop 0
v_pk_fma_f32 v[44:45], v[46:47], v[26:27], v[44:45] op_sel:[1,1,0] op_sel_hi:[0,1,1] neg_lo:[1,0,0]
s_nop 0
v_cvt_pk_bf16_f32 v63, v44, -v45
ds_write_addtid_b32 v63 offset:7344
v_pk_mul_f32 v[46:47], v[48:49], v[26:27] op_sel:[0,0] op_sel_hi:[1,0]
s_nop 0
v_pk_fma_f32 v[46:47], v[48:49], v[26:27], v[46:47] op_sel:[1,1,0] op_sel_hi:[0,1,1] neg_lo:[1,0,0]
s_nop 0
v_cvt_pk_bf16_f32 v66, v46, -v47
ds_write_addtid_b32 v66 offset:1632
v_pk_mul_f32 v[48:49], v[42:43], v[24:25] op_sel:[0,0] op_sel_hi:[1,0]
s_nop 0
v_pk_fma_f32 v[48:49], v[42:43], v[24:25], v[48:49] op_sel:[1,1,0] op_sel_hi:[0,1,1] neg_lo:[1,0,0]
s_nop 0
v_cvt_pk_bf16_f32 v60, v48, -v49
ds_write_addtid_b32 v60 offset:6528
v_pk_mul_f32 v[38:39], v[34:35], v[28:29] op_sel:[0,0] op_sel_hi:[1,0]
s_nop 0
v_pk_fma_f32 v[38:39], v[34:35], v[28:29], v[38:39] op_sel:[1,1,0] op_sel_hi:[0,1,1] neg_lo:[1,0,0]
v_pk_mul_f32 v[40:41], v[36:37], v[28:29] op_sel:[0,0] op_sel_hi:[1,0]
s_nop 0
v_pk_fma_f32 v[40:41], v[36:37], v[28:29], v[40:41] op_sel:[1,1,0] op_sel_hi:[0,1,1] neg_lo:[1,0,0]
v_cvt_pk_bf16_f32 v74, v38, v39
ds_write_addtid_b32 v74 offset:13056
v_cvt_pk_bf16_f32 v75, v40, v41
ds_write_addtid_b32 v75 offset:13328
v_pk_mul_f32 v[34:35], v[38:39], v[28:29] op_sel:[0,0] op_sel_hi:[1,0]
s_nop 0
v_pk_fma_f32 v[34:35], v[38:39], v[28:29], v[34:35] op_sel:[1,1,0] op_sel_hi:[0,1,1] neg_lo:[1,0,0]
v_pk_mul_f32 v[36:37], v[40:41], v[28:29] op_sel:[0,0] op_sel_hi:[1,0]
s_nop 0
v_pk_fma_f32 v[36:37], v[40:41], v[28:29], v[36:37] op_sel:[1,1,0] op_sel_hi:[0,1,1] neg_lo:[1,0,0]
v_cvt_pk_bf16_f32 v76, v34, v35
ds_write_addtid_b32 v76 offset:13600
v_cvt_pk_bf16_f32 v77, v36, v37
ds_write_addtid_b32 v77 offset:13872
v_pk_mul_f32 v[42:43], v[56:57], v[20:21] op_sel:[0,0] op_sel_hi:[1,0]
s_nop 0
v_pk_fma_f32 v[42:43], v[56:57], v[20:21], v[42:43] op_sel:[1,1,0] op_sel_hi:[0,1,1] neg_lo:[1,0,0]
s_nop 0
v_cvt_pk_bf16_f32 v65, v42, -v43
ds_write_addtid_b32 v65 offset:3536
v_pk_mul_f32 v[50:51], v[56:57], v[22:23] op_sel:[0,0] op_sel_hi:[1,0]
s_nop 0
v_pk_fma_f32 v[50:51], v[56:57], v[22:23], v[50:51] op_sel:[1,1,0] op_sel_hi:[0,1,1] neg_lo:[1,0,0]
s_nop 0
v_cvt_pk_bf16_f32 v66, v50, -v51
ds_write_addtid_b32 v66 offset:3808
v_pk_mul_f32 v[52:53], v[56:57], v[30:31] op_sel:[0,0] op_sel_hi:[1,0]
s_nop 0
v_pk_fma_f32 v[52:53], v[56:57], v[30:31], v[52:53] op_sel:[1,1,0] op_sel_hi:[0,1,1] neg_lo:[1,0,0]
s_nop 0
v_cvt_pk_bf16_f32 v64, v52, -v53
ds_write_addtid_b32 v64 offset:5440
v_pk_mul_f32 v[38:39], v[34:35], v[28:29] op_sel:[0,0] op_sel_hi:[1,0]
s_nop 0
v_pk_fma_f32 v[38:39], v[34:35], v[28:29], v[38:39] op_sel:[1,1,0] op_sel_hi:[0,1,1] neg_lo:[1,0,0]
v_pk_mul_f32 v[40:41], v[36:37], v[28:29] op_sel:[0,0] op_sel_hi:[1,0]
s_nop 0
v_pk_fma_f32 v[40:41], v[36:37], v[28:29], v[40:41] op_sel:[1,1,0] op_sel_hi:[0,1,1] neg_lo:[1,0,0]
v_cvt_pk_bf16_f32 v70, v38, v39
ds_write_addtid_b32 v70 offset:14144
v_cvt_pk_bf16_f32 v71, v40, v41
ds_write_addtid_b32 v71 offset:14416
v_pk_mul_f32 v[34:35], v[38:39], v[28:29] op_sel:[0,0] op_sel_hi:[1,0]
s_nop 0
v_pk_fma_f32 v[34:35], v[38:39], v[28:29], v[34:35] op_sel:[1,1,0] op_sel_hi:[0,1,1] neg_lo:[1,0,0]
v_pk_mul_f32 v[36:37], v[40:41], v[28:29] op_sel:[0,0] op_sel_hi:[1,0]
s_nop 0
v_pk_fma_f32 v[36:37], v[40:41], v[28:29], v[36:37] op_sel:[1,1,0] op_sel_hi:[0,1,1] neg_lo:[1,0,0]
v_cvt_pk_bf16_f32 v72, v34, v35
ds_write_addtid_b32 v72 offset:14688
v_cvt_pk_bf16_f32 v73, v36, v37
ds_write_addtid_b32 v73 offset:14960
v_pk_mul_f32 v[42:43], v[50:51], v[20:21] op_sel:[0,0] op_sel_hi:[1,0]
s_nop 0
v_pk_fma_f32 v[42:43], v[50:51], v[20:21], v[42:43] op_sel:[1,1,0] op_sel_hi:[0,1,1] neg_lo:[1,0,0]
s_nop 0
v_cvt_pk_bf16_f32 v67, v42, -v43
ds_write_addtid_b32 v67 offset:4080
v_pk_mul_f32 v[44:45], v[52:53], v[20:21] op_sel:[0,0] op_sel_hi:[1,0]
s_nop 0
v_pk_fma_f32 v[44:45], v[52:53], v[20:21], v[44:45] op_sel:[1,1,0] op_sel_hi:[0,1,1] neg_lo:[1,0,0]
s_nop 0
v_cvt_pk_bf16_f32 v65, v44, -v45
ds_write_addtid_b32 v65 offset:5712
v_pk_mul_f32 v[54:55], v[52:53], v[22:23] op_sel:[0,0] op_sel_hi:[1,0]
s_nop 0
v_pk_fma_f32 v[54:55], v[52:53], v[22:23], v[54:55] op_sel:[1,1,0] op_sel_hi:[0,1,1] neg_lo:[1,0,0]
s_nop 0
v_cvt_pk_bf16_f32 v66, v54, -v55
ds_write_addtid_b32 v66 offset:5984
v_pk_mul_f32 v[38:39], v[34:35], v[28:29] op_sel:[0,0] op_sel_hi:[1,0]
s_nop 0
v_pk_fma_f32 v[38:39], v[34:35], v[28:29], v[38:39] op_sel:[1,1,0] op_sel_hi:[0,1,1] neg_lo:[1,0,0]
v_pk_mul_f32 v[40:41], v[36:37], v[28:29] op_sel:[0,0] op_sel_hi:[1,0]
s_nop 0
v_pk_fma_f32 v[40:41], v[36:37], v[28:29], v[40:41] op_sel:[1,1,0] op_sel_hi:[0,1,1] neg_lo:[1,0,0]
v_cvt_pk_bf16_f32 v74, v38, v39
ds_write_addtid_b32 v74 offset:15232
v_cvt_pk_bf16_f32 v75, v40, v41
ds_write_addtid_b32 v75 offset:15504
v_pk_mul_f32 v[34:35], v[38:39], v[28:29] op_sel:[0,0] op_sel_hi:[1,0]
s_nop 0
v_pk_fma_f32 v[34:35], v[38:39], v[28:29], v[34:35] op_sel:[1,1,0] op_sel_hi:[0,1,1] neg_lo:[1,0,0]
v_pk_mul_f32 v[36:37], v[40:41], v[28:29] op_sel:[0,0] op_sel_hi:[1,0]
s_nop 0
v_pk_fma_f32 v[36:37], v[40:41], v[28:29], v[36:37] op_sel:[1,1,0] op_sel_hi:[0,1,1] neg_lo:[1,0,0]
v_cvt_pk_bf16_f32 v76, v34, v35
ds_write_addtid_b32 v76 offset:15776
v_cvt_pk_bf16_f32 v77, v36, v37
ds_write_addtid_b32 v77 offset:16048
v_pk_mul_f32 v[42:43], v[54:55], v[20:21] op_sel:[0,0] op_sel_hi:[1,0]
s_nop 0
v_pk_fma_f32 v[42:43], v[54:55], v[20:21], v[42:43] op_sel:[1,1,0] op_sel_hi:[0,1,1] neg_lo:[1,0,0]
s_nop 0
v_cvt_pk_bf16_f32 v67, v42, -v43
ds_write_addtid_b32 v67 offset:6256
ds_read_b128 v[64:67], v10 offset:0
ds_read_b128 v[68:71], v10 offset:7616
ds_read_b128 v[72:75], v10 offset:32
ds_read_b128 v[76:79], v10 offset:7648
ds_read_b128 v[80:83], v10 offset:64
ds_read_b128 v[84:87], v10 offset:7680
ds_read_b128 v[88:91], v10 offset:96
ds_read_b128 v[92:95], v10 offset:7712
ds_read_b128 v[96:99], v10 offset:128
ds_read_b128 v[100:103], v10 offset:7744
ds_read_b128 v[104:107], v10 offset:160
ds_read_b128 v[108:111], v10 offset:7776
ds_read_b128 v[112:115], v10 offset:192
ds_read_b128 v[116:119], v10 offset:7808
ds_read_b128 v[120:123], v10 offset:224
ds_read_b128 v[124:127], v10 offset:7840
s_waitcnt lgkmcnt(14)
v_mfma_f32_32x32x16_bf16 v[128:143], v[64:67], v[68:71], v[128:143]
s_waitcnt lgkmcnt(12)
v_mfma_f32_32x32x16_bf16 v[128:143], v[72:75], v[76:79], v[128:143]
s_waitcnt lgkmcnt(10)
v_mfma_f32_32x32x16_bf16 v[128:143], v[80:83], v[84:87], v[128:143]
s_waitcnt lgkmcnt(8)
v_mfma_f32_32x32x16_bf16 v[128:143], v[88:91], v[92:95], v[128:143]
s_waitcnt lgkmcnt(6)
v_mfma_f32_32x32x16_bf16 v[128:143], v[96:99], v[100:103], v[128:143]
s_waitcnt lgkmcnt(4)
v_mfma_f32_32x32x16_bf16 v[128:143], v[104:107], v[108:111], v[128:143]
s_waitcnt lgkmcnt(2)
v_mfma_f32_32x32x16_bf16 v[128:143], v[112:115], v[116:119], v[128:143]
s_waitcnt lgkmcnt(0)
v_mfma_f32_32x32x16_bf16 v[128:143], v[120:123], v[124:127], v[128:143]
s_mul_i32 s34, s30, 4352
s_add_u32 s34, s34, 70144
v_and_b32 v10, 31, v1
v_lshlrev_b32 v10, 4, v10
v_add_u32 v10, s34, v10
s_mov_b32 exec_hi, 0
s_nop 5
v_cvt_pk_bf16_f32 v64, v128, v129
v_cvt_pk_bf16_f32 v65, v130, v131
v_cvt_pk_bf16_f32 v66, v132, v133
v_cvt_pk_bf16_f32 v67, v134, v135
ds_write_b128 v10, v[64:67] offset:240
v_cvt_pk_bf16_f32 v68, v136, v136
v_cvt_pk_bf16_f32 v69, v137, v138
v_cvt_pk_bf16_f32 v70, v138, v138
v_cvt_pk_bf16_f32 v71, v139, v140
ds_write_b128 v10, v[68:71] offset:752
v_cvt_pk_bf16_f32 v72, v141, v141
v_cvt_pk_bf16_f32 v73, v141, v142
v_cvt_pk_bf16_f32 v74, v142, v142
v_cvt_pk_bf16_f32 v75, v143, v143
ds_write_b128 v10, v[72:75] offset:1264
s_mov_b32 exec_hi, -1
s_mov_b32 exec_lo, 0
v_cvt_pk_bf16_f32 v76, v128, v128
v_cvt_pk_bf16_f32 v77, v128, v129
v_cvt_pk_bf16_f32 v78, v129, v129
v_cvt_pk_bf16_f32 v79, v130, v130
ds_write_b128 v10, v[76:79] offset:1776
v_and_b32 v11, 1, v1
v_cmp_eq_u32 vcc, 0, v11
s_nop 1
v_cndmask_b32 v12, v133, v132, vcc
v_cvt_pk_bf16_f32 v80, v132, v132
v_cvt_pk_bf16_f32 v81, v132, v132
v_cvt_pk_bf16_f32 v82, v12, v133
v_cvt_pk_bf16_f32 v83, v133, v133
ds_write_b128 v10, v[80:83] offset:2288
v_cndmask_b32 v12, v135, v134, vcc
v_cvt_pk_bf16_f32 v84, v134, v134
v_cvt_pk_bf16_f32 v85, v134, v134
v_cvt_pk_bf16_f32 v86, v12, v135
v_cvt_pk_bf16_f32 v87, v135, v135
ds_write_b128 v10, v[84:87] offset:2800
v_cndmask_b32 v12, v137, v136, vcc
v_cvt_pk_bf16_f32 v88, v136, v136
v_cvt_pk_bf16_f32 v89, v136, v136
v_cvt_pk_bf16_f32 v90, v12, v137
v_cvt_pk_bf16_f32 v91, v137, v137
ds_write_b128 v10, v[88:91] offset:3312
v_cndmask_b32 v12, v139, v138, vcc
v_cvt_pk_bf16_f32 v92, v138, v138
v_cvt_pk_bf16_f32 v93, v138, v138
v_cvt_pk_bf16_f32 v94, v12, v139
v_cvt_pk_bf16_f32 v95, v139, v139
ds_write_b128 v10, v[92:95] offset:3824
s_mov_b32 exec_lo, -1
s_waitcnt lgkmcnt(0)
v_lshlrev_b32 v11, 4, v1
v_add_u32 v12, s34, v11
s_lshl_b32 s3, s31, 12
s_add_u32 s3, s3, 13631488
ds_read_b128 v[64:67], v12 offset:240
ds_read_b128 v[68:71], v12 offset:1264
ds_read_b128 v[72:75], v12 offset:2288
ds_read_b128 v[76:79], v12 offset:3312
s_waitcnt lgkmcnt(3)
buffer_store_dwordx4 v[64:67], v11, s[20:23], s3 offen offset:0 sc0 sc1
s_waitcnt lgkmcnt(2)
buffer_store_dwordx4 v[68:71], v11, s[20:23], s3 offen offset:1024 sc0 sc1
s_waitcnt lgkmcnt(1)
buffer_store_dwordx4 v[72:75], v11, s[20:23], s3 offen offset:2048 sc0 sc1
s_waitcnt lgkmcnt(0)
buffer_store_dwordx4 v[76:79], v11, s[20:23], s3 offen offset:3072 sc0 sc1
KA_FIN:
s_waitcnt vmcnt(0)
KA_END:
s_endpgm
KA_CPF:
s_getpc_b64 s[4:5]
KA_PC:
s_add_u32 s4, s4, kb_kernel-KA_PC
s_addc_u32 s5, s5, 0
v_lshlrev_b32 v1, 4, v0
v_mov_b32 v3, s5
v_add_co_u32 v2, vcc, s4, v1
s_nop 1
v_addc_co_u32 v3, vcc, 0, v3, vcc
s_mov_b32 s6, ALL_END-kb_kernel-16
v_add_u32 v4, 0, v1
v_cmp_ge_u32 vcc, s6, v4
s_and_b64 exec, exec, vcc
s_cbranch_execz KA_CPF_D
global_load_dwordx4 v[8:11], v[2:3], off
v_add_co_u32 v2, vcc, 0x1000, v2
s_nop 1
v_addc_co_u32 v3, vcc, 0, v3, vcc
v_add_u32 v4, 4096, v1
v_cmp_ge_u32 vcc, s6, v4
s_and_b64 exec, exec, vcc
s_cbranch_execz KA_CPF_D
global_load_dwordx4 v[12:15], v[2:3], off
v_add_co_u32 v2, vcc, 0x1000, v2
s_nop 1
v_addc_co_u32 v3, vcc, 0, v3, vcc
v_add_u32 v4, 8192, v1
v_cmp_ge_u32 vcc, s6, v4
s_and_b64 exec, exec, vcc
s_cbranch_execz KA_CPF_D
global_load_dwordx4 v[16:19], v[2:3], off
v_add_co_u32 v2, vcc, 0x1000, v2
s_nop 1
v_addc_co_u32 v3, vcc, 0, v3, vcc
v_add_u32 v4, 12288, v1
v_cmp_ge_u32 vcc, s6, v4
s_and_b64 exec, exec, vcc
s_cbranch_execz KA_CPF_D
global_load_dwordx4 v[20:23], v[2:3], off
v_add_co_u32 v2, vcc, 0x1000, v2
s_nop 1
v_addc_co_u32 v3, vcc, 0, v3, vcc
v_add_u32 v4, 16384, v1
v_cmp_ge_u32 vcc, s6, v4
s_and_b64 exec, exec, vcc
s_cbranch_execz KA_CPF_D
global_load_dwordx4 v[24:27], v[2:3], off
v_add_co_u32 v2, vcc, 0x1000, v2
s_nop 1
v_addc_co_u32 v3, vcc, 0, v3, vcc
v_add_u32 v4, 20480, v1
v_cmp_ge_u32 vcc, s6, v4
s_and_b64 exec, exec, vcc
s_cbranch_execz KA_CPF_D
global_load_dwordx4 v[28:31], v[2:3], off
v_add_co_u32 v2, vcc, 0x1000, v2
s_nop 1
v_addc_co_u32 v3, vcc, 0, v3, vcc
v_add_u32 v4, 24576, v1
v_cmp_ge_u32 vcc, s6, v4
s_and_b64 exec, exec, vcc
s_cbranch_execz KA_CPF_D
global_load_dwordx4 v[32:35], v[2:3], off
v_add_co_u32 v2, vcc, 0x1000, v2
s_nop 1
v_addc_co_u32 v3, vcc, 0, v3, vcc
v_add_u32 v4, 28672, v1
v_cmp_ge_u32 vcc, s6, v4
s_and_b64 exec, exec, vcc
s_cbranch_execz KA_CPF_D
global_load_dwordx4 v[36:39], v[2:3], off
v_add_co_u32 v2, vcc, 0x1000, v2
s_nop 1
v_addc_co_u32 v3, vcc, 0, v3, vcc
v_add_u32 v4, 32768, v1
v_cmp_ge_u32 vcc, s6, v4
s_and_b64 exec, exec, vcc
s_cbranch_execz KA_CPF_D
global_load_dwordx4 v[40:43], v[2:3], off
v_add_co_u32 v2, vcc, 0x1000, v2
s_nop 1
v_addc_co_u32 v3, vcc, 0, v3, vcc
v_add_u32 v4, 36864, v1
v_cmp_ge_u32 vcc, s6, v4
s_and_b64 exec, exec, vcc
s_cbranch_execz KA_CPF_D
global_load_dwordx4 v[44:47], v[2:3], off
v_add_co_u32 v2, vcc, 0x1000, v2
s_nop 1
v_addc_co_u32 v3, vcc, 0, v3, vcc
KA_CPF_D:
s_waitcnt vmcnt(0)
s_endpgm
ka_kernel_end:
.globl kb_kernel
.p2align 8
.type kb_kernel,@function
kb_kernel:
s_getpc_b64 s[4:5]
s_mov_b32 s6, kb_kernel_end-kb_kernel-64
v_lshlrev_b32 v1, 7, v0
v_min_u32 v1, s6, v1
v_mov_b32 v3, s5
v_add_co_u32 v2, vcc, s4, v1
s_nop 1
v_addc_co_u32 v3, vcc, 0, v3, vcc
global_load_dword v250, v[2:3], off
s_cmp_ge_u32 s2, 160
s_cbranch_scc1 KB_R
s_load_dwordx2 s[8:9], s[0:1], 120
s_load_dwordx2 s[46:47], s[0:1], 48
v_and_b32 v1, 63, v0
v_lshrrev_b32 v2, 6, v0
s_nop 0
v_readfirstlane_b32 s30, v2
s_and_b32 s3, s2, 7
s_mul_i32 s3, s3, 20
s_lshr_b32 s29, s2, 3
s_add_u32 s29, s29, s3
s_lshl_b32 s31, s29, 2
s_add_u32 s31, s31, s30
v_lshlrev_b32 v3, 4, v1
s_mul_i32 s34, s30, 4352
s_add_u32 s34, s34, 70144
s_mul_i32 s35, s30, 4384
s_add_u32 s35, s35, 87552
s_waitcnt lgkmcnt(0)
s_mov_b32 s20, s8
s_mov_b32 s21, s9
s_mov_b32 s22, 268435456
s_mov_b32 s23, 0x00020000
s_mov_b32 s68, s46
s_mov_b32 s69, s47
s_mov_b32 s70, 1280
s_mov_b32 s71, 0x00020000
s_lshl_b32 s3, s29, 14
s_lshl_b32 s27, s30, 12
s_add_u32 s27, s27, s3
s_add_u32 s26, s27, 3145728
buffer_load_dwordx4 v[200:203], v3, s[20:23], s26 offen offset:0
buffer_load_dwordx4 v[204:207], v3, s[20:23], s26 offen offset:1024
buffer_load_dwordx4 v[208:211], v3, s[20:23], s26 offen offset:2048
buffer_load_dwordx4 v[212:215], v3, s[20:23], s26 offen offset:3072
s_lshl_b32 s3, s30, 12
s_add_u32 s3, s3, 16384
buffer_load_dwordx4 v[216:219], v3, s[20:23], s3 offen offset:0
buffer_load_dwordx4 v[220:223], v3, s[20:23], s3 offen offset:1024
buffer_load_dwordx4 v[224:227], v3, s[20:23], s3 offen offset:2048
buffer_load_dwordx4 v[228:231], v3, s[20:23], s3 offen offset:3072
s_lshl_b32 s3, s29, 4
v_mov_b32 v7, s3
buffer_load_dwordx4 v[232:235], v7, s[20:23], 0 offen offset:0
buffer_load_dwordx4 v[236:239], v7, s[20:23], 0 offen offset:2560
s_mov_b32 s3, 5120
buffer_load_dwordx4 v[240:243], v7, s[20:23], s3 offen
s_lshl_b32 s3, s31, 1
v_mov_b32 v4, s3
buffer_load_ushort v197, v4, s[68:71], 0 offen
s_lshl_b32 s3, s31, 12
s_add_u32 s3, s3, 13631488
s_add_u32 m0, s34, 240
s_nop 0
buffer_load_dwordx4 v3, s[20:23], s3 offen offset:0 lds
buffer_load_dwordx4 v3, s[20:23], s3 offen offset:1024 lds
buffer_load_dwordx4 v3, s[20:23], s3 offen offset:2048 lds
buffer_load_dwordx4 v3, s[20:23], s3 offen offset:3072 lds
v_mov_b32 v64, 0
v_mov_b32 v65, 0
v_mov_b32 v66, 0
v_mov_b32 v67, 0
v_add_u32 v12, s34, v3
v_add_u32 v13, s35, v3
s_mov_b32 exec_hi, 0
s_mov_b32 exec_lo, 0x7fff
ds_write_b128 v12, v[64:67]
s_mov_b32 exec_lo, 0x1ffff
ds_write_b128 v13, v[64:67]
s_mov_b32 exec_lo, -1
s_mov_b32 exec_hi, -1
v_lshlrev_b32 v10, 2, v1
s_lshl_b32 s3, s30, 10
s_add_u32 s3, s3, 87824
v_add_u32 v10, s3, v10
v_mov_b32 v199, v10
s_waitcnt vmcnt(5)
v_add_f32 v236, 1.0, v236
v_cvt_pk_bf16_f32 v236, v236, v236
v_and_b32 v236, 0xffff0000, v236
v_add_f32 v237, 1.0, v237
v_cvt_pk_bf16_f32 v237, v237, v237
v_and_b32 v237, 0xffff0000, v237
v_add_f32 v238, 1.0, v238
v_cvt_pk_bf16_f32 v238, v238, v238
v_and_b32 v238, 0xffff0000, v238
v_add_f32 v239, 1.0, v239
v_cvt_pk_bf16_f32 v239, v239, v239
v_and_b32 v239, 0xffff0000, v239
v_lshlrev_b32 v16, 16, v200
v_lshlrev_b32 v17, 16, v202
v_fma_f32 v16, v16, v216, v217
v_fma_f32 v17, v17, v218, v219
v_fma_f32 v16, v16, v236, v232
v_fma_f32 v17, v17, v236, v232
v_cvt_pk_bf16_f32 v32, v16, v17
ds_write_b32 v10, v32 offset:0
v_and_b32 v18, 0xffff0000, v200
v_and_b32 v19, 0xffff0000, v202
v_fma_f32 v18, v18, v216, v217
v_fma_f32 v19, v19, v218, v219
v_fma_f32 v18, v18, v237, v233
v_fma_f32 v19, v19, v237, v233
v_cvt_pk_bf16_f32 v33, v18, v19
ds_write_b32 v10, v33 offset:4384
v_lshlrev_b32 v20, 16, v201
v_lshlrev_b32 v21, 16, v203
v_fma_f32 v20, v20, v216, v217
v_fma_f32 v21, v21, v218, v219
v_fma_f32 v20, v20, v238, v234
v_fma_f32 v21, v21, v238, v234
v_cvt_pk_bf16_f32 v34, v20, v21
ds_write_b32 v10, v34 offset:8768
v_and_b32 v22, 0xffff0000, v201
v_and_b32 v23, 0xffff0000, v203
v_fma_f32 v22, v22, v216, v217
v_fma_f32 v23, v23, v218, v219
v_fma_f32 v22, v22, v239, v235
v_fma_f32 v23, v23, v239, v235
v_cvt_pk_bf16_f32 v35, v22, v23
ds_write_b32 v10, v35 offset:13152
v_lshlrev_b32 v16, 16, v204
v_lshlrev_b32 v17, 16, v206
v_fma_f32 v16, v16, v220, v221
v_fma_f32 v17, v17, v222, v223
v_fma_f32 v16, v16, v236, v232
v_fma_f32 v17, v17, v236, v232
v_cvt_pk_bf16_f32 v36, v16, v17
ds_write_b32 v10, v36 offset:256
v_and_b32 v18, 0xffff0000, v204
v_and_b32 v19, 0xffff0000, v206
v_fma_f32 v18, v18, v220, v221
v_fma_f32 v19, v19, v222, v223
v_fma_f32 v18, v18, v237, v233
v_fma_f32 v19, v19, v237, v233
v_cvt_pk_bf16_f32 v37, v18, v19
ds_write_b32 v10, v37 offset:4640
v_lshlrev_b32 v20, 16, v205
v_lshlrev_b32 v21, 16, v207
v_fma_f32 v20, v20, v220, v221
v_fma_f32 v21, v21, v222, v223
v_fma_f32 v20, v20, v238, v234
v_fma_f32 v21, v21, v238, v234
v_cvt_pk_bf16_f32 v38, v20, v21
ds_write_b32 v10, v38 offset:9024
v_and_b32 v22, 0xffff0000, v205
v_and_b32 v23, 0xffff0000, v207
v_fma_f32 v22, v22, v220, v221
v_fma_f32 v23, v23, v222, v223
v_fma_f32 v22, v22, v239, v235
v_fma_f32 v23, v23, v239, v235
v_cvt_pk_bf16_f32 v39, v22, v23
ds_write_b32 v10, v39 offset:13408
v_lshlrev_b32 v16, 16, v208
v_lshlrev_b32 v17, 16, v210
v_fma_f32 v16, v16, v224, v225
v_fma_f32 v17, v17, v226, v227
v_fma_f32 v16, v16, v236, v232
v_fma_f32 v17, v17, v236, v232
v_cvt_pk_bf16_f32 v40, v16, v17
ds_write_b32 v10, v40 offset:512
v_and_b32 v18, 0xffff0000, v208
v_and_b32 v19, 0xffff0000, v210
v_fma_f32 v18, v18, v224, v225
v_fma_f32 v19, v19, v226, v227
v_fma_f32 v18, v18, v237, v233
v_fma_f32 v19, v19, v237, v233
v_cvt_pk_bf16_f32 v41, v18, v19
ds_write_b32 v10, v41 offset:4896
v_lshlrev_b32 v20, 16, v209
v_lshlrev_b32 v21, 16, v211
v_fma_f32 v20, v20, v224, v225
v_fma_f32 v21, v21, v226, v227
v_fma_f32 v20, v20, v238, v234
v_fma_f32 v21, v21, v238, v234
v_cvt_pk_bf16_f32 v42, v20, v21
ds_write_b32 v10, v42 offset:9280
v_and_b32 v22, 0xffff0000, v209
v_and_b32 v23, 0xffff0000, v211
v_fma_f32 v22, v22, v224, v225
v_fma_f32 v23, v23, v226, v227
v_fma_f32 v22, v22, v239, v235
v_fma_f32 v23, v23, v239, v235
v_cvt_pk_bf16_f32 v43, v22, v23
ds_write_b32 v10, v43 offset:13664
v_lshlrev_b32 v16, 16, v212
v_lshlrev_b32 v17, 16, v214
v_fma_f32 v16, v16, v228, v229
v_fma_f32 v17, v17, v230, v231
v_fma_f32 v16, v16, v236, v232
v_fma_f32 v17, v17, v236, v232
v_cvt_pk_bf16_f32 v44, v16, v17
ds_write_b32 v10, v44 offset:768
v_and_b32 v18, 0xffff0000, v212
v_and_b32 v19, 0xffff0000, v214
v_fma_f32 v18, v18, v228, v229
v_fma_f32 v19, v19, v230, v231
v_fma_f32 v18, v18, v237, v233
v_fma_f32 v19, v19, v237, v233
v_cvt_pk_bf16_f32 v45, v18, v19
ds_write_b32 v10, v45 offset:5152
v_lshlrev_b32 v20, 16, v213
v_lshlrev_b32 v21, 16, v215
v_fma_f32 v20, v20, v228, v229
v_fma_f32 v21, v21, v230, v231
v_fma_f32 v20, v20, v238, v234
v_fma_f32 v21, v21, v238, v234
v_cvt_pk_bf16_f32 v46, v20, v21
ds_write_b32 v10, v46 offset:9536
v_and_b32 v22, 0xffff0000, v213
v_and_b32 v23, 0xffff0000, v215
v_fma_f32 v22, v22, v228, v229
v_fma_f32 v23, v23, v230, v231
v_fma_f32 v22, v22, v239, v235
v_fma_f32 v23, v23, v239, v235
v_cvt_pk_bf16_f32 v47, v22, v23
ds_write_b32 v10, v47 offset:13920
s_waitcnt vmcnt(0) lgkmcnt(0)
s_barrier
s_mul_i32 s33, s30, 17536
v_lshlrev_b32 v11, 4, v1
v_add_u32 v12, s35, v11
v_sub_u32 v13, 4080, v11
v_add_u32 v13, s33, v13
s_mov_b32 s24, 0xffff
ds_read_b128 v[32:35], v12 offset:272
ds_read_b64 v[36:37], v12 offset:288
ds_read_b128 v[40:43], v12 offset:1296
ds_read_b64 v[44:45], v12 offset:1312
ds_read_b128 v[48:51], v12 offset:2320
ds_read_b64 v[52:53], v12 offset:2336
ds_read_b128 v[56:59], v12 offset:3344
ds_read_b64 v[60:61], v12 offset:3360
ds_read_b128 v[64:67], v12 offset:0
ds_read_b64 v[68:69], v12 offset:16
v_subrev_u32 v14, 3072, v13
v_add_u32 v15, 272, v13
s_waitcnt lgkmcnt(8)
s_waitcnt lgkmcnt(0)
v_bfi_b32 v96, s24, v36, v35
v_bfi_b32 v97, s24, v35, v34
v_bfi_b32 v98, s24, v34, v33
v_bfi_b32 v99, s24, v33, v32
ds_write_b128 v14, v[96:99] offset:3072
v_alignbit_b32 v100, v36, v36, 16
v_alignbit_b32 v101, v35, v35, 16
v_alignbit_b32 v102, v34, v34, 16
v_alignbit_b32 v103, v33, v33, 16
ds_write_b128 v14, v[100:103] offset:7456
v_bfi_b32 v104, s24, v37, v36
v_bfi_b32 v105, s24, v36, v35
v_bfi_b32 v106, s24, v35, v34
v_bfi_b32 v107, s24, v34, v33
ds_write_b128 v14, v[104:107] offset:11840
v_alignbit_b32 v108, v37, v37, 16
v_alignbit_b32 v109, v36, v36, 16
v_alignbit_b32 v110, v35, v35, 16
v_alignbit_b32 v111, v34, v34, 16
ds_write_b128 v14, v[108:111] offset:16224
s_nop 0
v_bfi_b32 v112, s24, v44, v43
v_bfi_b32 v113, s24, v43, v42
v_bfi_b32 v114, s24, v42, v41
v_bfi_b32 v115, s24, v41, v40
ds_write_b128 v14, v[112:115] offset:2048
v_alignbit_b32 v116, v44, v44, 16
v_alignbit_b32 v117, v43, v43, 16
v_alignbit_b32 v118, v42, v42, 16
v_alignbit_b32 v119, v41, v41, 16
ds_write_b128 v14, v[116:119] offset:6432
v_bfi_b32 v120, s24, v45, v44
v_bfi_b32 v121, s24, v44, v43
v_bfi_b32 v122, s24, v43, v42
v_bfi_b32 v123, s24, v42, v41
ds_write_b128 v14, v[120:123] offset:10816
v_alignbit_b32 v124, v45, v45, 16
v_alignbit_b32 v125, v44, v44, 16
v_alignbit_b32 v126, v43, v43, 16
v_alignbit_b32 v127, v42, v42, 16
ds_write_b128 v14, v[124:127] offset:15200
s_nop 0
v_bfi_b32 v96, s24, v52, v51
v_bfi_b32 v97, s24, v51, v50
v_bfi_b32 v98, s24, v50, v49
v_bfi_b32 v99, s24, v49, v48
ds_write_b128 v14, v[96:99] offset:1024
v_alignbit_b32 v100, v52, v52, 16
v_alignbit_b32 v101, v51, v51, 16
v_alignbit_b32 v102, v50, v50, 16
v_alignbit_b32 v103, v49, v49, 16
ds_write_b128 v14, v[100:103] offset:5408
v_bfi_b32 v104, s24, v53, v52
v_bfi_b32 v105, s24, v52, v51
v_bfi_b32 v106, s24, v51, v50
v_bfi_b32 v107, s24, v50, v49
ds_write_b128 v14, v[104:107] offset:9792
v_alignbit_b32 v108, v53, v53, 16
v_alignbit_b32 v109, v52, v52, 16
v_alignbit_b32 v110, v51, v51, 16
v_alignbit_b32 v111, v50, v50, 16
ds_write_b128 v14, v[108:111] offset:14176
s_nop 0
v_bfi_b32 v112, s24, v60, v59
v_bfi_b32 v113, s24, v59, v58
v_bfi_b32 v114, s24, v58, v57
v_bfi_b32 v115, s24, v57, v56
ds_write_b128 v14, v[112:115] offset:0
v_alignbit_b32 v116, v60, v60, 16
v_alignbit_b32 v117, v59, v59, 16
v_alignbit_b32 v118, v58, v58, 16
v_alignbit_b32 v119, v57, v57, 16
ds_write_b128 v14, v[116:119] offset:4384
v_bfi_b32 v120, s24, v61, v60
v_bfi_b32 v121, s24, v60, v59
v_bfi_b32 v122, s24, v59, v58
v_bfi_b32 v123, s24, v58, v57
ds_write_b128 v14, v[120:123] offset:8768
v_alignbit_b32 v124, v61, v61, 16
v_alignbit_b32 v125, v60, v60, 16
v_alignbit_b32 v126, v59, v59, 16
v_alignbit_b32 v127, v58, v58, 16
ds_write_b128 v14, v[124:127] offset:13152
s_mov_b32 exec_hi, 0
s_mov_b32 exec_lo, 0x1ffff
v_bfi_b32 v128, s24, v68, v67
v_bfi_b32 v129, s24, v67, v66
v_bfi_b32 v130, s24, v66, v65
v_bfi_b32 v131, s24, v65, v64
ds_write_b128 v15, v[128:131] offset:0
v_alignbit_b32 v132, v68, v68, 16
v_alignbit_b32 v133, v67, v67, 16
v_alignbit_b32 v134, v66, v66, 16
v_alignbit_b32 v135, v65, v65, 16
ds_write_b128 v15, v[132:135] offset:4384
v_bfi_b32 v136, s24, v69, v68
v_bfi_b32 v137, s24, v68, v67
v_bfi_b32 v138, s24, v67, v66
v_bfi_b32 v139, s24, v66, v65
ds_write_b128 v15, v[136:139] offset:8768
v_alignbit_b32 v140, v69, v69, 16
v_alignbit_b32 v141, v68, v68, 16
v_alignbit_b32 v142, v67, v67, 16
v_alignbit_b32 v143, v66, v66, 16
ds_write_b128 v15, v[140:143] offset:13152
s_mov_b32 exec_lo, -1
s_mov_b32 exec_hi, -1
v_and_b32 v10, 15, v1
v_lshrrev_b32 v11, 4, v1
v_add_u32 v12, v10, v11
v_lshlrev_b32 v12, 4, v12
v_add_u32 v12, s34, v12
v_and_b32 v13, 3, v10
v_bfe_u32 v14, v10, 2, 1
v_lshrrev_b32 v15, 3, v10
v_mul_u32_u24 v13, 4384, v13
v_lshl_add_u32 v13, v11, 4, v13
v_lshlrev_b32 v14, 3, v14
v_sub_u32 v13, v13, v14
v_lshlrev_b32 v15, 8, v15
v_sub_u32 v13, v13, v15
s_add_u32 s3, s33, 272
v_add_u32 v13, s3, v13
s_waitcnt lgkmcnt(0)
ds_read_b128 v[32:35], v12 offset:0
ds_read_b64 v[64:65], v13 offset:3584
ds_read_b64 v[66:67], v13 offset:3592
ds_read_b128 v[36:39], v12 offset:512
ds_read_b64 v[68:69], v13 offset:3072
ds_read_b64 v[70:71], v13 offset:3080
ds_read_b128 v[40:43], v12 offset:1024
ds_read_b64 v[72:73], v13 offset:2560
ds_read_b64 v[74:75], v13 offset:2568
ds_read_b128 v[44:47], v12 offset:1536
ds_read_b64 v[76:77], v13 offset:2048
ds_read_b64 v[78:79], v13 offset:2056
s_waitcnt lgkmcnt(0)
ds_read_b128 v[48:51], v12 offset:2048
ds_read_b64 v[80:81], v13 offset:1536
ds_read_b64 v[82:83], v13 offset:1544
ds_read_b128 v[52:55], v12 offset:2560
ds_read_b64 v[84:85], v13 offset:1024
ds_read_b64 v[86:87], v13 offset:1032
ds_read_b128 v[56:59], v12 offset:3072
ds_read_b64 v[88:89], v13 offset:512
ds_read_b64 v[90:91], v13 offset:520
ds_read_b128 v[60:63], v12 offset:3584
ds_read_b64 v[92:93], v13 offset:0
ds_read_b64 v[94:95], v13 offset:8
s_waitcnt lgkmcnt(0)
v_mfma_f32_16x16x32_bf16 v[160:163], v[64:67], v[32:35], 0
ds_read_b128 v[96:99], v12 offset:64
v_mfma_f32_16x16x32_bf16 v[164:167], v[68:71], v[32:35], 0
ds_read_b64 v[128:129], v13 offset:3648
v_mfma_f32_16x16x32_bf16 v[168:171], v[72:75], v[32:35], 0
ds_read_b64 v[130:131], v13 offset:3656
v_mfma_f32_16x16x32_bf16 v[172:175], v[76:79], v[32:35], 0
ds_read_b128 v[100:103], v12 offset:576
v_mfma_f32_16x16x32_bf16 v[176:179], v[80:83], v[32:35], 0
ds_read_b64 v[132:133], v13 offset:3136
v_mfma_f32_16x16x32_bf16 v[180:183], v[84:87], v[32:35], 0
ds_read_b64 v[134:135], v13 offset:3144
v_mfma_f32_16x16x32_bf16 v[184:187], v[88:91], v[32:35], 0
ds_read_b128 v[104:107], v12 offset:1088
v_mfma_f32_16x16x32_bf16 v[188:191], v[92:95], v[32:35], 0
ds_read_b64 v[136:137], v13 offset:2624
v_mfma_f32_16x16x32_bf16 v[164:167], v[64:67], v[36:39], v[164:167]
ds_read_b64 v[138:139], v13 offset:2632
v_mfma_f32_16x16x32_bf16 v[168:171], v[68:71], v[36:39], v[168:171]
ds_read_b128 v[108:111], v12 offset:1600
v_mfma_f32_16x16x32_bf16 v[172:175], v[72:75], v[36:39], v[172:175]
ds_read_b64 v[140:141], v13 offset:2112
v_mfma_f32_16x16x32_bf16 v[176:179], v[76:79], v[36:39], v[176:179]
ds_read_b64 v[142:143], v13 offset:2120
v_mfma_f32_16x16x32_bf16 v[180:183], v[80:83], v[36:39], v[180:183]
ds_read_b128 v[112:115], v12 offset:2112
v_mfma_f32_16x16x32_bf16 v[184:187], v[84:87], v[36:39], v[184:187]
ds_read_b64 v[144:145], v13 offset:1600
v_mfma_f32_16x16x32_bf16 v[188:191], v[88:91], v[36:39], v[188:191]
ds_read_b64 v[146:147], v13 offset:1608
v_mfma_f32_16x16x32_bf16 v[168:171], v[64:67], v[40:43], v[168:171]
ds_read_b128 v[116:119], v12 offset:2624
v_mfma_f32_16x16x32_bf16 v[172:175], v[68:71], v[40:43], v[172:175]
ds_read_b64 v[148:149], v13 offset:1088
v_mfma_f32_16x16x32_bf16 v[176:179], v[72:75], v[40:43], v[176:179]
ds_read_b64 v[150:151], v13 offset:1096
v_mfma_f32_16x16x32_bf16 v[180:183], v[76:79], v[40:43], v[180:183]
ds_read_b128 v[120:123], v12 offset:3136
v_mfma_f32_16x16x32_bf16 v[184:187], v[80:83], v[40:43], v[184:187]
ds_read_b64 v[152:153], v13 offset:576
v_mfma_f32_16x16x32_bf16 v[188:191], v[84:87], v[40:43], v[188:191]
ds_read_b64 v[154:155], v13 offset:584
v_mfma_f32_16x16x32_bf16 v[172:175], v[64:67], v[44:47], v[172:175]
ds_read_b128 v[124:127], v12 offset:3648
v_mfma_f32_16x16x32_bf16 v[176:179], v[68:71], v[44:47], v[176:179]
ds_read_b64 v[156:157], v13 offset:64
v_mfma_f32_16x16x32_bf16 v[180:183], v[72:75], v[44:47], v[180:183]
ds_read_b64 v[158:159], v13 offset:72
v_mfma_f32_16x16x32_bf16 v[184:187], v[76:79], v[44:47], v[184:187]
v_mfma_f32_16x16x32_bf16 v[188:191], v[80:83], v[44:47], v[188:191]
v_mfma_f32_16x16x32_bf16 v[176:179], v[64:67], v[48:51], v[176:179]
v_mfma_f32_16x16x32_bf16 v[180:183], v[68:71], v[48:51], v[180:183]
v_mfma_f32_16x16x32_bf16 v[184:187], v[72:75], v[48:51], v[184:187]
v_mfma_f32_16x16x32_bf16 v[188:191], v[76:79], v[48:51], v[188:191]
v_mfma_f32_16x16x32_bf16 v[180:183], v[64:67], v[52:55], v[180:183]
v_mfma_f32_16x16x32_bf16 v[184:187], v[68:71], v[52:55], v[184:187]
v_mfma_f32_16x16x32_bf16 v[188:191], v[72:75], v[52:55], v[188:191]
v_mfma_f32_16x16x32_bf16 v[184:187], v[64:67], v[56:59], v[184:187]
v_mfma_f32_16x16x32_bf16 v[188:191], v[68:71], v[56:59], v[188:191]
v_mfma_f32_16x16x32_bf16 v[188:191], v[64:67], v[60:63], v[188:191]
s_waitcnt lgkmcnt(0)
v_mfma_f32_16x16x32_bf16 v[160:163], v[128:131], v[96:99], v[160:163]
ds_read_b128 v[32:35], v12 offset:128
v_mfma_f32_16x16x32_bf16 v[164:167], v[132:135], v[96:99], v[164:167]
ds_read_b64 v[64:65], v13 offset:3712
v_mfma_f32_16x16x32_bf16 v[168:171], v[136:139], v[96:99], v[168:171]
ds_read_b64 v[66:67], v13 offset:3720
v_mfma_f32_16x16x32_bf16 v[172:175], v[140:143], v[96:99], v[172:175]
ds_read_b128 v[36:39], v12 offset:640
v_mfma_f32_16x16x32_bf16 v[176:179], v[144:147], v[96:99], v[176:179]
ds_read_b64 v[68:69], v13 offset:3200
v_mfma_f32_16x16x32_bf16 v[180:183], v[148:151], v[96:99], v[180:183]
ds_read_b64 v[70:71], v13 offset:3208
v_mfma_f32_16x16x32_bf16 v[184:187], v[152:155], v[96:99], v[184:187]
ds_read_b128 v[40:43], v12 offset:1152
v_mfma_f32_16x16x32_bf16 v[188:191], v[156:159], v[96:99], v[188:191]
ds_read_b64 v[72:73], v13 offset:2688
v_mfma_f32_16x16x32_bf16 v[164:167], v[128:131], v[100:103], v[164:167]
ds_read_b64 v[74:75], v13 offset:2696
v_mfma_f32_16x16x32_bf16 v[168:171], v[132:135], v[100:103], v[168:171]
ds_read_b128 v[44:47], v12 offset:1664
v_mfma_f32_16x16x32_bf16 v[172:175], v[136:139], v[100:103], v[172:175]
ds_read_b64 v[76:77], v13 offset:2176
v_mfma_f32_16x16x32_bf16 v[176:179], v[140:143], v[100:103], v[176:179]
ds_read_b64 v[78:79], v13 offset:2184
v_mfma_f32_16x16x32_bf16 v[180:183], v[144:147], v[100:103], v[180:183]
ds_read_b128 v[48:51], v12 offset:2176
v_mfma_f32_16x16x32_bf16 v[184:187], v[148:151], v[100:103], v[184:187]
ds_read_b64 v[80:81], v13 offset:1664
v_mfma_f32_16x16x32_bf16 v[188:191], v[152:155], v[100:103], v[188:191]
ds_read_b64 v[82:83], v13 offset:1672
v_mfma_f32_16x16x32_bf16 v[168:171], v[128:131], v[104:107], v[168:171]
ds_read_b128 v[52:55], v12 offset:2688
v_mfma_f32_16x16x32_bf16 v[172:175], v[132:135], v[104:107], v[172:175]
ds_read_b64 v[84:85], v13 offset:1152
v_mfma_f32_16x16x32_bf16 v[176:179], v[136:139], v[104:107], v[176:179]
ds_read_b64 v[86:87], v13 offset:1160
v_mfma_f32_16x16x32_bf16 v[180:183], v[140:143], v[104:107], v[180:183]
ds_read_b128 v[56:59], v12 offset:3200
v_mfma_f32_16x16x32_bf16 v[184:187], v[144:147], v[104:107], v[184:187]
ds_read_b64 v[88:89], v13 offset:640
v_mfma_f32_16x16x32_bf16 v[188:191], v[148:151], v[104:107], v[188:191]
ds_read_b64 v[90:91], v13 offset:648
v_mfma_f32_16x16x32_bf16 v[172:175], v[128:131], v[108:111], v[172:175]
ds_read_b128 v[60:63], v12 offset:3712
v_mfma_f32_16x16x32_bf16 v[176:179], v[132:135], v[108:111], v[176:179]
ds_read_b64 v[92:93], v13 offset:128
v_mfma_f32_16x16x32_bf16 v[180:183], v[136:139], v[108:111], v[180:183]
ds_read_b64 v[94:95], v13 offset:136
v_mfma_f32_16x16x32_bf16 v[184:187], v[140:143], v[108:111], v[184:187]
v_mfma_f32_16x16x32_bf16 v[188:191], v[144:147], v[108:111], v[188:191]
v_mfma_f32_16x16x32_bf16 v[176:179], v[128:131], v[112:115], v[176:179]
v_mfma_f32_16x16x32_bf16 v[180:183], v[132:135], v[112:115], v[180:183]
v_mfma_f32_16x16x32_bf16 v[184:187], v[136:139], v[112:115], v[184:187]
v_mfma_f32_16x16x32_bf16 v[188:191], v[140:143], v[112:115], v[188:191]
v_mfma_f32_16x16x32_bf16 v[180:183], v[128:131], v[116:119], v[180:183]
v_mfma_f32_16x16x32_bf16 v[184:187], v[132:135], v[116:119], v[184:187]
v_mfma_f32_16x16x32_bf16 v[188:191], v[136:139], v[116:119], v[188:191]
v_mfma_f32_16x16x32_bf16 v[184:187], v[128:131], v[120:123], v[184:187]
v_mfma_f32_16x16x32_bf16 v[188:191], v[132:135], v[120:123], v[188:191]
v_mfma_f32_16x16x32_bf16 v[188:191], v[128:131], v[124:127], v[188:191]
s_waitcnt lgkmcnt(0)
v_mfma_f32_16x16x32_bf16 v[160:163], v[64:67], v[32:35], v[160:163]
ds_read_b128 v[96:99], v12 offset:192
v_mfma_f32_16x16x32_bf16 v[164:167], v[68:71], v[32:35], v[164:167]
ds_read_b64 v[128:129], v13 offset:3776
v_mfma_f32_16x16x32_bf16 v[168:171], v[72:75], v[32:35], v[168:171]
ds_read_b64 v[130:131], v13 offset:3784
v_mfma_f32_16x16x32_bf16 v[172:175], v[76:79], v[32:35], v[172:175]
ds_read_b128 v[100:103], v12 offset:704
v_mfma_f32_16x16x32_bf16 v[176:179], v[80:83], v[32:35], v[176:179]
ds_read_b64 v[132:133], v13 offset:3264
v_mfma_f32_16x16x32_bf16 v[180:183], v[84:87], v[32:35], v[180:183]
ds_read_b64 v[134:135], v13 offset:3272
v_mfma_f32_16x16x32_bf16 v[184:187], v[88:91], v[32:35], v[184:187]
ds_read_b128 v[104:107], v12 offset:1216
v_mfma_f32_16x16x32_bf16 v[188:191], v[92:95], v[32:35], v[188:191]
ds_read_b64 v[136:137], v13 offset:2752
v_mfma_f32_16x16x32_bf16 v[164:167], v[64:67], v[36:39], v[164:167]
ds_read_b64 v[138:139], v13 offset:2760
v_mfma_f32_16x16x32_bf16 v[168:171], v[68:71], v[36:39], v[168:171]
ds_read_b128 v[108:111], v12 offset:1728
v_mfma_f32_16x16x32_bf16 v[172:175], v[72:75], v[36:39], v[172:175]
ds_read_b64 v[140:141], v13 offset:2240
v_mfma_f32_16x16x32_bf16 v[176:179], v[76:79], v[36:39], v[176:179]
ds_read_b64 v[142:143], v13 offset:2248
v_mfma_f32_16x16x32_bf16 v[180:183], v[80:83], v[36:39], v[180:183]
ds_read_b128 v[112:115], v12 offset:2240
v_mfma_f32_16x16x32_bf16 v[184:187], v[84:87], v[36:39], v[184:187]
ds_read_b64 v[144:145], v13 offset:1728
v_mfma_f32_16x16x32_bf16 v[188:191], v[88:91], v[36:39], v[188:191]
ds_read_b64 v[146:147], v13 offset:1736
v_mfma_f32_16x16x32_bf16 v[168:171], v[64:67], v[40:43], v[168:171]
ds_read_b128 v[116:119], v12 offset:2752
v_mfma_f32_16x16x32_bf16 v[172:175], v[68:71], v[40:43], v[172:175]
ds_read_b64 v[148:149], v13 offset:1216
v_mfma_f32_16x16x32_bf16 v[176:179], v[72:75], v[40:43], v[176:179]
ds_read_b64 v[150:151], v13 offset:1224
v_mfma_f32_16x16x32_bf16 v[180:183], v[76:79], v[40:43], v[180:183]
ds_read_b128 v[120:123], v12 offset:3264
v_mfma_f32_16x16x32_bf16 v[184:187], v[80:83], v[40:43], v[184:187]
ds_read_b64 v[152:153], v13 offset:704
v_mfma_f32_16x16x32_bf16 v[188:191], v[84:87], v[40:43], v[188:191]
ds_read_b64 v[154:155], v13 offset:712
v_mfma_f32_16x16x32_bf16 v[172:175], v[64:67], v[44:47], v[172:175]
ds_read_b128 v[124:127], v12 offset:3776
v_mfma_f32_16x16x32_bf16 v[176:179], v[68:71], v[44:47], v[176:179]
ds_read_b64 v[156:157], v13 offset:192
v_mfma_f32_16x16x32_bf16 v[180:183], v[72:75], v[44:47], v[180:183]
ds_read_b64 v[158:159], v13 offset:200
v_mfma_f32_16x16x32_bf16 v[184:187], v[76:79], v[44:47], v[184:187]
v_mfma_f32_16x16x32_bf16 v[188:191], v[80:83], v[44:47], v[188:191]
v_mfma_f32_16x16x32_bf16 v[176:179], v[64:67], v[48:51], v[176:179]
v_mfma_f32_16x16x32_bf16 v[180:183], v[68:71], v[48:51], v[180:183]
v_mfma_f32_16x16x32_bf16 v[184:187], v[72:75], v[48:51], v[184:187]
v_mfma_f32_16x16x32_bf16 v[188:191], v[76:79], v[48:51], v[188:191]
v_mfma_f32_16x16x32_bf16 v[180:183], v[64:67], v[52:55], v[180:183]
v_mfma_f32_16x16x32_bf16 v[184:187], v[68:71], v[52:55], v[184:187]
v_mfma_f32_16x16x32_bf16 v[188:191], v[72:75], v[52:55], v[188:191]
v_mfma_f32_16x16x32_bf16 v[184:187], v[64:67], v[56:59], v[184:187]
v_mfma_f32_16x16x32_bf16 v[188:191], v[68:71], v[56:59], v[188:191]
v_mfma_f32_16x16x32_bf16 v[188:191], v[64:67], v[60:63], v[188:191]
s_waitcnt lgkmcnt(0)
v_mfma_f32_16x16x32_bf16 v[160:163], v[128:131], v[96:99], v[160:163]
ds_read_b128 v[32:35], v12 offset:256
v_mfma_f32_16x16x32_bf16 v[164:167], v[132:135], v[96:99], v[164:167]
ds_read_b64 v[64:65], v13 offset:3840
v_mfma_f32_16x16x32_bf16 v[168:171], v[136:139], v[96:99], v[168:171]
ds_read_b64 v[66:67], v13 offset:3848
v_mfma_f32_16x16x32_bf16 v[172:175], v[140:143], v[96:99], v[172:175]
ds_read_b128 v[36:39], v12 offset:768
v_mfma_f32_16x16x32_bf16 v[176:179], v[144:147], v[96:99], v[176:179]
ds_read_b64 v[68:69], v13 offset:3328
v_mfma_f32_16x16x32_bf16 v[180:183], v[148:151], v[96:99], v[180:183]
ds_read_b64 v[70:71], v13 offset:3336
v_mfma_f32_16x16x32_bf16 v[184:187], v[152:155], v[96:99], v[184:187]
ds_read_b128 v[40:43], v12 offset:1280
v_mfma_f32_16x16x32_bf16 v[188:191], v[156:159], v[96:99], v[188:191]
ds_read_b64 v[72:73], v13 offset:2816
v_mfma_f32_16x16x32_bf16 v[164:167], v[128:131], v[100:103], v[164:167]
ds_read_b64 v[74:75], v13 offset:2824
v_mfma_f32_16x16x32_bf16 v[168:171], v[132:135], v[100:103], v[168:171]
ds_read_b128 v[44:47], v12 offset:1792
v_mfma_f32_16x16x32_bf16 v[172:175], v[136:139], v[100:103], v[172:175]
ds_read_b64 v[76:77], v13 offset:2304
v_mfma_f32_16x16x32_bf16 v[176:179], v[140:143], v[100:103], v[176:179]
ds_read_b64 v[78:79], v13 offset:2312
v_mfma_f32_16x16x32_bf16 v[180:183], v[144:147], v[100:103], v[180:183]
ds_read_b128 v[48:51], v12 offset:2304
v_mfma_f32_16x16x32_bf16 v[184:187], v[148:151], v[100:103], v[184:187]
ds_read_b64 v[80:81], v13 offset:1792
v_mfma_f32_16x16x32_bf16 v[188:191], v[152:155], v[100:103], v[188:191]
ds_read_b64 v[82:83], v13 offset:1800
v_mfma_f32_16x16x32_bf16 v[168:171], v[128:131], v[104:107], v[168:171]
ds_read_b128 v[52:55], v12 offset:2816
v_mfma_f32_16x16x32_bf16 v[172:175], v[132:135], v[104:107], v[172:175]
ds_read_b64 v[84:85], v13 offset:1280
v_mfma_f32_16x16x32_bf16 v[176:179], v[136:139], v[104:107], v[176:179]
ds_read_b64 v[86:87], v13 offset:1288
v_mfma_f32_16x16x32_bf16 v[180:183], v[140:143], v[104:107], v[180:183]
ds_read_b128 v[56:59], v12 offset:3328
v_mfma_f32_16x16x32_bf16 v[184:187], v[144:147], v[104:107], v[184:187]
ds_read_b64 v[88:89], v13 offset:768
v_mfma_f32_16x16x32_bf16 v[188:191], v[148:151], v[104:107], v[188:191]
ds_read_b64 v[90:91], v13 offset:776
v_mfma_f32_16x16x32_bf16 v[172:175], v[128:131], v[108:111], v[172:175]
ds_read_b128 v[60:63], v12 offset:3840
v_mfma_f32_16x16x32_bf16 v[176:179], v[132:135], v[108:111], v[176:179]
ds_read_b64 v[92:93], v13 offset:256
v_mfma_f32_16x16x32_bf16 v[180:183], v[136:139], v[108:111], v[180:183]
ds_read_b64 v[94:95], v13 offset:264
v_mfma_f32_16x16x32_bf16 v[184:187], v[140:143], v[108:111], v[184:187]
v_mfma_f32_16x16x32_bf16 v[188:191], v[144:147], v[108:111], v[188:191]
v_mfma_f32_16x16x32_bf16 v[176:179], v[128:131], v[112:115], v[176:179]
v_mfma_f32_16x16x32_bf16 v[180:183], v[132:135], v[112:115], v[180:183]
v_mfma_f32_16x16x32_bf16 v[184:187], v[136:139], v[112:115], v[184:187]
v_mfma_f32_16x16x32_bf16 v[188:191], v[140:143], v[112:115], v[188:191]
v_mfma_f32_16x16x32_bf16 v[180:183], v[128:131], v[116:119], v[180:183]
v_mfma_f32_16x16x32_bf16 v[184:187], v[132:135], v[116:119], v[184:187]
v_mfma_f32_16x16x32_bf16 v[188:191], v[136:139], v[116:119], v[188:191]
v_mfma_f32_16x16x32_bf16 v[184:187], v[128:131], v[120:123], v[184:187]
v_mfma_f32_16x16x32_bf16 v[188:191], v[132:135], v[120:123], v[188:191]
v_mfma_f32_16x16x32_bf16 v[188:191], v[128:131], v[124:127], v[188:191]
s_waitcnt lgkmcnt(0)
v_mfma_f32_16x16x32_bf16 v[160:163], v[64:67], v[32:35], v[160:163]
ds_read_b128 v[96:99], v12 offset:320
v_mfma_f32_16x16x32_bf16 v[164:167], v[68:71], v[32:35], v[164:167]
ds_read_b64 v[128:129], v13 offset:3904
v_mfma_f32_16x16x32_bf16 v[168:171], v[72:75], v[32:35], v[168:171]
ds_read_b64 v[130:131], v13 offset:3912
v_mfma_f32_16x16x32_bf16 v[172:175], v[76:79], v[32:35], v[172:175]
ds_read_b128 v[100:103], v12 offset:832
v_mfma_f32_16x16x32_bf16 v[176:179], v[80:83], v[32:35], v[176:179]
ds_read_b64 v[132:133], v13 offset:3392
v_mfma_f32_16x16x32_bf16 v[180:183], v[84:87], v[32:35], v[180:183]
ds_read_b64 v[134:135], v13 offset:3400
v_mfma_f32_16x16x32_bf16 v[184:187], v[88:91], v[32:35], v[184:187]
ds_read_b128 v[104:107], v12 offset:1344
v_mfma_f32_16x16x32_bf16 v[188:191], v[92:95], v[32:35], v[188:191]
ds_read_b64 v[136:137], v13 offset:2880
v_mfma_f32_16x16x32_bf16 v[164:167], v[64:67], v[36:39], v[164:167]
ds_read_b64 v[138:139], v13 offset:2888
v_mfma_f32_16x16x32_bf16 v[168:171], v[68:71], v[36:39], v[168:171]
ds_read_b128 v[108:111], v12 offset:1856
v_mfma_f32_16x16x32_bf16 v[172:175], v[72:75], v[36:39], v[172:175]
ds_read_b64 v[140:141], v13 offset:2368
v_mfma_f32_16x16x32_bf16 v[176:179], v[76:79], v[36:39], v[176:179]
ds_read_b64 v[142:143], v13 offset:2376
v_mfma_f32_16x16x32_bf16 v[180:183], v[80:83], v[36:39], v[180:183]
ds_read_b128 v[112:115], v12 offset:2368
v_mfma_f32_16x16x32_bf16 v[184:187], v[84:87], v[36:39], v[184:187]
ds_read_b64 v[144:145], v13 offset:1856
v_mfma_f32_16x16x32_bf16 v[188:191], v[88:91], v[36:39], v[188:191]
ds_read_b64 v[146:147], v13 offset:1864
v_mfma_f32_16x16x32_bf16 v[168:171], v[64:67], v[40:43], v[168:171]
ds_read_b128 v[116:119], v12 offset:2880
v_mfma_f32_16x16x32_bf16 v[172:175], v[68:71], v[40:43], v[172:175]
ds_read_b64 v[148:149], v13 offset:1344
v_mfma_f32_16x16x32_bf16 v[176:179], v[72:75], v[40:43], v[176:179]
ds_read_b64 v[150:151], v13 offset:1352
v_mfma_f32_16x16x32_bf16 v[180:183], v[76:79], v[40:43], v[180:183]
ds_read_b128 v[120:123], v12 offset:3392
v_mfma_f32_16x16x32_bf16 v[184:187], v[80:83], v[40:43], v[184:187]
ds_read_b64 v[152:153], v13 offset:832
v_mfma_f32_16x16x32_bf16 v[188:191], v[84:87], v[40:43], v[188:191]
ds_read_b64 v[154:155], v13 offset:840
v_mfma_f32_16x16x32_bf16 v[172:175], v[64:67], v[44:47], v[172:175]
ds_read_b128 v[124:127], v12 offset:3904
v_mfma_f32_16x16x32_bf16 v[176:179], v[68:71], v[44:47], v[176:179]
ds_read_b64 v[156:157], v13 offset:320
v_mfma_f32_16x16x32_bf16 v[180:183], v[72:75], v[44:47], v[180:183]
ds_read_b64 v[158:159], v13 offset:328
v_mfma_f32_16x16x32_bf16 v[184:187], v[76:79], v[44:47], v[184:187]
v_mfma_f32_16x16x32_bf16 v[188:191], v[80:83], v[44:47], v[188:191]
v_mfma_f32_16x16x32_bf16 v[176:179], v[64:67], v[48:51], v[176:179]
v_mfma_f32_16x16x32_bf16 v[180:183], v[68:71], v[48:51], v[180:183]
v_mfma_f32_16x16x32_bf16 v[184:187], v[72:75], v[48:51], v[184:187]
v_mfma_f32_16x16x32_bf16 v[188:191], v[76:79], v[48:51], v[188:191]
v_mfma_f32_16x16x32_bf16 v[180:183], v[64:67], v[52:55], v[180:183]
v_mfma_f32_16x16x32_bf16 v[184:187], v[68:71], v[52:55], v[184:187]
v_mfma_f32_16x16x32_bf16 v[188:191], v[72:75], v[52:55], v[188:191]
v_mfma_f32_16x16x32_bf16 v[184:187], v[64:67], v[56:59], v[184:187]
v_mfma_f32_16x16x32_bf16 v[188:191], v[68:71], v[56:59], v[188:191]
v_mfma_f32_16x16x32_bf16 v[188:191], v[64:67], v[60:63], v[188:191]
s_waitcnt lgkmcnt(0)
v_mfma_f32_16x16x32_bf16 v[160:163], v[128:131], v[96:99], v[160:163]
ds_read_b128 v[32:35], v12 offset:384
v_mfma_f32_16x16x32_bf16 v[164:167], v[132:135], v[96:99], v[164:167]
ds_read_b64 v[64:65], v13 offset:3968
v_mfma_f32_16x16x32_bf16 v[168:171], v[136:139], v[96:99], v[168:171]
ds_read_b64 v[66:67], v13 offset:3976
v_mfma_f32_16x16x32_bf16 v[172:175], v[140:143], v[96:99], v[172:175]
ds_read_b128 v[36:39], v12 offset:896
v_mfma_f32_16x16x32_bf16 v[176:179], v[144:147], v[96:99], v[176:179]
ds_read_b64 v[68:69], v13 offset:3456
v_mfma_f32_16x16x32_bf16 v[180:183], v[148:151], v[96:99], v[180:183]
ds_read_b64 v[70:71], v13 offset:3464
v_mfma_f32_16x16x32_bf16 v[184:187], v[152:155], v[96:99], v[184:187]
ds_read_b128 v[40:43], v12 offset:1408
v_mfma_f32_16x16x32_bf16 v[188:191], v[156:159], v[96:99], v[188:191]
ds_read_b64 v[72:73], v13 offset:2944
v_mfma_f32_16x16x32_bf16 v[164:167], v[128:131], v[100:103], v[164:167]
ds_read_b64 v[74:75], v13 offset:2952
v_mfma_f32_16x16x32_bf16 v[168:171], v[132:135], v[100:103], v[168:171]
ds_read_b128 v[44:47], v12 offset:1920
v_mfma_f32_16x16x32_bf16 v[172:175], v[136:139], v[100:103], v[172:175]
ds_read_b64 v[76:77], v13 offset:2432
v_mfma_f32_16x16x32_bf16 v[176:179], v[140:143], v[100:103], v[176:179]
ds_read_b64 v[78:79], v13 offset:2440
v_mfma_f32_16x16x32_bf16 v[180:183], v[144:147], v[100:103], v[180:183]
ds_read_b128 v[48:51], v12 offset:2432
v_mfma_f32_16x16x32_bf16 v[184:187], v[148:151], v[100:103], v[184:187]
ds_read_b64 v[80:81], v13 offset:1920
v_mfma_f32_16x16x32_bf16 v[188:191], v[152:155], v[100:103], v[188:191]
ds_read_b64 v[82:83], v13 offset:1928
v_mfma_f32_16x16x32_bf16 v[168:171], v[128:131], v[104:107], v[168:171]
ds_read_b128 v[52:55], v12 offset:2944
v_mfma_f32_16x16x32_bf16 v[172:175], v[132:135], v[104:107], v[172:175]
ds_read_b64 v[84:85], v13 offset:1408
v_mfma_f32_16x16x32_bf16 v[176:179], v[136:139], v[104:107], v[176:179]
ds_read_b64 v[86:87], v13 offset:1416
v_mfma_f32_16x16x32_bf16 v[180:183], v[140:143], v[104:107], v[180:183]
ds_read_b128 v[56:59], v12 offset:3456
v_mfma_f32_16x16x32_bf16 v[184:187], v[144:147], v[104:107], v[184:187]
ds_read_b64 v[88:89], v13 offset:896
v_mfma_f32_16x16x32_bf16 v[188:191], v[148:151], v[104:107], v[188:191]
ds_read_b64 v[90:91], v13 offset:904
v_mfma_f32_16x16x32_bf16 v[172:175], v[128:131], v[108:111], v[172:175]
ds_read_b128 v[60:63], v12 offset:3968
v_mfma_f32_16x16x32_bf16 v[176:179], v[132:135], v[108:111], v[176:179]
ds_read_b64 v[92:93], v13 offset:384
v_mfma_f32_16x16x32_bf16 v[180:183], v[136:139], v[108:111], v[180:183]
ds_read_b64 v[94:95], v13 offset:392
v_mfma_f32_16x16x32_bf16 v[184:187], v[140:143], v[108:111], v[184:187]
v_mfma_f32_16x16x32_bf16 v[188:191], v[144:147], v[108:111], v[188:191]
v_mfma_f32_16x16x32_bf16 v[176:179], v[128:131], v[112:115], v[176:179]
v_mfma_f32_16x16x32_bf16 v[180:183], v[132:135], v[112:115], v[180:183]
v_mfma_f32_16x16x32_bf16 v[184:187], v[136:139], v[112:115], v[184:187]
v_mfma_f32_16x16x32_bf16 v[188:191], v[140:143], v[112:115], v[188:191]
v_mfma_f32_16x16x32_bf16 v[180:183], v[128:131], v[116:119], v[180:183]
v_mfma_f32_16x16x32_bf16 v[184:187], v[132:135], v[116:119], v[184:187]
v_mfma_f32_16x16x32_bf16 v[188:191], v[136:139], v[116:119], v[188:191]
v_mfma_f32_16x16x32_bf16 v[184:187], v[128:131], v[120:123], v[184:187]
v_mfma_f32_16x16x32_bf16 v[188:191], v[132:135], v[120:123], v[188:191]
v_mfma_f32_16x16x32_bf16 v[188:191], v[128:131], v[124:127], v[188:191]
s_waitcnt lgkmcnt(0)
v_mfma_f32_16x16x32_bf16 v[160:163], v[64:67], v[32:35], v[160:163]
ds_read_b128 v[96:99], v12 offset:448
v_mfma_f32_16x16x32_bf16 v[164:167], v[68:71], v[32:35], v[164:167]
ds_read_b64 v[128:129], v13 offset:4032
v_mfma_f32_16x16x32_bf16 v[168:171], v[72:75], v[32:35], v[168:171]
ds_read_b64 v[130:131], v13 offset:4040
v_mfma_f32_16x16x32_bf16 v[172:175], v[76:79], v[32:35], v[172:175]
ds_read_b128 v[100:103], v12 offset:960
v_mfma_f32_16x16x32_bf16 v[176:179], v[80:83], v[32:35], v[176:179]
ds_read_b64 v[132:133], v13 offset:3520
v_mfma_f32_16x16x32_bf16 v[180:183], v[84:87], v[32:35], v[180:183]
ds_read_b64 v[134:135], v13 offset:3528
v_mfma_f32_16x16x32_bf16 v[184:187], v[88:91], v[32:35], v[184:187]
ds_read_b128 v[104:107], v12 offset:1472
v_mfma_f32_16x16x32_bf16 v[188:191], v[92:95], v[32:35], v[188:191]
ds_read_b64 v[136:137], v13 offset:3008
v_mfma_f32_16x16x32_bf16 v[164:167], v[64:67], v[36:39], v[164:167]
ds_read_b64 v[138:139], v13 offset:3016
v_mfma_f32_16x16x32_bf16 v[168:171], v[68:71], v[36:39], v[168:171]
ds_read_b128 v[108:111], v12 offset:1984
v_mfma_f32_16x16x32_bf16 v[172:175], v[72:75], v[36:39], v[172:175]
ds_read_b64 v[140:141], v13 offset:2496
v_mfma_f32_16x16x32_bf16 v[176:179], v[76:79], v[36:39], v[176:179]
ds_read_b64 v[142:143], v13 offset:2504
v_mfma_f32_16x16x32_bf16 v[180:183], v[80:83], v[36:39], v[180:183]
ds_read_b128 v[112:115], v12 offset:2496
v_mfma_f32_16x16x32_bf16 v[184:187], v[84:87], v[36:39], v[184:187]
ds_read_b64 v[144:145], v13 offset:1984
v_mfma_f32_16x16x32_bf16 v[188:191], v[88:91], v[36:39], v[188:191]
ds_read_b64 v[146:147], v13 offset:1992
v_mfma_f32_16x16x32_bf16 v[168:171], v[64:67], v[40:43], v[168:171]
ds_read_b128 v[116:119], v12 offset:3008
v_mfma_f32_16x16x32_bf16 v[172:175], v[68:71], v[40:43], v[172:175]
ds_read_b64 v[148:149], v13 offset:1472
v_mfma_f32_16x16x32_bf16 v[176:179], v[72:75], v[40:43], v[176:179]
ds_read_b64 v[150:151], v13 offset:1480
v_mfma_f32_16x16x32_bf16 v[180:183], v[76:79], v[40:43], v[180:183]
ds_read_b128 v[120:123], v12 offset:3520
v_mfma_f32_16x16x32_bf16 v[184:187], v[80:83], v[40:43], v[184:187]
ds_read_b64 v[152:153], v13 offset:960
v_mfma_f32_16x16x32_bf16 v[188:191], v[84:87], v[40:43], v[188:191]
ds_read_b64 v[154:155], v13 offset:968
v_mfma_f32_16x16x32_bf16 v[172:175], v[64:67], v[44:47], v[172:175]
ds_read_b128 v[124:127], v12 offset:4032
v_mfma_f32_16x16x32_bf16 v[176:179], v[68:71], v[44:47], v[176:179]
ds_read_b64 v[156:157], v13 offset:448
v_mfma_f32_16x16x32_bf16 v[180:183], v[72:75], v[44:47], v[180:183]
ds_read_b64 v[158:159], v13 offset:456
v_mfma_f32_16x16x32_bf16 v[184:187], v[76:79], v[44:47], v[184:187]
v_mfma_f32_16x16x32_bf16 v[188:191], v[80:83], v[44:47], v[188:191]
v_mfma_f32_16x16x32_bf16 v[176:179], v[64:67], v[48:51], v[176:179]
v_mfma_f32_16x16x32_bf16 v[180:183], v[68:71], v[48:51], v[180:183]
v_mfma_f32_16x16x32_bf16 v[184:187], v[72:75], v[48:51], v[184:187]
v_mfma_f32_16x16x32_bf16 v[188:191], v[76:79], v[48:51], v[188:191]
v_mfma_f32_16x16x32_bf16 v[180:183], v[64:67], v[52:55], v[180:183]
v_mfma_f32_16x16x32_bf16 v[184:187], v[68:71], v[52:55], v[184:187]
v_mfma_f32_16x16x32_bf16 v[188:191], v[72:75], v[52:55], v[188:191]
v_mfma_f32_16x16x32_bf16 v[184:187], v[64:67], v[56:59], v[184:187]
v_mfma_f32_16x16x32_bf16 v[188:191], v[68:71], v[56:59], v[188:191]
v_mfma_f32_16x16x32_bf16 v[188:191], v[64:67], v[60:63], v[188:191]
s_waitcnt lgkmcnt(0)
v_mfma_f32_16x16x32_bf16 v[160:163], v[128:131], v[96:99], v[160:163]
v_mfma_f32_16x16x32_bf16 v[164:167], v[132:135], v[96:99], v[164:167]
v_mfma_f32_16x16x32_bf16 v[168:171], v[136:139], v[96:99], v[168:171]
v_mfma_f32_16x16x32_bf16 v[172:175], v[140:143], v[96:99], v[172:175]
v_mfma_f32_16x16x32_bf16 v[176:179], v[144:147], v[96:99], v[176:179]
v_mfma_f32_16x16x32_bf16 v[180:183], v[148:151], v[96:99], v[180:183]
v_mfma_f32_16x16x32_bf16 v[184:187], v[152:155], v[96:99], v[184:187]
v_mfma_f32_16x16x32_bf16 v[188:191], v[156:159], v[96:99], v[188:191]
v_mfma_f32_16x16x32_bf16 v[164:167], v[128:131], v[100:103], v[164:167]
v_mfma_f32_16x16x32_bf16 v[168:171], v[132:135], v[100:103], v[168:171]
v_mfma_f32_16x16x32_bf16 v[172:175], v[136:139], v[100:103], v[172:175]
v_mfma_f32_16x16x32_bf16 v[176:179], v[140:143], v[100:103], v[176:179]
v_mfma_f32_16x16x32_bf16 v[180:183], v[144:147], v[100:103], v[180:183]
v_mfma_f32_16x16x32_bf16 v[184:187], v[148:151], v[100:103], v[184:187]
v_mfma_f32_16x16x32_bf16 v[188:191], v[152:155], v[100:103], v[188:191]
v_mfma_f32_16x16x32_bf16 v[168:171], v[128:131], v[104:107], v[168:171]
v_mfma_f32_16x16x32_bf16 v[172:175], v[132:135], v[104:107], v[172:175]
v_mfma_f32_16x16x32_bf16 v[176:179], v[136:139], v[104:107], v[176:179]
v_mfma_f32_16x16x32_bf16 v[180:183], v[140:143], v[104:107], v[180:183]
v_mfma_f32_16x16x32_bf16 v[184:187], v[144:147], v[104:107], v[184:187]
v_mfma_f32_16x16x32_bf16 v[188:191], v[148:151], v[104:107], v[188:191]
v_mfma_f32_16x16x32_bf16 v[172:175], v[128:131], v[108:111], v[172:175]
v_mfma_f32_16x16x32_bf16 v[176:179], v[132:135], v[108:111], v[176:179]
v_mfma_f32_16x16x32_bf16 v[180:183], v[136:139], v[108:111], v[180:183]
v_mfma_f32_16x16x32_bf16 v[184:187], v[140:143], v[108:111], v[184:187]
v_mfma_f32_16x16x32_bf16 v[188:191], v[144:147], v[108:111], v[188:191]
v_mfma_f32_16x16x32_bf16 v[176:179], v[128:131], v[112:115], v[176:179]
v_mfma_f32_16x16x32_bf16 v[180:183], v[132:135], v[112:115], v[180:183]
v_mfma_f32_16x16x32_bf16 v[184:187], v[136:139], v[112:115], v[184:187]
v_mfma_f32_16x16x32_bf16 v[188:191], v[140:143], v[112:115], v[188:191]
v_mfma_f32_16x16x32_bf16 v[180:183], v[128:131], v[116:119], v[180:183]
v_mfma_f32_16x16x32_bf16 v[184:187], v[132:135], v[116:119], v[184:187]
v_mfma_f32_16x16x32_bf16 v[188:191], v[136:139], v[116:119], v[188:191]
v_mfma_f32_16x16x32_bf16 v[184:187], v[128:131], v[120:123], v[184:187]
v_mfma_f32_16x16x32_bf16 v[188:191], v[132:135], v[120:123], v[188:191]
v_mfma_f32_16x16x32_bf16 v[188:191], v[128:131], v[124:127], v[188:191]
v_lshlrev_b32 v197, 16, v197
v_mov_b32 v198, v240
s_cmp_eq_u32 s30, 1
s_cselect_b64 vcc, -1, 0
v_cndmask_b32 v198, v198, v241, vcc
s_cmp_eq_u32 s30, 2
s_cselect_b64 vcc, -1, 0
v_cndmask_b32 v198, v198, v242, vcc
s_cmp_eq_u32 s30, 3
s_cselect_b64 vcc, -1, 0
v_cndmask_b32 v198, v198, v243, vcc
v_and_b32 v11, 15, v1
v_lshlrev_b32 v11, 4, v11
v_bfe_u32 v12, v1, 4, 1
v_lshl_add_u32 v11, v12, 3, v11
v_lshrrev_b32 v12, 5, v1
v_lshl_add_u32 v11, v12, 8, v11
s_add_u32 s3, s35, 272
v_add_u32 v11, s3, v11
ds_read_b64 v[32:33], v11 offset:0
ds_read_b64 v[34:35], v11 offset:512
ds_read_b64 v[36:37], v11 offset:1024
ds_read_b64 v[38:39], v11 offset:1536
ds_read_b64 v[40:41], v11 offset:2048
ds_read_b64 v[42:43], v11 offset:2560
ds_read_b64 v[44:45], v11 offset:3072
ds_read_b64 v[46:47], v11 offset:3584
s_waitcnt lgkmcnt(7)
v_lshlrev_b32 v64, 16, v32
v_and_b32 v65, 0xffff0000, v32
v_fma_f32 v64, v64, v197, v160
v_fma_f32 v65, v65, v197, v161
v_mul_f32 v64, v64, v198
v_mul_f32 v65, v65, v198
v_cvt_pk_bf16_f32 v96, v64, v65
v_lshlrev_b32 v66, 16, v33
v_and_b32 v67, 0xffff0000, v33
v_fma_f32 v66, v66, v197, v162
v_fma_f32 v67, v67, v197, v163
v_mul_f32 v66, v66, v198
v_mul_f32 v67, v67, v198
v_cvt_pk_bf16_f32 v97, v66, v67
ds_write_b64 v11, v[96:97] offset:0
s_waitcnt lgkmcnt(7)
v_lshlrev_b32 v68, 16, v34
v_and_b32 v69, 0xffff0000, v34
v_fma_f32 v68, v68, v197, v164
v_fma_f32 v69, v69, v197, v165
v_mul_f32 v68, v68, v198
v_mul_f32 v69, v69, v198
v_cvt_pk_bf16_f32 v98, v68, v69
v_lshlrev_b32 v70, 16, v35
v_and_b32 v71, 0xffff0000, v35
v_fma_f32 v70, v70, v197, v166
v_fma_f32 v71, v71, v197, v167
v_mul_f32 v70, v70, v198
v_mul_f32 v71, v71, v198
v_cvt_pk_bf16_f32 v99, v70, v71
ds_write_b64 v11, v[98:99] offset:512
s_waitcnt lgkmcnt(7)
v_lshlrev_b32 v64, 16, v36
v_and_b32 v65, 0xffff0000, v36
v_fma_f32 v64, v64, v197, v168
v_fma_f32 v65, v65, v197, v169
v_mul_f32 v64, v64, v198
v_mul_f32 v65, v65, v198
v_cvt_pk_bf16_f32 v100, v64, v65
v_lshlrev_b32 v66, 16, v37
v_and_b32 v67, 0xffff0000, v37
v_fma_f32 v66, v66, v197, v170
v_fma_f32 v67, v67, v197, v171
v_mul_f32 v66, v66, v198
v_mul_f32 v67, v67, v198
v_cvt_pk_bf16_f32 v101, v66, v67
ds_write_b64 v11, v[100:101] offset:1024
s_waitcnt lgkmcnt(7)
v_lshlrev_b32 v68, 16, v38
v_and_b32 v69, 0xffff0000, v38
v_fma_f32 v68, v68, v197, v172
v_fma_f32 v69, v69, v197, v173
v_mul_f32 v68, v68, v198
v_mul_f32 v69, v69, v198
v_cvt_pk_bf16_f32 v102, v68, v69
v_lshlrev_b32 v70, 16, v39
v_and_b32 v71, 0xffff0000, v39
v_fma_f32 v70, v70, v197, v174
v_fma_f32 v71, v71, v197, v175
v_mul_f32 v70, v70, v198
v_mul_f32 v71, v71, v198
v_cvt_pk_bf16_f32 v103, v70, v71
ds_write_b64 v11, v[102:103] offset:1536
s_waitcnt lgkmcnt(7)
v_lshlrev_b32 v64, 16, v40
v_and_b32 v65, 0xffff0000, v40
v_fma_f32 v64, v64, v197, v176
v_fma_f32 v65, v65, v197, v177
v_mul_f32 v64, v64, v198
v_mul_f32 v65, v65, v198
v_cvt_pk_bf16_f32 v104, v64, v65
v_lshlrev_b32 v66, 16, v41
v_and_b32 v67, 0xffff0000, v41
v_fma_f32 v66, v66, v197, v178
v_fma_f32 v67, v67, v197, v179
v_mul_f32 v66, v66, v198
v_mul_f32 v67, v67, v198
v_cvt_pk_bf16_f32 v105, v66, v67
ds_write_b64 v11, v[104:105] offset:2048
s_waitcnt lgkmcnt(7)
v_lshlrev_b32 v68, 16, v42
v_and_b32 v69, 0xffff0000, v42
v_fma_f32 v68, v68, v197, v180
v_fma_f32 v69, v69, v197, v181
v_mul_f32 v68, v68, v198
v_mul_f32 v69, v69, v198
v_cvt_pk_bf16_f32 v106, v68, v69
v_lshlrev_b32 v70, 16, v43
v_and_b32 v71, 0xffff0000, v43
v_fma_f32 v70, v70, v197, v182
v_fma_f32 v71, v71, v197, v183
v_mul_f32 v70, v70, v198
v_mul_f32 v71, v71, v198
v_cvt_pk_bf16_f32 v107, v70, v71
ds_write_b64 v11, v[106:107] offset:2560
s_waitcnt lgkmcnt(7)
v_lshlrev_b32 v64, 16, v44
v_and_b32 v65, 0xffff0000, v44
v_fma_f32 v64, v64, v197, v184
v_fma_f32 v65, v65, v197, v185
v_mul_f32 v64, v64, v198
v_mul_f32 v65, v65, v198
v_cvt_pk_bf16_f32 v108, v64, v65
v_lshlrev_b32 v66, 16, v45
v_and_b32 v67, 0xffff0000, v45
v_fma_f32 v66, v66, v197, v186
v_fma_f32 v67, v67, v197, v187
v_mul_f32 v66, v66, v198
v_mul_f32 v67, v67, v198
v_cvt_pk_bf16_f32 v109, v66, v67
ds_write_b64 v11, v[108:109] offset:3072
s_waitcnt lgkmcnt(7)
v_lshlrev_b32 v68, 16, v46
v_and_b32 v69, 0xffff0000, v46
v_fma_f32 v68, v68, v197, v188
v_fma_f32 v69, v69, v197, v189
v_mul_f32 v68, v68, v198
v_mul_f32 v69, v69, v198
v_cvt_pk_bf16_f32 v110, v68, v69
v_lshlrev_b32 v70, 16, v47
v_and_b32 v71, 0xffff0000, v47
v_fma_f32 v70, v70, v197, v190
v_fma_f32 v71, v71, v197, v191
v_mul_f32 v70, v70, v198
v_mul_f32 v71, v71, v198
v_cvt_pk_bf16_f32 v111, v70, v71
ds_write_b64 v11, v[110:111] offset:3584
s_waitcnt lgkmcnt(0)
s_barrier
ds_read_b32 v32, v199 offset:0
ds_read_b32 v33, v199 offset:4384
ds_read_b32 v34, v199 offset:8768
ds_read_b32 v35, v199 offset:13152
ds_read_b32 v36, v199 offset:256
ds_read_b32 v37, v199 offset:4640
ds_read_b32 v38, v199 offset:9024
ds_read_b32 v39, v199 offset:13408
ds_read_b32 v40, v199 offset:512
ds_read_b32 v41, v199 offset:4896
ds_read_b32 v42, v199 offset:9280
ds_read_b32 v43, v199 offset:13664
ds_read_b32 v44, v199 offset:768
ds_read_b32 v45, v199 offset:5152
ds_read_b32 v46, v199 offset:9536
ds_read_b32 v47, v199 offset:13920
s_add_u32 s26, s27, 65536
s_waitcnt lgkmcnt(12)
v_lshlrev_b32 v64, 16, v32
v_lshlrev_b32 v65, 16, v33
v_lshlrev_b32 v66, 16, v200
v_and_b32 v67, 0xffff0000, v200
v_add_f32 v64, v64, v66
v_add_f32 v65, v65, v67
v_cvt_pk_bf16_f32 v96, v64, v65
v_lshlrev_b32 v68, 16, v34
v_lshlrev_b32 v69, 16, v35
v_lshlrev_b32 v70, 16, v201
v_and_b32 v71, 0xffff0000, v201
v_add_f32 v68, v68, v70
v_add_f32 v69, v69, v71
v_cvt_pk_bf16_f32 v97, v68, v69
v_and_b32 v72, 0xffff0000, v32
v_and_b32 v73, 0xffff0000, v33
v_lshlrev_b32 v74, 16, v202
v_and_b32 v75, 0xffff0000, v202
v_add_f32 v72, v72, v74
v_add_f32 v73, v73, v75
v_cvt_pk_bf16_f32 v98, v72, v73
v_and_b32 v76, 0xffff0000, v34
v_and_b32 v77, 0xffff0000, v35
v_lshlrev_b32 v78, 16, v203
v_and_b32 v79, 0xffff0000, v203
v_add_f32 v76, v76, v78
v_add_f32 v77, v77, v79
v_cvt_pk_bf16_f32 v99, v76, v77
buffer_store_dwordx4 v[96:99], v3, s[20:23], s26 offen offset:0 sc0 sc1
s_waitcnt lgkmcnt(8)
v_lshlrev_b32 v64, 16, v36
v_lshlrev_b32 v65, 16, v37
v_lshlrev_b32 v66, 16, v204
v_and_b32 v67, 0xffff0000, v204
v_add_f32 v64, v64, v66
v_add_f32 v65, v65, v67
v_cvt_pk_bf16_f32 v100, v64, v65
v_lshlrev_b32 v68, 16, v38
v_lshlrev_b32 v69, 16, v39
v_lshlrev_b32 v70, 16, v205
v_and_b32 v71, 0xffff0000, v205
v_add_f32 v68, v68, v70
v_add_f32 v69, v69, v71
v_cvt_pk_bf16_f32 v101, v68, v69
v_and_b32 v72, 0xffff0000, v36
v_and_b32 v73, 0xffff0000, v37
v_lshlrev_b32 v74, 16, v206
v_and_b32 v75, 0xffff0000, v206
v_add_f32 v72, v72, v74
v_add_f32 v73, v73, v75
v_cvt_pk_bf16_f32 v102, v72, v73
v_and_b32 v76, 0xffff0000, v38
v_and_b32 v77, 0xffff0000, v39
v_lshlrev_b32 v78, 16, v207
v_and_b32 v79, 0xffff0000, v207
v_add_f32 v76, v76, v78
v_add_f32 v77, v77, v79
v_cvt_pk_bf16_f32 v103, v76, v77
buffer_store_dwordx4 v[100:103], v3, s[20:23], s26 offen offset:1024 sc0 sc1
s_waitcnt lgkmcnt(4)
v_lshlrev_b32 v64, 16, v40
v_lshlrev_b32 v65, 16, v41
v_lshlrev_b32 v66, 16, v208
v_and_b32 v67, 0xffff0000, v208
v_add_f32 v64, v64, v66
v_add_f32 v65, v65, v67
v_cvt_pk_bf16_f32 v104, v64, v65
v_lshlrev_b32 v68, 16, v42
v_lshlrev_b32 v69, 16, v43
v_lshlrev_b32 v70, 16, v209
v_and_b32 v71, 0xffff0000, v209
v_add_f32 v68, v68, v70
v_add_f32 v69, v69, v71
v_cvt_pk_bf16_f32 v105, v68, v69
v_and_b32 v72, 0xffff0000, v40
v_and_b32 v73, 0xffff0000, v41
v_lshlrev_b32 v74, 16, v210
v_and_b32 v75, 0xffff0000, v210
v_add_f32 v72, v72, v74
v_add_f32 v73, v73, v75
v_cvt_pk_bf16_f32 v106, v72, v73
v_and_b32 v76, 0xffff0000, v42
v_and_b32 v77, 0xffff0000, v43
v_lshlrev_b32 v78, 16, v211
v_and_b32 v79, 0xffff0000, v211
v_add_f32 v76, v76, v78
v_add_f32 v77, v77, v79
v_cvt_pk_bf16_f32 v107, v76, v77
buffer_store_dwordx4 v[104:107], v3, s[20:23], s26 offen offset:2048 sc0 sc1
s_waitcnt lgkmcnt(0)
v_lshlrev_b32 v64, 16, v44
v_lshlrev_b32 v65, 16, v45
v_lshlrev_b32 v66, 16, v212
v_and_b32 v67, 0xffff0000, v212
v_add_f32 v64, v64, v66
v_add_f32 v65, v65, v67
v_cvt_pk_bf16_f32 v108, v64, v65
v_lshlrev_b32 v68, 16, v46
v_lshlrev_b32 v69, 16, v47
v_lshlrev_b32 v70, 16, v213
v_and_b32 v71, 0xffff0000, v213
v_add_f32 v68, v68, v70
v_add_f32 v69, v69, v71
v_cvt_pk_bf16_f32 v109, v68, v69
v_and_b32 v72, 0xffff0000, v44
v_and_b32 v73, 0xffff0000, v45
v_lshlrev_b32 v74, 16, v214
v_and_b32 v75, 0xffff0000, v214
v_add_f32 v72, v72, v74
v_add_f32 v73, v73, v75
v_cvt_pk_bf16_f32 v110, v72, v73
v_and_b32 v76, 0xffff0000, v46
v_and_b32 v77, 0xffff0000, v47
v_lshlrev_b32 v78, 16, v215
v_and_b32 v79, 0xffff0000, v215
v_add_f32 v76, v76, v78
v_add_f32 v77, v77, v79
v_cvt_pk_bf16_f32 v111, v76, v77
buffer_store_dwordx4 v[108:111], v3, s[20:23], s26 offen offset:3072 sc0 sc1
s_branch KB_FIN
KB_R:
s_cmp_ge_u32 s2, 224
s_cbranch_scc1 KB_RD
s_load_dwordx4 s[4:7], s[0:1], 64
s_load_dwordx2 s[8:9], s[0:1], 120
s_sub_u32 s3, s2, 160
s_and_b32 s26, s3, 1
s_bfe_u32 s27, s3, 0x10001
s_lshr_b32 s28, s3, 2
v_mul_u32_u24 v1, 43691, v0
v_lshrrev_b32 v1, 19, v1
v_mul_u32_u24 v2, 12, v1
v_sub_u32 v2, v0, v2
v_mul_u32_u24 v3, 3072, v1
v_lshl_add_u32 v3, v2, 4, v3
v_lshlrev_b32 v4, 2, v1
v_lshlrev_b32 v5, 4, v0
v_cmp_gt_u32 vcc, 192, v0
s_and_saveexec_b64 s[40:41], vcc
s_waitcnt lgkmcnt(0)
s_cmp_eq_u32 s26, 0
s_cselect_b32 s4, s4, s6
s_cselect_b32 s5, s5, s7
s_mov_b32 s12, s4
s_mov_b32 s13, s5
s_mov_b32 s14, 1966080
s_mov_b32 s15, 0x00020000
s_mov_b32 s20, s8
s_mov_b32 s21, s9
s_mov_b32 s22, 268435456
s_mov_b32 s23, 0x00020000
s_cbranch_execz RWX_3
s_mul_i32 s29, s27, 983040
s_mul_i32 s3, s28, 192
s_add_u32 s29, s29, s3
buffer_load_dwordx4 v[32:35], v3, s[12:15], s29 offen
s_add_u32 s29, s29, 49152
buffer_load_dwordx4 v[36:39], v3, s[12:15], s29 offen
s_add_u32 s29, s29, 49152
buffer_load_dwordx4 v[40:43], v3, s[12:15], s29 offen
s_add_u32 s29, s29, 49152
buffer_load_dwordx4 v[44:47], v3, s[12:15], s29 offen
s_add_u32 s29, s29, 49152
buffer_load_dwordx4 v[48:51], v3, s[12:15], s29 offen
s_add_u32 s29, s29, 49152
buffer_load_dwordx4 v[52:55], v3, s[12:15], s29 offen
s_add_u32 s29, s29, 49152
buffer_load_dwordx4 v[56:59], v3, s[12:15], s29 offen
s_add_u32 s29, s29, 49152
buffer_load_dwordx4 v[60:63], v3, s[12:15], s29 offen
s_add_u32 s29, s29, 49152
buffer_load_dwordx4 v[64:67], v3, s[12:15], s29 offen
s_add_u32 s29, s29, 49152
buffer_load_dwordx4 v[68:71], v3, s[12:15], s29 offen
s_add_u32 s29, s29, 49152
buffer_load_dwordx4 v[72:75], v3, s[12:15], s29 offen
s_add_u32 s29, s29, 49152
buffer_load_dwordx4 v[76:79], v3, s[12:15], s29 offen
s_add_u32 s29, s29, 49152
buffer_load_dwordx4 v[80:83], v3, s[12:15], s29 offen
s_add_u32 s29, s29, 49152
buffer_load_dwordx4 v[84:87], v3, s[12:15], s29 offen
s_add_u32 s29, s29, 49152
buffer_load_dwordx4 v[88:91], v3, s[12:15], s29 offen
s_add_u32 s29, s29, 49152
buffer_load_dwordx4 v[92:95], v3, s[12:15], s29 offen
s_add_u32 s29, s29, 49152
buffer_load_dwordx4 v[96:99], v3, s[12:15], s29 offen
s_add_u32 s29, s29, 49152
buffer_load_dwordx4 v[100:103], v3, s[12:15], s29 offen
s_add_u32 s29, s29, 49152
buffer_load_dwordx4 v[104:107], v3, s[12:15], s29 offen
s_add_u32 s29, s29, 49152
buffer_load_dwordx4 v[108:111], v3, s[12:15], s29 offen
s_mul_i32 s3, s27, 1280
s_add_u32 s30, s3, 7680
s_add_u32 s31, s3, 10240
buffer_load_dword v112, v4, s[20:23], s31 offen offset:0
buffer_load_dword v132, v4, s[20:23], s30 offen offset:0
buffer_load_dword v113, v4, s[20:23], s31 offen offset:64
buffer_load_dword v133, v4, s[20:23], s30 offen offset:64
buffer_load_dword v114, v4, s[20:23], s31 offen offset:128
buffer_load_dword v134, v4, s[20:23], s30 offen offset:128
buffer_load_dword v115, v4, s[20:23], s31 offen offset:192
buffer_load_dword v135, v4, s[20:23], s30 offen offset:192
buffer_load_dword v116, v4, s[20:23], s31 offen offset:256
buffer_load_dword v136, v4, s[20:23], s30 offen offset:256
buffer_load_dword v117, v4, s[20:23], s31 offen offset:320
buffer_load_dword v137, v4, s[20:23], s30 offen offset:320
buffer_load_dword v118, v4, s[20:23], s31 offen offset:384
buffer_load_dword v138, v4, s[20:23], s30 offen offset:384
buffer_load_dword v119, v4, s[20:23], s31 offen offset:448
buffer_load_dword v139, v4, s[20:23], s30 offen offset:448
buffer_load_dword v120, v4, s[20:23], s31 offen offset:512
buffer_load_dword v140, v4, s[20:23], s30 offen offset:512
buffer_load_dword v121, v4, s[20:23], s31 offen offset:576
buffer_load_dword v141, v4, s[20:23], s30 offen offset:576
buffer_load_dword v122, v4, s[20:23], s31 offen offset:640
buffer_load_dword v142, v4, s[20:23], s30 offen offset:640
buffer_load_dword v123, v4, s[20:23], s31 offen offset:704
buffer_load_dword v143, v4, s[20:23], s30 offen offset:704
buffer_load_dword v124, v4, s[20:23], s31 offen offset:768
buffer_load_dword v144, v4, s[20:23], s30 offen offset:768
buffer_load_dword v125, v4, s[20:23], s31 offen offset:832
buffer_load_dword v145, v4, s[20:23], s30 offen offset:832
buffer_load_dword v126, v4, s[20:23], s31 offen offset:896
buffer_load_dword v146, v4, s[20:23], s30 offen offset:896
buffer_load_dword v127, v4, s[20:23], s31 offen offset:960
buffer_load_dword v147, v4, s[20:23], s30 offen offset:960
buffer_load_dword v128, v4, s[20:23], s31 offen offset:1024
buffer_load_dword v148, v4, s[20:23], s30 offen offset:1024
buffer_load_dword v129, v4, s[20:23], s31 offen offset:1088
buffer_load_dword v149, v4, s[20:23], s30 offen offset:1088
buffer_load_dword v130, v4, s[20:23], s31 offen offset:1152
buffer_load_dword v150, v4, s[20:23], s30 offen offset:1152
buffer_load_dword v131, v4, s[20:23], s31 offen offset:1216
buffer_load_dword v151, v4, s[20:23], s30 offen offset:1216
v_mov_b32 v160, 0
v_mov_b32 v161, 0
v_mov_b32 v162, 0
v_mov_b32 v163, 0
v_mov_b32 v164, 0
v_mov_b32 v165, 0
v_mov_b32 v166, 0
v_mov_b32 v167, 0
v_mov_b32 v168, 0
v_mov_b32 v169, 0
v_mov_b32 v170, 0
v_mov_b32 v171, 0
v_mov_b32 v172, 0
v_mov_b32 v173, 0
v_mov_b32 v174, 0
v_mov_b32 v175, 0
s_mul_i32 s29, s28, 245760
s_mul_i32 s3, s27, 122880
s_add_u32 s29, s29, s3
s_mul_i32 s3, s26, 6144
s_add_u32 s29, s29, s3
s_add_u32 s29, s29, 16777216
s_waitcnt vmcnt(38)
v_add_f32 v112, 1.0, v112
v_cvt_pk_bf16_f32 v112, v112, v112
v_and_b32 v112, 0xffff0000, v112
v_lshlrev_b32 v8, 16, v32
v_and_b32 v9, 0xffff0000, v32
v_fmac_f32 v168, v8, v132
v_fmac_f32 v169, v9, v132
v_mul_f32 v8, v8, v112
v_mul_f32 v9, v9, v112
v_cvt_pk_bf16_f32 v32, v8, v9
v_lshlrev_b32 v10, 16, v32
v_and_b32 v11, 0xffff0000, v32
v_add_f32 v160, v160, v10
v_add_f32 v161, v161, v11
v_lshlrev_b32 v12, 16, v33
v_and_b32 v13, 0xffff0000, v33
v_fmac_f32 v170, v12, v132
v_fmac_f32 v171, v13, v132
v_mul_f32 v12, v12, v112
v_mul_f32 v13, v13, v112
v_cvt_pk_bf16_f32 v33, v12, v13
v_lshlrev_b32 v14, 16, v33
v_and_b32 v15, 0xffff0000, v33
v_add_f32 v162, v162, v14
v_add_f32 v163, v163, v15
v_lshlrev_b32 v8, 16, v34
v_and_b32 v9, 0xffff0000, v34
v_fmac_f32 v172, v8, v132
v_fmac_f32 v173, v9, v132
v_mul_f32 v8, v8, v112
v_mul_f32 v9, v9, v112
v_cvt_pk_bf16_f32 v34, v8, v9
v_lshlrev_b32 v10, 16, v34
v_and_b32 v11, 0xffff0000, v34
v_add_f32 v164, v164, v10
v_add_f32 v165, v165, v11
v_lshlrev_b32 v12, 16, v35
v_and_b32 v13, 0xffff0000, v35
v_fmac_f32 v174, v12, v132
v_fmac_f32 v175, v13, v132
v_mul_f32 v12, v12, v112
v_mul_f32 v13, v13, v112
v_cvt_pk_bf16_f32 v35, v12, v13
v_lshlrev_b32 v14, 16, v35
v_and_b32 v15, 0xffff0000, v35
v_add_f32 v166, v166, v14
v_add_f32 v167, v167, v15
s_add_u32 s3, s29, 0
buffer_store_dwordx4 v[32:35], v5, s[20:23], s3 offen sc0 sc1
s_waitcnt vmcnt(37)
v_add_f32 v113, 1.0, v113
v_cvt_pk_bf16_f32 v113, v113, v113
v_and_b32 v113, 0xffff0000, v113
v_lshlrev_b32 v8, 16, v36
v_and_b32 v9, 0xffff0000, v36
v_fmac_f32 v168, v8, v133
v_fmac_f32 v169, v9, v133
v_mul_f32 v8, v8, v113
v_mul_f32 v9, v9, v113
v_cvt_pk_bf16_f32 v36, v8, v9
v_lshlrev_b32 v10, 16, v36
v_and_b32 v11, 0xffff0000, v36
v_add_f32 v160, v160, v10
v_add_f32 v161, v161, v11
v_lshlrev_b32 v12, 16, v37
v_and_b32 v13, 0xffff0000, v37
v_fmac_f32 v170, v12, v133
v_fmac_f32 v171, v13, v133
v_mul_f32 v12, v12, v113
v_mul_f32 v13, v13, v113
v_cvt_pk_bf16_f32 v37, v12, v13
v_lshlrev_b32 v14, 16, v37
v_and_b32 v15, 0xffff0000, v37
v_add_f32 v162, v162, v14
v_add_f32 v163, v163, v15
v_lshlrev_b32 v8, 16, v38
v_and_b32 v9, 0xffff0000, v38
v_fmac_f32 v172, v8, v133
v_fmac_f32 v173, v9, v133
v_mul_f32 v8, v8, v113
v_mul_f32 v9, v9, v113
v_cvt_pk_bf16_f32 v38, v8, v9
v_lshlrev_b32 v10, 16, v38
v_and_b32 v11, 0xffff0000, v38
v_add_f32 v164, v164, v10
v_add_f32 v165, v165, v11
v_lshlrev_b32 v12, 16, v39
v_and_b32 v13, 0xffff0000, v39
v_fmac_f32 v174, v12, v133
v_fmac_f32 v175, v13, v133
v_mul_f32 v12, v12, v113
v_mul_f32 v13, v13, v113
v_cvt_pk_bf16_f32 v39, v12, v13
v_lshlrev_b32 v14, 16, v39
v_and_b32 v15, 0xffff0000, v39
v_add_f32 v166, v166, v14
v_add_f32 v167, v167, v15
s_add_u32 s3, s29, 3072
buffer_store_dwordx4 v[36:39], v5, s[20:23], s3 offen sc0 sc1
s_waitcnt vmcnt(36)
v_add_f32 v114, 1.0, v114
v_cvt_pk_bf16_f32 v114, v114, v114
v_and_b32 v114, 0xffff0000, v114
v_lshlrev_b32 v8, 16, v40
v_and_b32 v9, 0xffff0000, v40
v_fmac_f32 v168, v8, v134
v_fmac_f32 v169, v9, v134
v_mul_f32 v8, v8, v114
v_mul_f32 v9, v9, v114
v_cvt_pk_bf16_f32 v40, v8, v9
v_lshlrev_b32 v10, 16, v40
v_and_b32 v11, 0xffff0000, v40
v_add_f32 v160, v160, v10
v_add_f32 v161, v161, v11
v_lshlrev_b32 v12, 16, v41
v_and_b32 v13, 0xffff0000, v41
v_fmac_f32 v170, v12, v134
v_fmac_f32 v171, v13, v134
v_mul_f32 v12, v12, v114
v_mul_f32 v13, v13, v114
v_cvt_pk_bf16_f32 v41, v12, v13
v_lshlrev_b32 v14, 16, v41
v_and_b32 v15, 0xffff0000, v41
v_add_f32 v162, v162, v14
v_add_f32 v163, v163, v15
v_lshlrev_b32 v8, 16, v42
v_and_b32 v9, 0xffff0000, v42
v_fmac_f32 v172, v8, v134
v_fmac_f32 v173, v9, v134
v_mul_f32 v8, v8, v114
v_mul_f32 v9, v9, v114
v_cvt_pk_bf16_f32 v42, v8, v9
v_lshlrev_b32 v10, 16, v42
v_and_b32 v11, 0xffff0000, v42
v_add_f32 v164, v164, v10
v_add_f32 v165, v165, v11
v_lshlrev_b32 v12, 16, v43
v_and_b32 v13, 0xffff0000, v43
v_fmac_f32 v174, v12, v134
v_fmac_f32 v175, v13, v134
v_mul_f32 v12, v12, v114
v_mul_f32 v13, v13, v114
v_cvt_pk_bf16_f32 v43, v12, v13
v_lshlrev_b32 v14, 16, v43
v_and_b32 v15, 0xffff0000, v43
v_add_f32 v166, v166, v14
v_add_f32 v167, v167, v15
s_add_u32 s3, s29, 12288
buffer_store_dwordx4 v[40:43], v5, s[20:23], s3 offen sc0 sc1
s_waitcnt vmcnt(35)
v_add_f32 v115, 1.0, v115
v_cvt_pk_bf16_f32 v115, v115, v115
v_and_b32 v115, 0xffff0000, v115
v_lshlrev_b32 v8, 16, v44
v_and_b32 v9, 0xffff0000, v44
v_fmac_f32 v168, v8, v135
v_fmac_f32 v169, v9, v135
v_mul_f32 v8, v8, v115
v_mul_f32 v9, v9, v115
v_cvt_pk_bf16_f32 v44, v8, v9
v_lshlrev_b32 v10, 16, v44
v_and_b32 v11, 0xffff0000, v44
v_add_f32 v160, v160, v10
v_add_f32 v161, v161, v11
v_lshlrev_b32 v12, 16, v45
v_and_b32 v13, 0xffff0000, v45
v_fmac_f32 v170, v12, v135
v_fmac_f32 v171, v13, v135
v_mul_f32 v12, v12, v115
v_mul_f32 v13, v13, v115
v_cvt_pk_bf16_f32 v45, v12, v13
v_lshlrev_b32 v14, 16, v45
v_and_b32 v15, 0xffff0000, v45
v_add_f32 v162, v162, v14
v_add_f32 v163, v163, v15
v_lshlrev_b32 v8, 16, v46
v_and_b32 v9, 0xffff0000, v46
v_fmac_f32 v172, v8, v135
v_fmac_f32 v173, v9, v135
v_mul_f32 v8, v8, v115
v_mul_f32 v9, v9, v115
v_cvt_pk_bf16_f32 v46, v8, v9
v_lshlrev_b32 v10, 16, v46
v_and_b32 v11, 0xffff0000, v46
v_add_f32 v164, v164, v10
v_add_f32 v165, v165, v11
v_lshlrev_b32 v12, 16, v47
v_and_b32 v13, 0xffff0000, v47
v_fmac_f32 v174, v12, v135
v_fmac_f32 v175, v13, v135
v_mul_f32 v12, v12, v115
v_mul_f32 v13, v13, v115
v_cvt_pk_bf16_f32 v47, v12, v13
v_lshlrev_b32 v14, 16, v47
v_and_b32 v15, 0xffff0000, v47
v_add_f32 v166, v166, v14
v_add_f32 v167, v167, v15
s_add_u32 s3, s29, 15360
buffer_store_dwordx4 v[44:47], v5, s[20:23], s3 offen sc0 sc1
s_waitcnt vmcnt(34)
v_add_f32 v116, 1.0, v116
v_cvt_pk_bf16_f32 v116, v116, v116
v_and_b32 v116, 0xffff0000, v116
v_lshlrev_b32 v8, 16, v48
v_and_b32 v9, 0xffff0000, v48
v_fmac_f32 v168, v8, v136
v_fmac_f32 v169, v9, v136
v_mul_f32 v8, v8, v116
v_mul_f32 v9, v9, v116
v_cvt_pk_bf16_f32 v48, v8, v9
v_lshlrev_b32 v10, 16, v48
v_and_b32 v11, 0xffff0000, v48
v_add_f32 v160, v160, v10
v_add_f32 v161, v161, v11
v_lshlrev_b32 v12, 16, v49
v_and_b32 v13, 0xffff0000, v49
v_fmac_f32 v170, v12, v136
v_fmac_f32 v171, v13, v136
v_mul_f32 v12, v12, v116
v_mul_f32 v13, v13, v116
v_cvt_pk_bf16_f32 v49, v12, v13
v_lshlrev_b32 v14, 16, v49
v_and_b32 v15, 0xffff0000, v49
v_add_f32 v162, v162, v14
v_add_f32 v163, v163, v15
v_lshlrev_b32 v8, 16, v50
v_and_b32 v9, 0xffff0000, v50
v_fmac_f32 v172, v8, v136
v_fmac_f32 v173, v9, v136
v_mul_f32 v8, v8, v116
v_mul_f32 v9, v9, v116
v_cvt_pk_bf16_f32 v50, v8, v9
v_lshlrev_b32 v10, 16, v50
v_and_b32 v11, 0xffff0000, v50
v_add_f32 v164, v164, v10
v_add_f32 v165, v165, v11
v_lshlrev_b32 v12, 16, v51
v_and_b32 v13, 0xffff0000, v51
v_fmac_f32 v174, v12, v136
v_fmac_f32 v175, v13, v136
v_mul_f32 v12, v12, v116
v_mul_f32 v13, v13, v116
v_cvt_pk_bf16_f32 v51, v12, v13
v_lshlrev_b32 v14, 16, v51
v_and_b32 v15, 0xffff0000, v51
v_add_f32 v166, v166, v14
v_add_f32 v167, v167, v15
s_add_u32 s3, s29, 24576
buffer_store_dwordx4 v[48:51], v5, s[20:23], s3 offen sc0 sc1
s_waitcnt vmcnt(33)
v_add_f32 v117, 1.0, v117
v_cvt_pk_bf16_f32 v117, v117, v117
v_and_b32 v117, 0xffff0000, v117
v_lshlrev_b32 v8, 16, v52
v_and_b32 v9, 0xffff0000, v52
v_fmac_f32 v168, v8, v137
v_fmac_f32 v169, v9, v137
v_mul_f32 v8, v8, v117
v_mul_f32 v9, v9, v117
v_cvt_pk_bf16_f32 v52, v8, v9
v_lshlrev_b32 v10, 16, v52
v_and_b32 v11, 0xffff0000, v52
v_add_f32 v160, v160, v10
v_add_f32 v161, v161, v11
v_lshlrev_b32 v12, 16, v53
v_and_b32 v13, 0xffff0000, v53
v_fmac_f32 v170, v12, v137
v_fmac_f32 v171, v13, v137
v_mul_f32 v12, v12, v117
v_mul_f32 v13, v13, v117
v_cvt_pk_bf16_f32 v53, v12, v13
v_lshlrev_b32 v14, 16, v53
v_and_b32 v15, 0xffff0000, v53
v_add_f32 v162, v162, v14
v_add_f32 v163, v163, v15
v_lshlrev_b32 v8, 16, v54
v_and_b32 v9, 0xffff0000, v54
v_fmac_f32 v172, v8, v137
v_fmac_f32 v173, v9, v137
v_mul_f32 v8, v8, v117
v_mul_f32 v9, v9, v117
v_cvt_pk_bf16_f32 v54, v8, v9
v_lshlrev_b32 v10, 16, v54
v_and_b32 v11, 0xffff0000, v54
v_add_f32 v164, v164, v10
v_add_f32 v165, v165, v11
v_lshlrev_b32 v12, 16, v55
v_and_b32 v13, 0xffff0000, v55
v_fmac_f32 v174, v12, v137
v_fmac_f32 v175, v13, v137
v_mul_f32 v12, v12, v117
v_mul_f32 v13, v13, v117
v_cvt_pk_bf16_f32 v55, v12, v13
v_lshlrev_b32 v14, 16, v55
v_and_b32 v15, 0xffff0000, v55
v_add_f32 v166, v166, v14
v_add_f32 v167, v167, v15
s_add_u32 s3, s29, 27648
buffer_store_dwordx4 v[52:55], v5, s[20:23], s3 offen sc0 sc1
s_waitcnt vmcnt(32)
v_add_f32 v118, 1.0, v118
v_cvt_pk_bf16_f32 v118, v118, v118
v_and_b32 v118, 0xffff0000, v118
v_lshlrev_b32 v8, 16, v56
v_and_b32 v9, 0xffff0000, v56
v_fmac_f32 v168, v8, v138
v_fmac_f32 v169, v9, v138
v_mul_f32 v8, v8, v118
v_mul_f32 v9, v9, v118
v_cvt_pk_bf16_f32 v56, v8, v9
v_lshlrev_b32 v10, 16, v56
v_and_b32 v11, 0xffff0000, v56
v_add_f32 v160, v160, v10
v_add_f32 v161, v161, v11
v_lshlrev_b32 v12, 16, v57
v_and_b32 v13, 0xffff0000, v57
v_fmac_f32 v170, v12, v138
v_fmac_f32 v171, v13, v138
v_mul_f32 v12, v12, v118
v_mul_f32 v13, v13, v118
v_cvt_pk_bf16_f32 v57, v12, v13
v_lshlrev_b32 v14, 16, v57
v_and_b32 v15, 0xffff0000, v57
v_add_f32 v162, v162, v14
v_add_f32 v163, v163, v15
v_lshlrev_b32 v8, 16, v58
v_and_b32 v9, 0xffff0000, v58
v_fmac_f32 v172, v8, v138
v_fmac_f32 v173, v9, v138
v_mul_f32 v8, v8, v118
v_mul_f32 v9, v9, v118
v_cvt_pk_bf16_f32 v58, v8, v9
v_lshlrev_b32 v10, 16, v58
v_and_b32 v11, 0xffff0000, v58
v_add_f32 v164, v164, v10
v_add_f32 v165, v165, v11
v_lshlrev_b32 v12, 16, v59
v_and_b32 v13, 0xffff0000, v59
v_fmac_f32 v174, v12, v138
v_fmac_f32 v175, v13, v138
v_mul_f32 v12, v12, v118
v_mul_f32 v13, v13, v118
v_cvt_pk_bf16_f32 v59, v12, v13
v_lshlrev_b32 v14, 16, v59
v_and_b32 v15, 0xffff0000, v59
v_add_f32 v166, v166, v14
v_add_f32 v167, v167, v15
s_add_u32 s3, s29, 36864
buffer_store_dwordx4 v[56:59], v5, s[20:23], s3 offen sc0 sc1
s_waitcnt vmcnt(31)
v_add_f32 v119, 1.0, v119
v_cvt_pk_bf16_f32 v119, v119, v119
v_and_b32 v119, 0xffff0000, v119
v_lshlrev_b32 v8, 16, v60
v_and_b32 v9, 0xffff0000, v60
v_fmac_f32 v168, v8, v139
v_fmac_f32 v169, v9, v139
v_mul_f32 v8, v8, v119
v_mul_f32 v9, v9, v119
v_cvt_pk_bf16_f32 v60, v8, v9
v_lshlrev_b32 v10, 16, v60
v_and_b32 v11, 0xffff0000, v60
v_add_f32 v160, v160, v10
v_add_f32 v161, v161, v11
v_lshlrev_b32 v12, 16, v61
v_and_b32 v13, 0xffff0000, v61
v_fmac_f32 v170, v12, v139
v_fmac_f32 v171, v13, v139
v_mul_f32 v12, v12, v119
v_mul_f32 v13, v13, v119
v_cvt_pk_bf16_f32 v61, v12, v13
v_lshlrev_b32 v14, 16, v61
v_and_b32 v15, 0xffff0000, v61
v_add_f32 v162, v162, v14
v_add_f32 v163, v163, v15
v_lshlrev_b32 v8, 16, v62
v_and_b32 v9, 0xffff0000, v62
v_fmac_f32 v172, v8, v139
v_fmac_f32 v173, v9, v139
v_mul_f32 v8, v8, v119
v_mul_f32 v9, v9, v119
v_cvt_pk_bf16_f32 v62, v8, v9
v_lshlrev_b32 v10, 16, v62
v_and_b32 v11, 0xffff0000, v62
v_add_f32 v164, v164, v10
v_add_f32 v165, v165, v11
v_lshlrev_b32 v12, 16, v63
v_and_b32 v13, 0xffff0000, v63
v_fmac_f32 v174, v12, v139
v_fmac_f32 v175, v13, v139
v_mul_f32 v12, v12, v119
v_mul_f32 v13, v13, v119
v_cvt_pk_bf16_f32 v63, v12, v13
v_lshlrev_b32 v14, 16, v63
v_and_b32 v15, 0xffff0000, v63
v_add_f32 v166, v166, v14
v_add_f32 v167, v167, v15
s_add_u32 s3, s29, 39936
buffer_store_dwordx4 v[60:63], v5, s[20:23], s3 offen sc0 sc1
s_waitcnt vmcnt(30)
v_add_f32 v120, 1.0, v120
v_cvt_pk_bf16_f32 v120, v120, v120
v_and_b32 v120, 0xffff0000, v120
v_lshlrev_b32 v8, 16, v64
v_and_b32 v9, 0xffff0000, v64
v_fmac_f32 v168, v8, v140
v_fmac_f32 v169, v9, v140
v_mul_f32 v8, v8, v120
v_mul_f32 v9, v9, v120
v_cvt_pk_bf16_f32 v64, v8, v9
v_lshlrev_b32 v10, 16, v64
v_and_b32 v11, 0xffff0000, v64
v_add_f32 v160, v160, v10
v_add_f32 v161, v161, v11
v_lshlrev_b32 v12, 16, v65
v_and_b32 v13, 0xffff0000, v65
v_fmac_f32 v170, v12, v140
v_fmac_f32 v171, v13, v140
v_mul_f32 v12, v12, v120
v_mul_f32 v13, v13, v120
v_cvt_pk_bf16_f32 v65, v12, v13
v_lshlrev_b32 v14, 16, v65
v_and_b32 v15, 0xffff0000, v65
v_add_f32 v162, v162, v14
v_add_f32 v163, v163, v15
v_lshlrev_b32 v8, 16, v66
v_and_b32 v9, 0xffff0000, v66
v_fmac_f32 v172, v8, v140
v_fmac_f32 v173, v9, v140
v_mul_f32 v8, v8, v120
v_mul_f32 v9, v9, v120
v_cvt_pk_bf16_f32 v66, v8, v9
v_lshlrev_b32 v10, 16, v66
v_and_b32 v11, 0xffff0000, v66
v_add_f32 v164, v164, v10
v_add_f32 v165, v165, v11
v_lshlrev_b32 v12, 16, v67
v_and_b32 v13, 0xffff0000, v67
v_fmac_f32 v174, v12, v140
v_fmac_f32 v175, v13, v140
v_mul_f32 v12, v12, v120
v_mul_f32 v13, v13, v120
v_cvt_pk_bf16_f32 v67, v12, v13
v_lshlrev_b32 v14, 16, v67
v_and_b32 v15, 0xffff0000, v67
v_add_f32 v166, v166, v14
v_add_f32 v167, v167, v15
s_add_u32 s3, s29, 49152
buffer_store_dwordx4 v[64:67], v5, s[20:23], s3 offen sc0 sc1
s_waitcnt vmcnt(29)
v_add_f32 v121, 1.0, v121
v_cvt_pk_bf16_f32 v121, v121, v121
v_and_b32 v121, 0xffff0000, v121
v_lshlrev_b32 v8, 16, v68
v_and_b32 v9, 0xffff0000, v68
v_fmac_f32 v168, v8, v141
v_fmac_f32 v169, v9, v141
v_mul_f32 v8, v8, v121
v_mul_f32 v9, v9, v121
v_cvt_pk_bf16_f32 v68, v8, v9
v_lshlrev_b32 v10, 16, v68
v_and_b32 v11, 0xffff0000, v68
v_add_f32 v160, v160, v10
v_add_f32 v161, v161, v11
v_lshlrev_b32 v12, 16, v69
v_and_b32 v13, 0xffff0000, v69
v_fmac_f32 v170, v12, v141
v_fmac_f32 v171, v13, v141
v_mul_f32 v12, v12, v121
v_mul_f32 v13, v13, v121
v_cvt_pk_bf16_f32 v69, v12, v13
v_lshlrev_b32 v14, 16, v69
v_and_b32 v15, 0xffff0000, v69
v_add_f32 v162, v162, v14
v_add_f32 v163, v163, v15
v_lshlrev_b32 v8, 16, v70
v_and_b32 v9, 0xffff0000, v70
v_fmac_f32 v172, v8, v141
v_fmac_f32 v173, v9, v141
v_mul_f32 v8, v8, v121
v_mul_f32 v9, v9, v121
v_cvt_pk_bf16_f32 v70, v8, v9
v_lshlrev_b32 v10, 16, v70
v_and_b32 v11, 0xffff0000, v70
v_add_f32 v164, v164, v10
v_add_f32 v165, v165, v11
v_lshlrev_b32 v12, 16, v71
v_and_b32 v13, 0xffff0000, v71
v_fmac_f32 v174, v12, v141
v_fmac_f32 v175, v13, v141
v_mul_f32 v12, v12, v121
v_mul_f32 v13, v13, v121
v_cvt_pk_bf16_f32 v71, v12, v13
v_lshlrev_b32 v14, 16, v71
v_and_b32 v15, 0xffff0000, v71
v_add_f32 v166, v166, v14
v_add_f32 v167, v167, v15
s_add_u32 s3, s29, 52224
buffer_store_dwordx4 v[68:71], v5, s[20:23], s3 offen sc0 sc1
s_waitcnt vmcnt(28)
v_add_f32 v122, 1.0, v122
v_cvt_pk_bf16_f32 v122, v122, v122
v_and_b32 v122, 0xffff0000, v122
v_lshlrev_b32 v8, 16, v72
v_and_b32 v9, 0xffff0000, v72
v_fmac_f32 v168, v8, v142
v_fmac_f32 v169, v9, v142
v_mul_f32 v8, v8, v122
v_mul_f32 v9, v9, v122
v_cvt_pk_bf16_f32 v72, v8, v9
v_lshlrev_b32 v10, 16, v72
v_and_b32 v11, 0xffff0000, v72
v_add_f32 v160, v160, v10
v_add_f32 v161, v161, v11
v_lshlrev_b32 v12, 16, v73
v_and_b32 v13, 0xffff0000, v73
v_fmac_f32 v170, v12, v142
v_fmac_f32 v171, v13, v142
v_mul_f32 v12, v12, v122
v_mul_f32 v13, v13, v122
v_cvt_pk_bf16_f32 v73, v12, v13
v_lshlrev_b32 v14, 16, v73
v_and_b32 v15, 0xffff0000, v73
v_add_f32 v162, v162, v14
v_add_f32 v163, v163, v15
v_lshlrev_b32 v8, 16, v74
v_and_b32 v9, 0xffff0000, v74
v_fmac_f32 v172, v8, v142
v_fmac_f32 v173, v9, v142
v_mul_f32 v8, v8, v122
v_mul_f32 v9, v9, v122
v_cvt_pk_bf16_f32 v74, v8, v9
v_lshlrev_b32 v10, 16, v74
v_and_b32 v11, 0xffff0000, v74
v_add_f32 v164, v164, v10
v_add_f32 v165, v165, v11
v_lshlrev_b32 v12, 16, v75
v_and_b32 v13, 0xffff0000, v75
v_fmac_f32 v174, v12, v142
v_fmac_f32 v175, v13, v142
v_mul_f32 v12, v12, v122
v_mul_f32 v13, v13, v122
v_cvt_pk_bf16_f32 v75, v12, v13
v_lshlrev_b32 v14, 16, v75
v_and_b32 v15, 0xffff0000, v75
v_add_f32 v166, v166, v14
v_add_f32 v167, v167, v15
s_add_u32 s3, s29, 61440
buffer_store_dwordx4 v[72:75], v5, s[20:23], s3 offen sc0 sc1
s_waitcnt vmcnt(27)
v_add_f32 v123, 1.0, v123
v_cvt_pk_bf16_f32 v123, v123, v123
v_and_b32 v123, 0xffff0000, v123
v_lshlrev_b32 v8, 16, v76
v_and_b32 v9, 0xffff0000, v76
v_fmac_f32 v168, v8, v143
v_fmac_f32 v169, v9, v143
v_mul_f32 v8, v8, v123
v_mul_f32 v9, v9, v123
v_cvt_pk_bf16_f32 v76, v8, v9
v_lshlrev_b32 v10, 16, v76
v_and_b32 v11, 0xffff0000, v76
v_add_f32 v160, v160, v10
v_add_f32 v161, v161, v11
v_lshlrev_b32 v12, 16, v77
v_and_b32 v13, 0xffff0000, v77
v_fmac_f32 v170, v12, v143
v_fmac_f32 v171, v13, v143
v_mul_f32 v12, v12, v123
v_mul_f32 v13, v13, v123
v_cvt_pk_bf16_f32 v77, v12, v13
v_lshlrev_b32 v14, 16, v77
v_and_b32 v15, 0xffff0000, v77
v_add_f32 v162, v162, v14
v_add_f32 v163, v163, v15
v_lshlrev_b32 v8, 16, v78
v_and_b32 v9, 0xffff0000, v78
v_fmac_f32 v172, v8, v143
v_fmac_f32 v173, v9, v143
v_mul_f32 v8, v8, v123
v_mul_f32 v9, v9, v123
v_cvt_pk_bf16_f32 v78, v8, v9
v_lshlrev_b32 v10, 16, v78
v_and_b32 v11, 0xffff0000, v78
v_add_f32 v164, v164, v10
v_add_f32 v165, v165, v11
v_lshlrev_b32 v12, 16, v79
v_and_b32 v13, 0xffff0000, v79
v_fmac_f32 v174, v12, v143
v_fmac_f32 v175, v13, v143
v_mul_f32 v12, v12, v123
v_mul_f32 v13, v13, v123
v_cvt_pk_bf16_f32 v79, v12, v13
v_lshlrev_b32 v14, 16, v79
v_and_b32 v15, 0xffff0000, v79
v_add_f32 v166, v166, v14
v_add_f32 v167, v167, v15
s_add_u32 s3, s29, 64512
buffer_store_dwordx4 v[76:79], v5, s[20:23], s3 offen sc0 sc1
s_waitcnt vmcnt(26)
v_add_f32 v124, 1.0, v124
v_cvt_pk_bf16_f32 v124, v124, v124
v_and_b32 v124, 0xffff0000, v124
v_lshlrev_b32 v8, 16, v80
v_and_b32 v9, 0xffff0000, v80
v_fmac_f32 v168, v8, v144
v_fmac_f32 v169, v9, v144
v_mul_f32 v8, v8, v124
v_mul_f32 v9, v9, v124
v_cvt_pk_bf16_f32 v80, v8, v9
v_lshlrev_b32 v10, 16, v80
v_and_b32 v11, 0xffff0000, v80
v_add_f32 v160, v160, v10
v_add_f32 v161, v161, v11
v_lshlrev_b32 v12, 16, v81
v_and_b32 v13, 0xffff0000, v81
v_fmac_f32 v170, v12, v144
v_fmac_f32 v171, v13, v144
v_mul_f32 v12, v12, v124
v_mul_f32 v13, v13, v124
v_cvt_pk_bf16_f32 v81, v12, v13
v_lshlrev_b32 v14, 16, v81
v_and_b32 v15, 0xffff0000, v81
v_add_f32 v162, v162, v14
v_add_f32 v163, v163, v15
v_lshlrev_b32 v8, 16, v82
v_and_b32 v9, 0xffff0000, v82
v_fmac_f32 v172, v8, v144
v_fmac_f32 v173, v9, v144
v_mul_f32 v8, v8, v124
v_mul_f32 v9, v9, v124
v_cvt_pk_bf16_f32 v82, v8, v9
v_lshlrev_b32 v10, 16, v82
v_and_b32 v11, 0xffff0000, v82
v_add_f32 v164, v164, v10
v_add_f32 v165, v165, v11
v_lshlrev_b32 v12, 16, v83
v_and_b32 v13, 0xffff0000, v83
v_fmac_f32 v174, v12, v144
v_fmac_f32 v175, v13, v144
v_mul_f32 v12, v12, v124
v_mul_f32 v13, v13, v124
v_cvt_pk_bf16_f32 v83, v12, v13
v_lshlrev_b32 v14, 16, v83
v_and_b32 v15, 0xffff0000, v83
v_add_f32 v166, v166, v14
v_add_f32 v167, v167, v15
s_add_u32 s3, s29, 73728
buffer_store_dwordx4 v[80:83], v5, s[20:23], s3 offen sc0 sc1
s_waitcnt vmcnt(25)
v_add_f32 v125, 1.0, v125
v_cvt_pk_bf16_f32 v125, v125, v125
v_and_b32 v125, 0xffff0000, v125
v_lshlrev_b32 v8, 16, v84
v_and_b32 v9, 0xffff0000, v84
v_fmac_f32 v168, v8, v145
v_fmac_f32 v169, v9, v145
v_mul_f32 v8, v8, v125
v_mul_f32 v9, v9, v125
v_cvt_pk_bf16_f32 v84, v8, v9
v_lshlrev_b32 v10, 16, v84
v_and_b32 v11, 0xffff0000, v84
v_add_f32 v160, v160, v10
v_add_f32 v161, v161, v11
v_lshlrev_b32 v12, 16, v85
v_and_b32 v13, 0xffff0000, v85
v_fmac_f32 v170, v12, v145
v_fmac_f32 v171, v13, v145
v_mul_f32 v12, v12, v125
v_mul_f32 v13, v13, v125
v_cvt_pk_bf16_f32 v85, v12, v13
v_lshlrev_b32 v14, 16, v85
v_and_b32 v15, 0xffff0000, v85
v_add_f32 v162, v162, v14
v_add_f32 v163, v163, v15
v_lshlrev_b32 v8, 16, v86
v_and_b32 v9, 0xffff0000, v86
v_fmac_f32 v172, v8, v145
v_fmac_f32 v173, v9, v145
v_mul_f32 v8, v8, v125
v_mul_f32 v9, v9, v125
v_cvt_pk_bf16_f32 v86, v8, v9
v_lshlrev_b32 v10, 16, v86
v_and_b32 v11, 0xffff0000, v86
v_add_f32 v164, v164, v10
v_add_f32 v165, v165, v11
v_lshlrev_b32 v12, 16, v87
v_and_b32 v13, 0xffff0000, v87
v_fmac_f32 v174, v12, v145
v_fmac_f32 v175, v13, v145
v_mul_f32 v12, v12, v125
v_mul_f32 v13, v13, v125
v_cvt_pk_bf16_f32 v87, v12, v13
v_lshlrev_b32 v14, 16, v87
v_and_b32 v15, 0xffff0000, v87
v_add_f32 v166, v166, v14
v_add_f32 v167, v167, v15
s_add_u32 s3, s29, 76800
buffer_store_dwordx4 v[84:87], v5, s[20:23], s3 offen sc0 sc1
s_waitcnt vmcnt(24)
v_add_f32 v126, 1.0, v126
v_cvt_pk_bf16_f32 v126, v126, v126
v_and_b32 v126, 0xffff0000, v126
v_lshlrev_b32 v8, 16, v88
v_and_b32 v9, 0xffff0000, v88
v_fmac_f32 v168, v8, v146
v_fmac_f32 v169, v9, v146
v_mul_f32 v8, v8, v126
v_mul_f32 v9, v9, v126
v_cvt_pk_bf16_f32 v88, v8, v9
v_lshlrev_b32 v10, 16, v88
v_and_b32 v11, 0xffff0000, v88
v_add_f32 v160, v160, v10
v_add_f32 v161, v161, v11
v_lshlrev_b32 v12, 16, v89
v_and_b32 v13, 0xffff0000, v89
v_fmac_f32 v170, v12, v146
v_fmac_f32 v171, v13, v146
v_mul_f32 v12, v12, v126
v_mul_f32 v13, v13, v126
v_cvt_pk_bf16_f32 v89, v12, v13
v_lshlrev_b32 v14, 16, v89
v_and_b32 v15, 0xffff0000, v89
v_add_f32 v162, v162, v14
v_add_f32 v163, v163, v15
v_lshlrev_b32 v8, 16, v90
v_and_b32 v9, 0xffff0000, v90
v_fmac_f32 v172, v8, v146
v_fmac_f32 v173, v9, v146
v_mul_f32 v8, v8, v126
v_mul_f32 v9, v9, v126
v_cvt_pk_bf16_f32 v90, v8, v9
v_lshlrev_b32 v10, 16, v90
v_and_b32 v11, 0xffff0000, v90
v_add_f32 v164, v164, v10
v_add_f32 v165, v165, v11
v_lshlrev_b32 v12, 16, v91
v_and_b32 v13, 0xffff0000, v91
v_fmac_f32 v174, v12, v146
v_fmac_f32 v175, v13, v146
v_mul_f32 v12, v12, v126
v_mul_f32 v13, v13, v126
v_cvt_pk_bf16_f32 v91, v12, v13
v_lshlrev_b32 v14, 16, v91
v_and_b32 v15, 0xffff0000, v91
v_add_f32 v166, v166, v14
v_add_f32 v167, v167, v15
s_add_u32 s3, s29, 86016
buffer_store_dwordx4 v[88:91], v5, s[20:23], s3 offen sc0 sc1
s_waitcnt vmcnt(23)
v_add_f32 v127, 1.0, v127
v_cvt_pk_bf16_f32 v127, v127, v127
v_and_b32 v127, 0xffff0000, v127
v_lshlrev_b32 v8, 16, v92
v_and_b32 v9, 0xffff0000, v92
v_fmac_f32 v168, v8, v147
v_fmac_f32 v169, v9, v147
v_mul_f32 v8, v8, v127
v_mul_f32 v9, v9, v127
v_cvt_pk_bf16_f32 v92, v8, v9
v_lshlrev_b32 v10, 16, v92
v_and_b32 v11, 0xffff0000, v92
v_add_f32 v160, v160, v10
v_add_f32 v161, v161, v11
v_lshlrev_b32 v12, 16, v93
v_and_b32 v13, 0xffff0000, v93
v_fmac_f32 v170, v12, v147
v_fmac_f32 v171, v13, v147
v_mul_f32 v12, v12, v127
v_mul_f32 v13, v13, v127
v_cvt_pk_bf16_f32 v93, v12, v13
v_lshlrev_b32 v14, 16, v93
v_and_b32 v15, 0xffff0000, v93
v_add_f32 v162, v162, v14
v_add_f32 v163, v163, v15
v_lshlrev_b32 v8, 16, v94
v_and_b32 v9, 0xffff0000, v94
v_fmac_f32 v172, v8, v147
v_fmac_f32 v173, v9, v147
v_mul_f32 v8, v8, v127
v_mul_f32 v9, v9, v127
v_cvt_pk_bf16_f32 v94, v8, v9
v_lshlrev_b32 v10, 16, v94
v_and_b32 v11, 0xffff0000, v94
v_add_f32 v164, v164, v10
v_add_f32 v165, v165, v11
v_lshlrev_b32 v12, 16, v95
v_and_b32 v13, 0xffff0000, v95
v_fmac_f32 v174, v12, v147
v_fmac_f32 v175, v13, v147
v_mul_f32 v12, v12, v127
v_mul_f32 v13, v13, v127
v_cvt_pk_bf16_f32 v95, v12, v13
v_lshlrev_b32 v14, 16, v95
v_and_b32 v15, 0xffff0000, v95
v_add_f32 v166, v166, v14
v_add_f32 v167, v167, v15
s_add_u32 s3, s29, 89088
buffer_store_dwordx4 v[92:95], v5, s[20:23], s3 offen sc0 sc1
s_waitcnt vmcnt(22)
v_add_f32 v128, 1.0, v128
v_cvt_pk_bf16_f32 v128, v128, v128
v_and_b32 v128, 0xffff0000, v128
v_lshlrev_b32 v8, 16, v96
v_and_b32 v9, 0xffff0000, v96
v_fmac_f32 v168, v8, v148
v_fmac_f32 v169, v9, v148
v_mul_f32 v8, v8, v128
v_mul_f32 v9, v9, v128
v_cvt_pk_bf16_f32 v96, v8, v9
v_lshlrev_b32 v10, 16, v96
v_and_b32 v11, 0xffff0000, v96
v_add_f32 v160, v160, v10
v_add_f32 v161, v161, v11
v_lshlrev_b32 v12, 16, v97
v_and_b32 v13, 0xffff0000, v97
v_fmac_f32 v170, v12, v148
v_fmac_f32 v171, v13, v148
v_mul_f32 v12, v12, v128
v_mul_f32 v13, v13, v128
v_cvt_pk_bf16_f32 v97, v12, v13
v_lshlrev_b32 v14, 16, v97
v_and_b32 v15, 0xffff0000, v97
v_add_f32 v162, v162, v14
v_add_f32 v163, v163, v15
v_lshlrev_b32 v8, 16, v98
v_and_b32 v9, 0xffff0000, v98
v_fmac_f32 v172, v8, v148
v_fmac_f32 v173, v9, v148
v_mul_f32 v8, v8, v128
v_mul_f32 v9, v9, v128
v_cvt_pk_bf16_f32 v98, v8, v9
v_lshlrev_b32 v10, 16, v98
v_and_b32 v11, 0xffff0000, v98
v_add_f32 v164, v164, v10
v_add_f32 v165, v165, v11
v_lshlrev_b32 v12, 16, v99
v_and_b32 v13, 0xffff0000, v99
v_fmac_f32 v174, v12, v148
v_fmac_f32 v175, v13, v148
v_mul_f32 v12, v12, v128
v_mul_f32 v13, v13, v128
v_cvt_pk_bf16_f32 v99, v12, v13
v_lshlrev_b32 v14, 16, v99
v_and_b32 v15, 0xffff0000, v99
v_add_f32 v166, v166, v14
v_add_f32 v167, v167, v15
s_add_u32 s3, s29, 98304
buffer_store_dwordx4 v[96:99], v5, s[20:23], s3 offen sc0 sc1
s_waitcnt vmcnt(21)
v_add_f32 v129, 1.0, v129
v_cvt_pk_bf16_f32 v129, v129, v129
v_and_b32 v129, 0xffff0000, v129
v_lshlrev_b32 v8, 16, v100
v_and_b32 v9, 0xffff0000, v100
v_fmac_f32 v168, v8, v149
v_fmac_f32 v169, v9, v149
v_mul_f32 v8, v8, v129
v_mul_f32 v9, v9, v129
v_cvt_pk_bf16_f32 v100, v8, v9
v_lshlrev_b32 v10, 16, v100
v_and_b32 v11, 0xffff0000, v100
v_add_f32 v160, v160, v10
v_add_f32 v161, v161, v11
v_lshlrev_b32 v12, 16, v101
v_and_b32 v13, 0xffff0000, v101
v_fmac_f32 v170, v12, v149
v_fmac_f32 v171, v13, v149
v_mul_f32 v12, v12, v129
v_mul_f32 v13, v13, v129
v_cvt_pk_bf16_f32 v101, v12, v13
v_lshlrev_b32 v14, 16, v101
v_and_b32 v15, 0xffff0000, v101
v_add_f32 v162, v162, v14
v_add_f32 v163, v163, v15
v_lshlrev_b32 v8, 16, v102
v_and_b32 v9, 0xffff0000, v102
v_fmac_f32 v172, v8, v149
v_fmac_f32 v173, v9, v149
v_mul_f32 v8, v8, v129
v_mul_f32 v9, v9, v129
v_cvt_pk_bf16_f32 v102, v8, v9
v_lshlrev_b32 v10, 16, v102
v_and_b32 v11, 0xffff0000, v102
v_add_f32 v164, v164, v10
v_add_f32 v165, v165, v11
v_lshlrev_b32 v12, 16, v103
v_and_b32 v13, 0xffff0000, v103
v_fmac_f32 v174, v12, v149
v_fmac_f32 v175, v13, v149
v_mul_f32 v12, v12, v129
v_mul_f32 v13, v13, v129
v_cvt_pk_bf16_f32 v103, v12, v13
v_lshlrev_b32 v14, 16, v103
v_and_b32 v15, 0xffff0000, v103
v_add_f32 v166, v166, v14
v_add_f32 v167, v167, v15
s_add_u32 s3, s29, 101376
buffer_store_dwordx4 v[100:103], v5, s[20:23], s3 offen sc0 sc1
s_waitcnt vmcnt(20)
v_add_f32 v130, 1.0, v130
v_cvt_pk_bf16_f32 v130, v130, v130
v_and_b32 v130, 0xffff0000, v130
v_lshlrev_b32 v8, 16, v104
v_and_b32 v9, 0xffff0000, v104
v_fmac_f32 v168, v8, v150
v_fmac_f32 v169, v9, v150
v_mul_f32 v8, v8, v130
v_mul_f32 v9, v9, v130
v_cvt_pk_bf16_f32 v104, v8, v9
v_lshlrev_b32 v10, 16, v104
v_and_b32 v11, 0xffff0000, v104
v_add_f32 v160, v160, v10
v_add_f32 v161, v161, v11
v_lshlrev_b32 v12, 16, v105
v_and_b32 v13, 0xffff0000, v105
v_fmac_f32 v170, v12, v150
v_fmac_f32 v171, v13, v150
v_mul_f32 v12, v12, v130
v_mul_f32 v13, v13, v130
v_cvt_pk_bf16_f32 v105, v12, v13
v_lshlrev_b32 v14, 16, v105
v_and_b32 v15, 0xffff0000, v105
v_add_f32 v162, v162, v14
v_add_f32 v163, v163, v15
v_lshlrev_b32 v8, 16, v106
v_and_b32 v9, 0xffff0000, v106
v_fmac_f32 v172, v8, v150
v_fmac_f32 v173, v9, v150
v_mul_f32 v8, v8, v130
v_mul_f32 v9, v9, v130
v_cvt_pk_bf16_f32 v106, v8, v9
v_lshlrev_b32 v10, 16, v106
v_and_b32 v11, 0xffff0000, v106
v_add_f32 v164, v164, v10
v_add_f32 v165, v165, v11
v_lshlrev_b32 v12, 16, v107
v_and_b32 v13, 0xffff0000, v107
v_fmac_f32 v174, v12, v150
v_fmac_f32 v175, v13, v150
v_mul_f32 v12, v12, v130
v_mul_f32 v13, v13, v130
v_cvt_pk_bf16_f32 v107, v12, v13
v_lshlrev_b32 v14, 16, v107
v_and_b32 v15, 0xffff0000, v107
v_add_f32 v166, v166, v14
v_add_f32 v167, v167, v15
s_add_u32 s3, s29, 110592
buffer_store_dwordx4 v[104:107], v5, s[20:23], s3 offen sc0 sc1
s_waitcnt vmcnt(19)
v_add_f32 v131, 1.0, v131
v_cvt_pk_bf16_f32 v131, v131, v131
v_and_b32 v131, 0xffff0000, v131
v_lshlrev_b32 v8, 16, v108
v_and_b32 v9, 0xffff0000, v108
v_fmac_f32 v168, v8, v151
v_fmac_f32 v169, v9, v151
v_mul_f32 v8, v8, v131
v_mul_f32 v9, v9, v131
v_cvt_pk_bf16_f32 v108, v8, v9
v_lshlrev_b32 v10, 16, v108
v_and_b32 v11, 0xffff0000, v108
v_add_f32 v160, v160, v10
v_add_f32 v161, v161, v11
v_lshlrev_b32 v12, 16, v109
v_and_b32 v13, 0xffff0000, v109
v_fmac_f32 v170, v12, v151
v_fmac_f32 v171, v13, v151
v_mul_f32 v12, v12, v131
v_mul_f32 v13, v13, v131
v_cvt_pk_bf16_f32 v109, v12, v13
v_lshlrev_b32 v14, 16, v109
v_and_b32 v15, 0xffff0000, v109
v_add_f32 v162, v162, v14
v_add_f32 v163, v163, v15
v_lshlrev_b32 v8, 16, v110
v_and_b32 v9, 0xffff0000, v110
v_fmac_f32 v172, v8, v151
v_fmac_f32 v173, v9, v151
v_mul_f32 v8, v8, v131
v_mul_f32 v9, v9, v131
v_cvt_pk_bf16_f32 v110, v8, v9
v_lshlrev_b32 v10, 16, v110
v_and_b32 v11, 0xffff0000, v110
v_add_f32 v164, v164, v10
v_add_f32 v165, v165, v11
v_lshlrev_b32 v12, 16, v111
v_and_b32 v13, 0xffff0000, v111
v_fmac_f32 v174, v12, v151
v_fmac_f32 v175, v13, v151
v_mul_f32 v12, v12, v131
v_mul_f32 v13, v13, v131
v_cvt_pk_bf16_f32 v111, v12, v13
v_lshlrev_b32 v14, 16, v111
v_and_b32 v15, 0xffff0000, v111
v_add_f32 v166, v166, v14
v_add_f32 v167, v167, v15
s_add_u32 s3, s29, 113664
buffer_store_dwordx4 v[108:111], v5, s[20:23], s3 offen sc0 sc1
v_mul_u32_u24 v6, 768, v1
v_lshl_add_u32 v6, v2, 5, v6
ds_write_b128 v6, v[160:163]
ds_write_b128 v6, v[164:167] offset:16
ds_write_b128 v6, v[168:171] offset:384
ds_write_b128 v6, v[172:175] offset:400
RWX_3:
s_mov_b64 exec, s[40:41]
s_waitcnt lgkmcnt(0)
s_barrier
v_cmp_gt_u32 vcc, 192, v0
s_and_saveexec_b64 s[40:41], vcc
s_cbranch_execz RWY_4
v_lshlrev_b32 v6, 2, v0
ds_read_b32 v32, v6 offset:0
ds_read_b32 v33, v6 offset:768
ds_read_b32 v34, v6 offset:1536
ds_read_b32 v35, v6 offset:2304
ds_read_b32 v36, v6 offset:3072
ds_read_b32 v37, v6 offset:3840
ds_read_b32 v38, v6 offset:4608
ds_read_b32 v39, v6 offset:5376
ds_read_b32 v40, v6 offset:6144
ds_read_b32 v41, v6 offset:6912
ds_read_b32 v42, v6 offset:7680
ds_read_b32 v43, v6 offset:8448
ds_read_b32 v44, v6 offset:9216
ds_read_b32 v45, v6 offset:9984
ds_read_b32 v46, v6 offset:10752
ds_read_b32 v47, v6 offset:11520
s_waitcnt lgkmcnt(0)
v_add_f32 v32, v32, v40
v_add_f32 v33, v33, v41
v_add_f32 v34, v34, v42
v_add_f32 v35, v35, v43
v_add_f32 v36, v36, v44
v_add_f32 v37, v37, v45
v_add_f32 v38, v38, v46
v_add_f32 v39, v39, v47
v_add_f32 v32, v32, v36
v_add_f32 v33, v33, v37
v_add_f32 v34, v34, v38
v_add_f32 v35, v35, v39
v_add_f32 v32, v32, v34
v_add_f32 v33, v33, v35
v_add_f32 v32, v32, v33
v_cvt_pk_bf16_f32 v33, v32, v32
v_and_b32 v34, 0xffff0000, v33
v_sub_f32 v34, v32, v34
v_cvt_pk_bf16_f32 v33, v32, v34
v_cmp_le_u32 vcc, 96, v0
s_nop 1
v_cndmask_b32 v35, 0, 1, vcc
v_mul_u32_u24 v36, 96, v35
v_sub_u32 v36, v0, v36
v_lshlrev_b32 v36, 4, v36
v_lshl_add_u32 v36, v35, 3, v36
s_mul_i32 s3, s26, 24576
s_mul_i32 s29, s28, 1536
s_add_u32 s3, s3, s29
s_lshl_b32 s29, s27, 2
s_add_u32 s3, s3, s29
s_add_u32 s3, s3, 20971520
buffer_store_dword v33, v36, s[20:23], s3 offen sc0 sc1
RWY_4:
s_mov_b64 exec, s[40:41]
s_branch KB_FIN
KB_RD:
s_cmp_ge_u32 s2, 256
s_cbranch_scc1 KB_END
s_load_dwordx2 s[4:5], s[0:1], 80
s_load_dwordx2 s[8:9], s[0:1], 120
s_sub_u32 s3, s2, 224
s_and_b32 s29, s3, 7
s_lshr_b32 s28, s3, 3
v_and_b32 v1, 63, v0
v_lshrrev_b32 v2, 6, v0
s_nop 0
v_readfirstlane_b32 s31, v2
v_add_u32 v3, 0, v1
v_mul_u32_u24 v4, 52429, v3
v_lshrrev_b32 v4, 19, v4
v_mul_u32_u24 v5, 10, v4
v_sub_u32 v5, v3, v5
v_lshrrev_b32 v6, 4, v4
v_lshlrev_b32 v6, 4, v6
v_bfe_u32 v7, v4, 2, 1
v_lshl_add_u32 v6, v7, 3, v6
v_bfe_u32 v7, v4, 3, 1
v_lshl_add_u32 v6, v7, 2, v6
v_and_b32 v7, 3, v4
v_add_u32 v6, v6, v7
v_mul_u32_u24 v6, 1280, v6
v_lshl_add_u32 v6, v5, 4, v6
s_mul_i32 s3, s29, 160
v_add_u32 v10, s3, v6
v_add_u32 v3, 64, v1
v_mul_u32_u24 v4, 52429, v3
v_lshrrev_b32 v4, 19, v4
v_mul_u32_u24 v5, 10, v4
v_sub_u32 v5, v3, v5
v_lshrrev_b32 v6, 4, v4
v_lshlrev_b32 v6, 4, v6
v_bfe_u32 v7, v4, 2, 1
v_lshl_add_u32 v6, v7, 3, v6
v_bfe_u32 v7, v4, 3, 1
v_lshl_add_u32 v6, v7, 2, v6
v_and_b32 v7, 3, v4
v_add_u32 v6, v6, v7
v_mul_u32_u24 v6, 1280, v6
v_lshl_add_u32 v6, v5, 4, v6
s_mul_i32 s3, s29, 160
v_add_u32 v11, s3, v6
v_add_u32 v3, 128, v1
v_mul_u32_u24 v4, 52429, v3
v_lshrrev_b32 v4, 19, v4
v_mul_u32_u24 v5, 10, v4
v_sub_u32 v5, v3, v5
v_lshrrev_b32 v6, 4, v4
v_lshlrev_b32 v6, 4, v6
v_bfe_u32 v7, v4, 2, 1
v_lshl_add_u32 v6, v7, 3, v6
v_bfe_u32 v7, v4, 3, 1
v_lshl_add_u32 v6, v7, 2, v6
v_and_b32 v7, 3, v4
v_add_u32 v6, v6, v7
v_mul_u32_u24 v6, 1280, v6
v_lshl_add_u32 v6, v5, 4, v6
s_mul_i32 s3, s29, 160
v_add_u32 v12, s3, v6
v_add_u32 v3, 192, v1
v_mul_u32_u24 v4, 52429, v3
v_lshrrev_b32 v4, 19, v4
v_mul_u32_u24 v5, 10, v4
v_sub_u32 v5, v3, v5
v_lshrrev_b32 v6, 4, v4
v_lshlrev_b32 v6, 4, v6
v_bfe_u32 v7, v4, 2, 1
v_lshl_add_u32 v6, v7, 3, v6
v_bfe_u32 v7, v4, 3, 1
v_lshl_add_u32 v6, v7, 2, v6
v_and_b32 v7, 3, v4
v_add_u32 v6, v6, v7
v_mul_u32_u24 v6, 1280, v6
v_lshl_add_u32 v6, v5, 4, v6
s_mul_i32 s3, s29, 160
v_add_u32 v13, s3, v6
v_add_u32 v3, 256, v1
v_mul_u32_u24 v4, 52429, v3
v_lshrrev_b32 v4, 19, v4
v_mul_u32_u24 v5, 10, v4
v_sub_u32 v5, v3, v5
v_lshrrev_b32 v6, 4, v4
v_lshlrev_b32 v6, 4, v6
v_bfe_u32 v7, v4, 2, 1
v_lshl_add_u32 v6, v7, 3, v6
v_bfe_u32 v7, v4, 3, 1
v_lshl_add_u32 v6, v7, 2, v6
v_and_b32 v7, 3, v4
v_add_u32 v6, v6, v7
v_mul_u32_u24 v6, 1280, v6
v_lshl_add_u32 v6, v5, 4, v6
s_mul_i32 s3, s29, 160
v_add_u32 v14, s3, v6
v_lshlrev_b32 v15, 4, v1
s_mul_i32 s30, s28, 12
s_mul_i32 s3, s31, 3
s_add_u32 s30, s30, s3
s_mul_i32 s32, s30, 40960
s_mul_i32 s33, s29, 245760
s_mul_i32 s3, s30, 5120
s_add_u32 s33, s33, s3
s_add_u32 s33, s33, 22020096
s_waitcnt lgkmcnt(0)
s_mov_b32 s12, s4
s_mov_b32 s13, s5
s_mov_b32 s14, 1966080
s_mov_b32 s15, 0x00020000
s_mov_b32 s20, s8
s_mov_b32 s21, s9
s_mov_b32 s22, 268435456
s_mov_b32 s23, 0x00020000
buffer_load_dwordx4 v[32:35], v10, s[12:15], s32 offen
buffer_load_dwordx4 v[36:39], v11, s[12:15], s32 offen
buffer_load_dwordx4 v[40:43], v12, s[12:15], s32 offen
buffer_load_dwordx4 v[44:47], v13, s[12:15], s32 offen
buffer_load_dwordx4 v[48:51], v14, s[12:15], s32 offen
s_add_u32 s32, s32, 40960
buffer_load_dwordx4 v[52:55], v10, s[12:15], s32 offen
buffer_load_dwordx4 v[56:59], v11, s[12:15], s32 offen
buffer_load_dwordx4 v[60:63], v12, s[12:15], s32 offen
buffer_load_dwordx4 v[64:67], v13, s[12:15], s32 offen
buffer_load_dwordx4 v[68:71], v14, s[12:15], s32 offen
s_add_u32 s32, s32, 40960
buffer_load_dwordx4 v[72:75], v10, s[12:15], s32 offen
buffer_load_dwordx4 v[76:79], v11, s[12:15], s32 offen
buffer_load_dwordx4 v[80:83], v12, s[12:15], s32 offen
buffer_load_dwordx4 v[84:87], v13, s[12:15], s32 offen
buffer_load_dwordx4 v[88:91], v14, s[12:15], s32 offen
s_add_u32 s32, s32, 40960
s_waitcnt vmcnt(14)
s_add_u32 s3, s33, 0
buffer_store_dwordx4 v[32:35], v15, s[20:23], s3 offen sc0 sc1
s_waitcnt vmcnt(14)
s_add_u32 s3, s33, 1024
buffer_store_dwordx4 v[36:39], v15, s[20:23], s3 offen sc0 sc1
s_waitcnt vmcnt(14)
s_add_u32 s3, s33, 2048
buffer_store_dwordx4 v[40:43], v15, s[20:23], s3 offen sc0 sc1
s_waitcnt vmcnt(14)
s_add_u32 s3, s33, 3072
buffer_store_dwordx4 v[44:47], v15, s[20:23], s3 offen sc0 sc1
s_waitcnt vmcnt(14)
s_add_u32 s3, s33, 4096
buffer_store_dwordx4 v[48:51], v15, s[20:23], s3 offen sc0 sc1
s_waitcnt vmcnt(14)
s_add_u32 s3, s33, 5120
buffer_store_dwordx4 v[52:55], v15, s[20:23], s3 offen sc0 sc1
s_waitcnt vmcnt(14)
s_add_u32 s3, s33, 6144
buffer_store_dwordx4 v[56:59], v15, s[20:23], s3 offen sc0 sc1
s_waitcnt vmcnt(14)
s_add_u32 s3, s33, 7168
buffer_store_dwordx4 v[60:63], v15, s[20:23], s3 offen sc0 sc1
s_waitcnt vmcnt(14)
s_add_u32 s3, s33, 8192
buffer_store_dwordx4 v[64:67], v15, s[20:23], s3 offen sc0 sc1
s_waitcnt vmcnt(14)
s_add_u32 s3, s33, 9216
buffer_store_dwordx4 v[68:71], v15, s[20:23], s3 offen sc0 sc1
s_waitcnt vmcnt(14)
s_add_u32 s3, s33, 10240
buffer_store_dwordx4 v[72:75], v15, s[20:23], s3 offen sc0 sc1
s_waitcnt vmcnt(14)
s_add_u32 s3, s33, 11264
buffer_store_dwordx4 v[76:79], v15, s[20:23], s3 offen sc0 sc1
s_waitcnt vmcnt(14)
s_add_u32 s3, s33, 12288
buffer_store_dwordx4 v[80:83], v15, s[20:23], s3 offen sc0 sc1
s_waitcnt vmcnt(14)
s_add_u32 s3, s33, 13312
buffer_store_dwordx4 v[84:87], v15, s[20:23], s3 offen sc0 sc1
s_waitcnt vmcnt(14)
s_add_u32 s3, s33, 14336
buffer_store_dwordx4 v[88:91], v15, s[20:23], s3 offen sc0 sc1
KB_FIN:
s_waitcnt vmcnt(0)
KB_END:
s_endpgm
kb_kernel_end:
.globl kd_kernel
.p2align 8
.type kd_kernel,@function
kd_kernel:
s_getpc_b64 s[4:5]
s_mov_b32 s6, kd_kernel_end-kd_kernel-64
v_lshlrev_b32 v1, 7, v0
v_min_u32 v1, s6, v1
v_mov_b32 v3, s5
v_add_co_u32 v2, vcc, s4, v1
s_nop 1
v_addc_co_u32 v3, vcc, 0, v3, vcc
global_load_dword v250, v[2:3], off
s_cmp_ge_u32 s2, 256
s_cbranch_scc1 KD_END
s_load_dwordx2 s[8:9], s[0:1], 120
s_and_b32 s26, s2, 7
s_lshr_b32 s27, s2, 3
s_and_b32 s28, s26, 1
s_lshl_b32 s28, s28, 3
s_and_b32 s29, s27, 7
s_add_u32 s28, s28, s29
s_lshr_b32 s29, s26, 1
s_lshl_b32 s29, s29, 2
s_lshr_b32 s30, s27, 3
s_add_u32 s29, s29, s30
v_and_b32 v1, 63, v0
v_lshrrev_b32 v2, 6, v0
v_lshlrev_b32 v13, 4, v1
v_readfirstlane_b32 s31, v2
s_mul_i32 s32, s29, 245760
s_mul_i32 s34, s31, 3072
s_add_u32 s32, s32, s34
s_add_u32 s32, s32, 16777216
s_lshr_b32 s3, s31, 1
s_lshl_b32 s3, s3, 5
s_add_u32 s34, s34, s3
s_lshl_b32 s33, s31, 15
s_lshl_b32 s3, s28, 10
s_add_u32 s33, s33, s3
s_add_u32 s33, s33, 65536
s_lshl_b32 s35, s31, 11
s_add_u32 s35, s35, 12352
s_waitcnt lgkmcnt(0)
s_mov_b32 s20, s8
s_mov_b32 s21, s9
s_mov_b32 s22, 268435456
s_mov_b32 s23, 0x00020000
s_add_u32 m0, s34, 0
s_nop 0
buffer_load_dwordx4 v13, s[20:23], s32 offen lds
buffer_load_dwordx4 v13, s[20:23], s32 offen offset:1024 lds
buffer_load_dwordx4 v13, s[20:23], s32 offen offset:2048 lds
s_add_u32 s32, s32, 12288
s_add_u32 m0, s35, 0
s_nop 0
buffer_load_dwordx4 v13, s[20:23], s33 offen lds
s_add_u32 s3, s33, 15360
buffer_load_dwordx4 v13, s[20:23], s3 offen offset:1024 lds
s_add_u32 s33, s33, 131072
s_add_u32 m0, s34, 20544
s_nop 0
buffer_load_dwordx4 v13, s[20:23], s32 offen lds
buffer_load_dwordx4 v13, s[20:23], s32 offen offset:1024 lds
buffer_load_dwordx4 v13, s[20:23], s32 offen offset:2048 lds
s_add_u32 s32, s32, 12288
s_add_u32 m0, s35, 20544
s_nop 0
buffer_load_dwordx4 v13, s[20:23], s33 offen lds
s_add_u32 s3, s33, 15360
buffer_load_dwordx4 v13, s[20:23], s3 offen offset:1024 lds
s_add_u32 s33, s33, 131072
v_and_b32 v3, 15, v1
v_bfe_u32 v4, v1, 4, 1
v_mul_u32_u24 v4, 1536, v4
v_add_u32 v3, v3, v4
s_and_b32 s36, s31, 1
s_lshr_b32 s37, s31, 1
s_mul_i32 s3, s29, 96
s_mul_i32 s38, s36, 48
s_add_u32 s3, s3, s38
v_add_u32 v75, s3, v3
v_lshlrev_b32 v75, 4, v75
s_mov_b32 s40, 20971520
v_bfe_u32 v3, v1, 4, 1
v_mul_u32_u24 v14, 6176, v3
v_lshrrev_b32 v3, 5, v1
v_lshlrev_b32 v3, 3, v3
v_bfe_u32 v4, v1, 2, 2
v_add_u32 v3, v3, v4
v_mul_u32_u24 v3, 192, v3
v_add_u32 v14, v14, v3
v_and_b32 v3, 3, v1
v_lshl_add_u32 v14, v3, 3, v14
s_mul_i32 s3, s36, 96
v_add_u32 v14, s3, v14
v_lshrrev_b32 v3, 5, v1
v_lshlrev_b32 v15, 11, v3
v_and_b32 v3, 31, v1
v_lshl_add_u32 v15, v3, 3, v15
s_lshl_b32 s3, s37, 9
s_add_u32 s3, s3, 12352
s_lshl_b32 s38, s36, 8
s_add_u32 s39, s3, s38
s_sub_u32 s3, s3, s38
s_add_u32 s3, s3, 256
v_add_u32 v72, s3, v15
v_add_u32 v15, s39, v15
v_add_u32 v16, 61632, v14
v_add_u32 v17, 61632, v15
v_add_u32 v18, 123264, v14
v_add_u32 v19, 123264, v15
v_add_u32 v73, 61632, v72
v_add_u32 v74, 123264, v72
v_lshrrev_b32 v3, 4, v1
v_lshlrev_b32 v104, 11, v3
v_and_b32 v3, 15, v1
v_lshl_add_u32 v104, v3, 3, v104
s_lshl_b32 s3, s37, 9
s_lshl_b32 s38, s36, 8
s_add_u32 s3, s3, s38
s_add_u32 s3, s3, 12352
v_add_u32 v104, s3, v104
v_add_u32 v105, 61632, v104
v_add_u32 v106, 123264, v104
v_mov_b32 v100, 0x3f803f80
v_mov_b32 v101, 0x3f803f80
v_mov_b32 v102, 0x3f803f80
v_mov_b32 v103, 0x3f803f80
v_and_b32 v3, 3, v1
v_cmp_eq_u32 s[42:43], 1, v3
v_cmp_eq_u32 s[44:45], 2, v3
v_cmp_eq_u32 s[46:47], 3, v3
v_bfe_u32 v4, v1, 2, 2
v_lshrrev_b32 v5, 4, v1
v_cmp_eq_u32 s[48:49], v4, v5
v_cmp_gt_u32 s[50:51], 32, v1
v_and_b32 v3, 15, v1
v_lshlrev_b32 v3, 4, v3
s_lshl_b32 s3, s37, 10
s_add_u32 s38, s3, 143808
s_lshl_b32 s3, s36, 9
s_add_u32 s3, s3, s38
v_add_u32 v2, s3, v3
v_and_b32 v3, 31, v1
v_lshlrev_b32 v3, 4, v3
v_add_u32 v12, s3, v3
s_xor_b32 s3, s36, 1
s_lshl_b32 s3, s3, 9
s_add_u32 s3, s3, s38
v_add_u32 v107, s3, v3
s_or_b64 s[44:45], s[44:45], s[46:47]
s_mul_i32 s3, s29, 12
s_mul_i32 s38, s36, 6
s_add_u32 s3, s3, s38
s_lshl_b32 s3, s3, 15
s_lshl_b32 s38, s28, 11
s_add_u32 s3, s3, s38
s_lshl_b32 s38, s37, 10
s_add_u32 s3, s3, s38
s_add_u32 s3, s3, 6291456
s_lshl_b32 s38, s36, 9
s_add_u32 s39, s3, s38
s_sub_u32 s41, s3, s38
s_add_u32 s41, s41, 512
v_lshrrev_b32 v3, 5, v1
v_lshlrev_b32 v11, 15, v3
v_and_b32 v3, 31, v1
v_lshl_add_u32 v11, v3, 4, v11
s_waitcnt vmcnt(5)
s_barrier
ds_read_b64_tr_b16 v[32:33], v14 offset:0
ds_read_b64_tr_b16 v[34:35], v14 offset:768
ds_read_b64 v[44:45], v15 offset:0
ds_read_b64 v[46:47], v15 offset:1024
ds_read_b64 v[48:49], v72 offset:0
ds_read_b64 v[50:51], v72 offset:1024
ds_read_b64_tr_b16 v[36:37], v14 offset:32
ds_read_b64_tr_b16 v[38:39], v14 offset:800
ds_read_b64_tr_b16 v[40:41], v14 offset:64
ds_read_b64_tr_b16 v[42:43], v14 offset:832
s_waitcnt lgkmcnt(0)
v_mfma_f32_32x32x16_bf16 v[128:143], v[32:35], v[44:47], 0
ds_read_b64_tr_b16 v[52:53], v14 offset:3072
ds_read_b64_tr_b16 v[54:55], v14 offset:3840
ds_read_b64 v[64:65], v15 offset:4096
ds_read_b64 v[66:67], v15 offset:5120
v_mfma_f32_32x32x16_bf16 v[144:159], v[32:35], v[48:51], 0
ds_read_b64 v[68:69], v72 offset:4096
ds_read_b64 v[70:71], v72 offset:5120
ds_read_b64_tr_b16 v[56:57], v14 offset:3104
ds_read_b64_tr_b16 v[58:59], v14 offset:3872
s_add_u32 m0, s34, 41088
s_nop 0
buffer_load_dwordx4 v13, s[20:23], s32 offen lds
v_mfma_f32_32x32x16_bf16 v[160:175], v[36:39], v[44:47], 0
ds_read_b64_tr_b16 v[60:61], v14 offset:3136
ds_read_b64_tr_b16 v[62:63], v14 offset:3904
ds_read_b64 v[76:77], v104 offset:0
ds_read_b64 v[78:79], v104 offset:1024
buffer_load_dwordx4 v13, s[20:23], s32 offen offset:1024 lds
v_mfma_f32_32x32x16_bf16 v[176:191], v[36:39], v[48:51], 0
ds_read_b64 v[80:81], v104 offset:128
ds_read_b64 v[82:83], v104 offset:1152
buffer_load_dwordx4 v13, s[20:23], s32 offen offset:2048 lds
s_add_u32 s32, s32, 12288
v_mfma_f32_32x32x16_bf16 v[192:207], v[40:43], v[44:47], 0
s_add_u32 m0, s35, 41088
s_nop 0
buffer_load_dwordx4 v13, s[20:23], s33 offen lds
s_add_u32 s3, s33, 15360
v_mfma_f32_32x32x16_bf16 v[208:223], v[40:43], v[48:51], 0
buffer_load_dwordx4 v13, s[20:23], s3 offen offset:1024 lds
s_add_u32 s33, s33, 131072
s_waitcnt lgkmcnt(4)
v_mfma_f32_32x32x16_bf16 v[128:143], v[52:55], v[64:67], v[128:143]
s_waitcnt vmcnt(5)
s_barrier
ds_read_b64_tr_b16 v[32:33], v14 offset:20544
ds_read_b64_tr_b16 v[34:35], v14 offset:21312
ds_read_b64 v[44:45], v15 offset:20544
ds_read_b64 v[46:47], v15 offset:21568
v_mfma_f32_32x32x16_bf16 v[144:159], v[52:55], v[68:71], v[144:159]
ds_read_b64 v[48:49], v72 offset:20544
ds_read_b64 v[50:51], v72 offset:21568
ds_read_b64_tr_b16 v[36:37], v14 offset:20576
ds_read_b64_tr_b16 v[38:39], v14 offset:21344
s_add_u32 m0, s34, 61632
s_nop 0
buffer_load_dwordx4 v13, s[20:23], s32 offen lds
v_mfma_f32_32x32x16_bf16 v[160:175], v[56:59], v[64:67], v[160:175]
ds_read_b64_tr_b16 v[40:41], v14 offset:20608
ds_read_b64_tr_b16 v[42:43], v14 offset:21376
s_waitcnt lgkmcnt(10)
v_mfma_f32_16x16x32_bf16 v[84:87], v[76:79], v[76:79], 0
buffer_load_dwordx4 v13, s[20:23], s32 offen offset:1024 lds
v_mfma_f32_32x32x16_bf16 v[176:191], v[56:59], v[68:71], v[176:191]
v_mfma_f32_16x16x32_bf16 v[92:95], v[100:103], v[76:79], 0
buffer_load_dwordx4 v13, s[20:23], s32 offen offset:2048 lds
s_add_u32 s32, s32, 12288
v_mfma_f32_32x32x16_bf16 v[192:207], v[60:63], v[64:67], v[192:207]
v_mfma_f32_16x16x32_bf16 v[88:91], v[80:83], v[80:83], 0
s_add_u32 m0, s35, 61632
s_nop 0
buffer_load_dwordx4 v13, s[20:23], s33 offen lds
s_add_u32 s3, s33, 15360
v_mfma_f32_32x32x16_bf16 v[208:223], v[60:63], v[68:71], v[208:223]
v_mfma_f32_16x16x32_bf16 v[96:99], v[100:103], v[80:83], 0
buffer_load_dwordx4 v13, s[20:23], s3 offen offset:1024 lds
s_add_u32 s33, s33, 131072
s_waitcnt lgkmcnt(0)
v_mfma_f32_32x32x16_bf16 v[128:143], v[32:35], v[44:47], v[128:143]
ds_read_b64_tr_b16 v[52:53], v14 offset:23616
ds_read_b64_tr_b16 v[54:55], v14 offset:24384
ds_read_b64 v[64:65], v15 offset:24640
ds_read_b64 v[66:67], v15 offset:25664
v_mfma_f32_32x32x16_bf16 v[144:159], v[32:35], v[48:51], v[144:159]
ds_read_b64 v[68:69], v72 offset:24640
ds_read_b64 v[70:71], v72 offset:25664
ds_read_b64_tr_b16 v[56:57], v14 offset:23648
ds_read_b64_tr_b16 v[58:59], v14 offset:24416
s_add_u32 m0, s34, 82176
s_nop 0
buffer_load_dwordx4 v13, s[20:23], s32 offen lds
v_mfma_f32_32x32x16_bf16 v[160:175], v[36:39], v[44:47], v[160:175]
ds_read_b64_tr_b16 v[60:61], v14 offset:23680
ds_read_b64_tr_b16 v[62:63], v14 offset:24448
ds_read_b64 v[76:77], v104 offset:20544
ds_read_b64 v[78:79], v104 offset:21568
buffer_load_dwordx4 v13, s[20:23], s32 offen offset:1024 lds
v_mfma_f32_32x32x16_bf16 v[176:191], v[36:39], v[48:51], v[176:191]
ds_read_b64 v[80:81], v104 offset:20672
ds_read_b64 v[82:83], v104 offset:21696
buffer_load_dwordx4 v13, s[20:23], s32 offen offset:2048 lds
s_add_u32 s32, s32, 12288
v_mfma_f32_32x32x16_bf16 v[192:207], v[40:43], v[44:47], v[192:207]
s_add_u32 m0, s35, 82176
s_nop 0
buffer_load_dwordx4 v13, s[20:23], s33 offen lds
s_add_u32 s3, s33, 15360
v_mfma_f32_32x32x16_bf16 v[208:223], v[40:43], v[48:51], v[208:223]
buffer_load_dwordx4 v13, s[20:23], s3 offen offset:1024 lds
s_add_u32 s33, s33, 131072
s_waitcnt lgkmcnt(4)
v_mfma_f32_32x32x16_bf16 v[128:143], v[52:55], v[64:67], v[128:143]
s_waitcnt vmcnt(10)
s_barrier
ds_read_b64_tr_b16 v[32:33], v14 offset:41088
ds_read_b64_tr_b16 v[34:35], v14 offset:41856
ds_read_b64 v[44:45], v15 offset:41088
ds_read_b64 v[46:47], v15 offset:42112
v_mfma_f32_32x32x16_bf16 v[144:159], v[52:55], v[68:71], v[144:159]
ds_read_b64 v[48:49], v72 offset:41088
ds_read_b64 v[50:51], v72 offset:42112
ds_read_b64_tr_b16 v[36:37], v14 offset:41120
ds_read_b64_tr_b16 v[38:39], v14 offset:41888
s_add_u32 m0, s34, 102720
s_nop 0
buffer_load_dwordx4 v13, s[20:23], s32 offen lds
v_mfma_f32_32x32x16_bf16 v[160:175], v[56:59], v[64:67], v[160:175]
ds_read_b64_tr_b16 v[40:41], v14 offset:41152
ds_read_b64_tr_b16 v[42:43], v14 offset:41920
s_waitcnt lgkmcnt(10)
v_mfma_f32_16x16x32_bf16 v[84:87], v[76:79], v[76:79], v[84:87]
buffer_load_dwordx4 v13, s[20:23], s32 offen offset:1024 lds
v_mfma_f32_32x32x16_bf16 v[176:191], v[56:59], v[68:71], v[176:191]
v_mfma_f32_16x16x32_bf16 v[92:95], v[100:103], v[76:79], v[92:95]
buffer_load_dwordx4 v13, s[20:23], s32 offen offset:2048 lds
s_add_u32 s32, s32, 12288
v_mfma_f32_32x32x16_bf16 v[192:207], v[60:63], v[64:67], v[192:207]
v_mfma_f32_16x16x32_bf16 v[88:91], v[80:83], v[80:83], v[88:91]
s_add_u32 m0, s35, 102720
s_nop 0
buffer_load_dwordx4 v13, s[20:23], s33 offen lds
s_add_u32 s3, s33, 15360
v_mfma_f32_32x32x16_bf16 v[208:223], v[60:63], v[68:71], v[208:223]
v_mfma_f32_16x16x32_bf16 v[96:99], v[100:103], v[80:83], v[96:99]
buffer_load_dwordx4 v13, s[20:23], s3 offen offset:1024 lds
s_add_u32 s33, s33, 131072
s_waitcnt lgkmcnt(0)
v_mfma_f32_32x32x16_bf16 v[128:143], v[32:35], v[44:47], v[128:143]
ds_read_b64_tr_b16 v[52:53], v14 offset:44160
ds_read_b64_tr_b16 v[54:55], v14 offset:44928
ds_read_b64 v[64:65], v15 offset:45184
ds_read_b64 v[66:67], v15 offset:46208
v_mfma_f32_32x32x16_bf16 v[144:159], v[32:35], v[48:51], v[144:159]
ds_read_b64 v[68:69], v72 offset:45184
ds_read_b64 v[70:71], v72 offset:46208
ds_read_b64_tr_b16 v[56:57], v14 offset:44192
ds_read_b64_tr_b16 v[58:59], v14 offset:44960
v_mfma_f32_32x32x16_bf16 v[160:175], v[36:39], v[44:47], v[160:175]
ds_read_b64_tr_b16 v[60:61], v14 offset:44224
ds_read_b64_tr_b16 v[62:63], v14 offset:44992
ds_read_b64 v[76:77], v104 offset:41088
ds_read_b64 v[78:79], v104 offset:42112
v_mfma_f32_32x32x16_bf16 v[176:191], v[36:39], v[48:51], v[176:191]
ds_read_b64 v[80:81], v104 offset:41216
ds_read_b64 v[82:83], v104 offset:42240
s_add_u32 m0, s34, 123264
s_nop 0
buffer_load_dwordx4 v13, s[20:23], s32 offen lds
v_mfma_f32_32x32x16_bf16 v[192:207], v[40:43], v[44:47], v[192:207]
buffer_load_dwordx4 v13, s[20:23], s32 offen offset:1024 lds
v_mfma_f32_32x32x16_bf16 v[208:223], v[40:43], v[48:51], v[208:223]
buffer_load_dwordx4 v13, s[20:23], s32 offen offset:2048 lds
s_add_u32 s32, s32, 12288
s_waitcnt lgkmcnt(4)
v_mfma_f32_32x32x16_bf16 v[128:143], v[52:55], v[64:67], v[128:143]
s_waitcnt vmcnt(13)
s_barrier
ds_read_b64_tr_b16 v[32:33], v16 offset:0
ds_read_b64_tr_b16 v[34:35], v16 offset:768
ds_read_b64 v[44:45], v17 offset:0
ds_read_b64 v[46:47], v17 offset:1024
v_mfma_f32_32x32x16_bf16 v[144:159], v[52:55], v[68:71], v[144:159]
ds_read_b64 v[48:49], v73 offset:0
ds_read_b64 v[50:51], v73 offset:1024
ds_read_b64_tr_b16 v[36:37], v16 offset:32
ds_read_b64_tr_b16 v[38:39], v16 offset:800
v_mfma_f32_32x32x16_bf16 v[160:175], v[56:59], v[64:67], v[160:175]
ds_read_b64_tr_b16 v[40:41], v16 offset:64
ds_read_b64_tr_b16 v[42:43], v16 offset:832
s_waitcnt lgkmcnt(10)
v_mfma_f32_16x16x32_bf16 v[84:87], v[76:79], v[76:79], v[84:87]
v_mfma_f32_32x32x16_bf16 v[176:191], v[56:59], v[68:71], v[176:191]
v_mfma_f32_16x16x32_bf16 v[92:95], v[100:103], v[76:79], v[92:95]
v_mfma_f32_32x32x16_bf16 v[192:207], v[60:63], v[64:67], v[192:207]
v_mfma_f32_16x16x32_bf16 v[88:91], v[80:83], v[80:83], v[88:91]
s_add_u32 m0, s35, 123264
s_nop 0
buffer_load_dwordx4 v13, s[20:23], s33 offen lds
s_add_u32 s3, s33, 15360
v_mfma_f32_32x32x16_bf16 v[208:223], v[60:63], v[68:71], v[208:223]
v_mfma_f32_16x16x32_bf16 v[96:99], v[100:103], v[80:83], v[96:99]
buffer_load_dwordx4 v13, s[20:23], s3 offen offset:1024 lds
s_add_u32 s33, s33, 131072
s_waitcnt lgkmcnt(0)
v_mfma_f32_32x32x16_bf16 v[128:143], v[32:35], v[44:47], v[128:143]
ds_read_b64_tr_b16 v[52:53], v16 offset:3072
ds_read_b64_tr_b16 v[54:55], v16 offset:3840
ds_read_b64 v[64:65], v17 offset:4096
ds_read_b64 v[66:67], v17 offset:5120
v_mfma_f32_32x32x16_bf16 v[144:159], v[32:35], v[48:51], v[144:159]
ds_read_b64 v[68:69], v73 offset:4096
ds_read_b64 v[70:71], v73 offset:5120
ds_read_b64_tr_b16 v[56:57], v16 offset:3104
ds_read_b64_tr_b16 v[58:59], v16 offset:3872
v_mfma_f32_32x32x16_bf16 v[160:175], v[36:39], v[44:47], v[160:175]
ds_read_b64_tr_b16 v[60:61], v16 offset:3136
ds_read_b64_tr_b16 v[62:63], v16 offset:3904
ds_read_b64 v[76:77], v105 offset:0
ds_read_b64 v[78:79], v105 offset:1024
v_mfma_f32_32x32x16_bf16 v[176:191], v[36:39], v[48:51], v[176:191]
ds_read_b64 v[80:81], v105 offset:128
ds_read_b64 v[82:83], v105 offset:1152
s_add_u32 m0, s34, 0
s_nop 0
buffer_load_dwordx4 v13, s[20:23], s32 offen lds
v_mfma_f32_32x32x16_bf16 v[192:207], v[40:43], v[44:47], v[192:207]
buffer_load_dwordx4 v13, s[20:23], s32 offen offset:1024 lds
v_mfma_f32_32x32x16_bf16 v[208:223], v[40:43], v[48:51], v[208:223]
buffer_load_dwordx4 v13, s[20:23], s32 offen offset:2048 lds
s_add_u32 s32, s32, 12288
s_waitcnt lgkmcnt(4)
v_mfma_f32_32x32x16_bf16 v[128:143], v[52:55], v[64:67], v[128:143]
s_waitcnt vmcnt(13)
s_barrier
ds_read_b64_tr_b16 v[32:33], v16 offset:20544
ds_read_b64_tr_b16 v[34:35], v16 offset:21312
ds_read_b64 v[44:45], v17 offset:20544
ds_read_b64 v[46:47], v17 offset:21568
v_mfma_f32_32x32x16_bf16 v[144:159], v[52:55], v[68:71], v[144:159]
ds_read_b64 v[48:49], v73 offset:20544
ds_read_b64 v[50:51], v73 offset:21568
ds_read_b64_tr_b16 v[36:37], v16 offset:20576
ds_read_b64_tr_b16 v[38:39], v16 offset:21344
v_mfma_f32_32x32x16_bf16 v[160:175], v[56:59], v[64:67], v[160:175]
ds_read_b64_tr_b16 v[40:41], v16 offset:20608
ds_read_b64_tr_b16 v[42:43], v16 offset:21376
s_waitcnt lgkmcnt(10)
v_mfma_f32_16x16x32_bf16 v[84:87], v[76:79], v[76:79], v[84:87]
v_mfma_f32_32x32x16_bf16 v[176:191], v[56:59], v[68:71], v[176:191]
v_mfma_f32_16x16x32_bf16 v[92:95], v[100:103], v[76:79], v[92:95]
v_mfma_f32_32x32x16_bf16 v[192:207], v[60:63], v[64:67], v[192:207]
v_mfma_f32_16x16x32_bf16 v[88:91], v[80:83], v[80:83], v[88:91]
s_add_u32 m0, s35, 0
s_nop 0
buffer_load_dwordx4 v13, s[20:23], s33 offen lds
s_add_u32 s3, s33, 15360
v_mfma_f32_32x32x16_bf16 v[208:223], v[60:63], v[68:71], v[208:223]
v_mfma_f32_16x16x32_bf16 v[96:99], v[100:103], v[80:83], v[96:99]
buffer_load_dwordx4 v13, s[20:23], s3 offen offset:1024 lds
s_add_u32 s33, s33, 131072
s_waitcnt lgkmcnt(0)
v_mfma_f32_32x32x16_bf16 v[128:143], v[32:35], v[44:47], v[128:143]
ds_read_b64_tr_b16 v[52:53], v16 offset:23616
ds_read_b64_tr_b16 v[54:55], v16 offset:24384
ds_read_b64 v[64:65], v17 offset:24640
ds_read_b64 v[66:67], v17 offset:25664
v_mfma_f32_32x32x16_bf16 v[144:159], v[32:35], v[48:51], v[144:159]
ds_read_b64 v[68:69], v73 offset:24640
ds_read_b64 v[70:71], v73 offset:25664
ds_read_b64_tr_b16 v[56:57], v16 offset:23648
ds_read_b64_tr_b16 v[58:59], v16 offset:24416
v_mfma_f32_32x32x16_bf16 v[160:175], v[36:39], v[44:47], v[160:175]
ds_read_b64_tr_b16 v[60:61], v16 offset:23680
ds_read_b64_tr_b16 v[62:63], v16 offset:24448
ds_read_b64 v[76:77], v105 offset:20544
ds_read_b64 v[78:79], v105 offset:21568
v_mfma_f32_32x32x16_bf16 v[176:191], v[36:39], v[48:51], v[176:191]
ds_read_b64 v[80:81], v105 offset:20672
ds_read_b64 v[82:83], v105 offset:21696
s_add_u32 m0, s34, 20544
s_nop 0
buffer_load_dwordx4 v13, s[20:23], s32 offen lds
v_mfma_f32_32x32x16_bf16 v[192:207], v[40:43], v[44:47], v[192:207]
buffer_load_dwordx4 v13, s[20:23], s32 offen offset:1024 lds
v_mfma_f32_32x32x16_bf16 v[208:223], v[40:43], v[48:51], v[208:223]
buffer_load_dwordx4 v13, s[20:23], s32 offen offset:2048 lds
s_add_u32 s32, s32, 12288
s_waitcnt lgkmcnt(4)
v_mfma_f32_32x32x16_bf16 v[128:143], v[52:55], v[64:67], v[128:143]
s_waitcnt vmcnt(13)
s_barrier
ds_read_b64_tr_b16 v[32:33], v16 offset:41088
ds_read_b64_tr_b16 v[34:35], v16 offset:41856
ds_read_b64 v[44:45], v17 offset:41088
ds_read_b64 v[46:47], v17 offset:42112
v_mfma_f32_32x32x16_bf16 v[144:159], v[52:55], v[68:71], v[144:159]
ds_read_b64 v[48:49], v73 offset:41088
ds_read_b64 v[50:51], v73 offset:42112
ds_read_b64_tr_b16 v[36:37], v16 offset:41120
ds_read_b64_tr_b16 v[38:39], v16 offset:41888
v_mfma_f32_32x32x16_bf16 v[160:175], v[56:59], v[64:67], v[160:175]
ds_read_b64_tr_b16 v[40:41], v16 offset:41152
ds_read_b64_tr_b16 v[42:43], v16 offset:41920
s_waitcnt lgkmcnt(10)
v_mfma_f32_16x16x32_bf16 v[84:87], v[76:79], v[76:79], v[84:87]
v_mfma_f32_32x32x16_bf16 v[176:191], v[56:59], v[68:71], v[176:191]
v_mfma_f32_16x16x32_bf16 v[92:95], v[100:103], v[76:79], v[92:95]
v_mfma_f32_32x32x16_bf16 v[192:207], v[60:63], v[64:67], v[192:207]
v_mfma_f32_16x16x32_bf16 v[88:91], v[80:83], v[80:83], v[88:91]
s_add_u32 m0, s35, 20544
s_nop 0
buffer_load_dwordx4 v13, s[20:23], s33 offen lds
s_add_u32 s3, s33, 15360
v_mfma_f32_32x32x16_bf16 v[208:223], v[60:63], v[68:71], v[208:223]
v_mfma_f32_16x16x32_bf16 v[96:99], v[100:103], v[80:83], v[96:99]
buffer_load_dwordx4 v13, s[20:23], s3 offen offset:1024 lds
s_add_u32 s33, s33, 131072
s_waitcnt lgkmcnt(0)
v_mfma_f32_32x32x16_bf16 v[128:143], v[32:35], v[44:47], v[128:143]
ds_read_b64_tr_b16 v[52:53], v16 offset:44160
ds_read_b64_tr_b16 v[54:55], v16 offset:44928
ds_read_b64 v[64:65], v17 offset:45184
ds_read_b64 v[66:67], v17 offset:46208
v_mfma_f32_32x32x16_bf16 v[144:159], v[32:35], v[48:51], v[144:159]
ds_read_b64 v[68:69], v73 offset:45184
ds_read_b64 v[70:71], v73 offset:46208
ds_read_b64_tr_b16 v[56:57], v16 offset:44192
ds_read_b64_tr_b16 v[58:59], v16 offset:44960
v_mfma_f32_32x32x16_bf16 v[160:175], v[36:39], v[44:47], v[160:175]
ds_read_b64_tr_b16 v[60:61], v16 offset:44224
ds_read_b64_tr_b16 v[62:63], v16 offset:44992
ds_read_b64 v[76:77], v105 offset:41088
ds_read_b64 v[78:79], v105 offset:42112
v_mfma_f32_32x32x16_bf16 v[176:191], v[36:39], v[48:51], v[176:191]
ds_read_b64 v[80:81], v105 offset:41216
ds_read_b64 v[82:83], v105 offset:42240
s_add_u32 m0, s34, 41088
s_nop 0
buffer_load_dwordx4 v13, s[20:23], s32 offen lds
v_mfma_f32_32x32x16_bf16 v[192:207], v[40:43], v[44:47], v[192:207]
buffer_load_dwordx4 v13, s[20:23], s32 offen offset:1024 lds
v_mfma_f32_32x32x16_bf16 v[208:223], v[40:43], v[48:51], v[208:223]
buffer_load_dwordx4 v13, s[20:23], s32 offen offset:2048 lds
s_add_u32 s32, s32, 12288
s_waitcnt lgkmcnt(4)
v_mfma_f32_32x32x16_bf16 v[128:143], v[52:55], v[64:67], v[128:143]
s_waitcnt vmcnt(13)
s_barrier
ds_read_b64_tr_b16 v[32:33], v18 offset:0
ds_read_b64_tr_b16 v[34:35], v18 offset:768
ds_read_b64 v[44:45], v19 offset:0
ds_read_b64 v[46:47], v19 offset:1024
v_mfma_f32_32x32x16_bf16 v[144:159], v[52:55], v[68:71], v[144:159]
ds_read_b64 v[48:49], v74 offset:0
ds_read_b64 v[50:51], v74 offset:1024
ds_read_b64_tr_b16 v[36:37], v18 offset:32
ds_read_b64_tr_b16 v[38:39], v18 offset:800
v_mfma_f32_32x32x16_bf16 v[160:175], v[56:59], v[64:67], v[160:175]
ds_read_b64_tr_b16 v[40:41], v18 offset:64
ds_read_b64_tr_b16 v[42:43], v18 offset:832
s_waitcnt lgkmcnt(10)
v_mfma_f32_16x16x32_bf16 v[84:87], v[76:79], v[76:79], v[84:87]
v_mfma_f32_32x32x16_bf16 v[176:191], v[56:59], v[68:71], v[176:191]
v_mfma_f32_16x16x32_bf16 v[92:95], v[100:103], v[76:79], v[92:95]
v_mfma_f32_32x32x16_bf16 v[192:207], v[60:63], v[64:67], v[192:207]
v_mfma_f32_16x16x32_bf16 v[88:91], v[80:83], v[80:83], v[88:91]
s_add_u32 m0, s35, 41088
s_nop 0
buffer_load_dwordx4 v13, s[20:23], s33 offen lds
s_add_u32 s3, s33, 15360
v_mfma_f32_32x32x16_bf16 v[208:223], v[60:63], v[68:71], v[208:223]
v_mfma_f32_16x16x32_bf16 v[96:99], v[100:103], v[80:83], v[96:99]
buffer_load_dwordx4 v13, s[20:23], s3 offen offset:1024 lds
s_add_u32 s33, s33, 131072
s_waitcnt lgkmcnt(0)
v_mfma_f32_32x32x16_bf16 v[128:143], v[32:35], v[44:47], v[128:143]
ds_read_b64_tr_b16 v[52:53], v18 offset:3072
ds_read_b64_tr_b16 v[54:55], v18 offset:3840
ds_read_b64 v[64:65], v19 offset:4096
ds_read_b64 v[66:67], v19 offset:5120
v_mfma_f32_32x32x16_bf16 v[144:159], v[32:35], v[48:51], v[144:159]
ds_read_b64 v[68:69], v74 offset:4096
ds_read_b64 v[70:71], v74 offset:5120
ds_read_b64_tr_b16 v[56:57], v18 offset:3104
ds_read_b64_tr_b16 v[58:59], v18 offset:3872
v_mfma_f32_32x32x16_bf16 v[160:175], v[36:39], v[44:47], v[160:175]
ds_read_b64_tr_b16 v[60:61], v18 offset:3136
ds_read_b64_tr_b16 v[62:63], v18 offset:3904
ds_read_b64 v[76:77], v106 offset:0
ds_read_b64 v[78:79], v106 offset:1024
v_mfma_f32_32x32x16_bf16 v[176:191], v[36:39], v[48:51], v[176:191]
ds_read_b64 v[80:81], v106 offset:128
ds_read_b64 v[82:83], v106 offset:1152
s_add_u32 m0, s34, 61632
s_nop 0
buffer_load_dwordx4 v13, s[20:23], s32 offen lds
v_mfma_f32_32x32x16_bf16 v[192:207], v[40:43], v[44:47], v[192:207]
buffer_load_dwordx4 v13, s[20:23], s32 offen offset:1024 lds
v_mfma_f32_32x32x16_bf16 v[208:223], v[40:43], v[48:51], v[208:223]
buffer_load_dwordx4 v13, s[20:23], s32 offen offset:2048 lds
s_add_u32 s32, s32, 12288
s_waitcnt lgkmcnt(4)
v_mfma_f32_32x32x16_bf16 v[128:143], v[52:55], v[64:67], v[128:143]
s_waitcnt vmcnt(13)
s_barrier
ds_read_b64_tr_b16 v[32:33], v14 offset:0
ds_read_b64_tr_b16 v[34:35], v14 offset:768
ds_read_b64 v[44:45], v15 offset:0
ds_read_b64 v[46:47], v15 offset:1024
v_mfma_f32_32x32x16_bf16 v[144:159], v[52:55], v[68:71], v[144:159]
ds_read_b64 v[48:49], v72 offset:0
ds_read_b64 v[50:51], v72 offset:1024
ds_read_b64_tr_b16 v[36:37], v14 offset:32
ds_read_b64_tr_b16 v[38:39], v14 offset:800
v_mfma_f32_32x32x16_bf16 v[160:175], v[56:59], v[64:67], v[160:175]
ds_read_b64_tr_b16 v[40:41], v14 offset:64
ds_read_b64_tr_b16 v[42:43], v14 offset:832
s_waitcnt lgkmcnt(10)
v_mfma_f32_16x16x32_bf16 v[84:87], v[76:79], v[76:79], v[84:87]
v_mfma_f32_32x32x16_bf16 v[176:191], v[56:59], v[68:71], v[176:191]
v_mfma_f32_16x16x32_bf16 v[92:95], v[100:103], v[76:79], v[92:95]
v_mfma_f32_32x32x16_bf16 v[192:207], v[60:63], v[64:67], v[192:207]
v_mfma_f32_16x16x32_bf16 v[88:91], v[80:83], v[80:83], v[88:91]
s_add_u32 m0, s35, 61632
s_nop 0
buffer_load_dwordx4 v13, s[20:23], s33 offen lds
s_add_u32 s3, s33, 15360
v_mfma_f32_32x32x16_bf16 v[208:223], v[60:63], v[68:71], v[208:223]
v_mfma_f32_16x16x32_bf16 v[96:99], v[100:103], v[80:83], v[96:99]
buffer_load_dwordx4 v13, s[20:23], s3 offen offset:1024 lds
s_add_u32 s33, s33, 131072
s_waitcnt lgkmcnt(0)
v_mfma_f32_32x32x16_bf16 v[128:143], v[32:35], v[44:47], v[128:143]
ds_read_b64_tr_b16 v[52:53], v14 offset:3072
ds_read_b64_tr_b16 v[54:55], v14 offset:3840
ds_read_b64 v[64:65], v15 offset:4096
ds_read_b64 v[66:67], v15 offset:5120
v_mfma_f32_32x32x16_bf16 v[144:159], v[32:35], v[48:51], v[144:159]
ds_read_b64 v[68:69], v72 offset:4096
ds_read_b64 v[70:71], v72 offset:5120
ds_read_b64_tr_b16 v[56:57], v14 offset:3104
ds_read_b64_tr_b16 v[58:59], v14 offset:3872
v_mfma_f32_32x32x16_bf16 v[160:175], v[36:39], v[44:47], v[160:175]
ds_read_b64_tr_b16 v[60:61], v14 offset:3136
ds_read_b64_tr_b16 v[62:63], v14 offset:3904
ds_read_b64 v[76:77], v104 offset:0
ds_read_b64 v[78:79], v104 offset:1024
v_mfma_f32_32x32x16_bf16 v[176:191], v[36:39], v[48:51], v[176:191]
ds_read_b64 v[80:81], v104 offset:128
ds_read_b64 v[82:83], v104 offset:1152
s_add_u32 m0, s34, 82176
s_nop 0
buffer_load_dwordx4 v13, s[20:23], s32 offen lds
v_mfma_f32_32x32x16_bf16 v[192:207], v[40:43], v[44:47], v[192:207]
buffer_load_dwordx4 v13, s[20:23], s32 offen offset:1024 lds
v_mfma_f32_32x32x16_bf16 v[208:223], v[40:43], v[48:51], v[208:223]
buffer_load_dwordx4 v13, s[20:23], s32 offen offset:2048 lds
s_add_u32 s32, s32, 12288
s_waitcnt lgkmcnt(4)
v_mfma_f32_32x32x16_bf16 v[128:143], v[52:55], v[64:67], v[128:143]
s_waitcnt vmcnt(13)
s_barrier
ds_read_b64_tr_b16 v[32:33], v14 offset:20544
ds_read_b64_tr_b16 v[34:35], v14 offset:21312
ds_read_b64 v[44:45], v15 offset:20544
ds_read_b64 v[46:47], v15 offset:21568
v_mfma_f32_32x32x16_bf16 v[144:159], v[52:55], v[68:71], v[144:159]
ds_read_b64 v[48:49], v72 offset:20544
ds_read_b64 v[50:51], v72 offset:21568
ds_read_b64_tr_b16 v[36:37], v14 offset:20576
ds_read_b64_tr_b16 v[38:39], v14 offset:21344
v_mfma_f32_32x32x16_bf16 v[160:175], v[56:59], v[64:67], v[160:175]
ds_read_b64_tr_b16 v[40:41], v14 offset:20608
ds_read_b64_tr_b16 v[42:43], v14 offset:21376
s_waitcnt lgkmcnt(10)
v_mfma_f32_16x16x32_bf16 v[84:87], v[76:79], v[76:79], v[84:87]
v_mfma_f32_32x32x16_bf16 v[176:191], v[56:59], v[68:71], v[176:191]
v_mfma_f32_16x16x32_bf16 v[92:95], v[100:103], v[76:79], v[92:95]
v_mfma_f32_32x32x16_bf16 v[192:207], v[60:63], v[64:67], v[192:207]
v_mfma_f32_16x16x32_bf16 v[88:91], v[80:83], v[80:83], v[88:91]
s_add_u32 m0, s35, 82176
s_nop 0
buffer_load_dwordx4 v13, s[20:23], s33 offen lds
s_add_u32 s3, s33, 15360
v_mfma_f32_32x32x16_bf16 v[208:223], v[60:63], v[68:71], v[208:223]
v_mfma_f32_16x16x32_bf16 v[96:99], v[100:103], v[80:83], v[96:99]
buffer_load_dwordx4 v13, s[20:23], s3 offen offset:1024 lds
s_add_u32 s33, s33, 131072
s_waitcnt lgkmcnt(0)
v_mfma_f32_32x32x16_bf16 v[128:143], v[32:35], v[44:47], v[128:143]
ds_read_b64_tr_b16 v[52:53], v14 offset:23616
ds_read_b64_tr_b16 v[54:55], v14 offset:24384
ds_read_b64 v[64:65], v15 offset:24640
ds_read_b64 v[66:67], v15 offset:25664
v_mfma_f32_32x32x16_bf16 v[144:159], v[32:35], v[48:51], v[144:159]
ds_read_b64 v[68:69], v72 offset:24640
ds_read_b64 v[70:71], v72 offset:25664
ds_read_b64_tr_b16 v[56:57], v14 offset:23648
ds_read_b64_tr_b16 v[58:59], v14 offset:24416
v_mfma_f32_32x32x16_bf16 v[160:175], v[36:39], v[44:47], v[160:175]
ds_read_b64_tr_b16 v[60:61], v14 offset:23680
ds_read_b64_tr_b16 v[62:63], v14 offset:24448
ds_read_b64 v[76:77], v104 offset:20544
ds_read_b64 v[78:79], v104 offset:21568
v_mfma_f32_32x32x16_bf16 v[176:191], v[36:39], v[48:51], v[176:191]
ds_read_b64 v[80:81], v104 offset:20672
ds_read_b64 v[82:83], v104 offset:21696
s_add_u32 m0, s34, 102720
s_nop 0
buffer_load_dwordx4 v13, s[20:23], s32 offen lds
v_mfma_f32_32x32x16_bf16 v[192:207], v[40:43], v[44:47], v[192:207]
buffer_load_dwordx4 v13, s[20:23], s32 offen offset:1024 lds
v_mfma_f32_32x32x16_bf16 v[208:223], v[40:43], v[48:51], v[208:223]
buffer_load_dwordx4 v13, s[20:23], s32 offen offset:2048 lds
s_add_u32 s32, s32, 12288
s_waitcnt lgkmcnt(4)
v_mfma_f32_32x32x16_bf16 v[128:143], v[52:55], v[64:67], v[128:143]
s_waitcnt vmcnt(13)
s_barrier
ds_read_b64_tr_b16 v[32:33], v14 offset:41088
ds_read_b64_tr_b16 v[34:35], v14 offset:41856
ds_read_b64 v[44:45], v15 offset:41088
ds_read_b64 v[46:47], v15 offset:42112
v_mfma_f32_32x32x16_bf16 v[144:159], v[52:55], v[68:71], v[144:159]
ds_read_b64 v[48:49], v72 offset:41088
ds_read_b64 v[50:51], v72 offset:42112
ds_read_b64_tr_b16 v[36:37], v14 offset:41120
ds_read_b64_tr_b16 v[38:39], v14 offset:41888
v_mfma_f32_32x32x16_bf16 v[160:175], v[56:59], v[64:67], v[160:175]
ds_read_b64_tr_b16 v[40:41], v14 offset:41152
ds_read_b64_tr_b16 v[42:43], v14 offset:41920
s_waitcnt lgkmcnt(10)
v_mfma_f32_16x16x32_bf16 v[84:87], v[76:79], v[76:79], v[84:87]
v_mfma_f32_32x32x16_bf16 v[176:191], v[56:59], v[68:71], v[176:191]
v_mfma_f32_16x16x32_bf16 v[92:95], v[100:103], v[76:79], v[92:95]
v_mfma_f32_32x32x16_bf16 v[192:207], v[60:63], v[64:67], v[192:207]
v_mfma_f32_16x16x32_bf16 v[88:91], v[80:83], v[80:83], v[88:91]
s_add_u32 m0, s35, 102720
s_nop 0
buffer_load_dwordx4 v13, s[20:23], s33 offen lds
s_add_u32 s3, s33, 15360
v_mfma_f32_32x32x16_bf16 v[208:223], v[60:63], v[68:71], v[208:223]
v_mfma_f32_16x16x32_bf16 v[96:99], v[100:103], v[80:83], v[96:99]
buffer_load_dwordx4 v13, s[20:23], s3 offen offset:1024 lds
s_add_u32 s33, s33, 131072
s_waitcnt lgkmcnt(0)
v_mfma_f32_32x32x16_bf16 v[128:143], v[32:35], v[44:47], v[128:143]
ds_read_b64_tr_b16 v[52:53], v14 offset:44160
ds_read_b64_tr_b16 v[54:55], v14 offset:44928
ds_read_b64 v[64:65], v15 offset:45184
ds_read_b64 v[66:67], v15 offset:46208
v_mfma_f32_32x32x16_bf16 v[144:159], v[32:35], v[48:51], v[144:159]
ds_read_b64 v[68:69], v72 offset:45184
ds_read_b64 v[70:71], v72 offset:46208
ds_read_b64_tr_b16 v[56:57], v14 offset:44192
ds_read_b64_tr_b16 v[58:59], v14 offset:44960
v_mfma_f32_32x32x16_bf16 v[160:175], v[36:39], v[44:47], v[160:175]
ds_read_b64_tr_b16 v[60:61], v14 offset:44224
ds_read_b64_tr_b16 v[62:63], v14 offset:44992
ds_read_b64 v[76:77], v104 offset:41088
ds_read_b64 v[78:79], v104 offset:42112
v_mfma_f32_32x32x16_bf16 v[176:191], v[36:39], v[48:51], v[176:191]
ds_read_b64 v[80:81], v104 offset:41216
ds_read_b64 v[82:83], v104 offset:42240
s_add_u32 m0, s34, 123264
s_nop 0
buffer_load_dwordx4 v13, s[20:23], s32 offen lds
v_mfma_f32_32x32x16_bf16 v[192:207], v[40:43], v[44:47], v[192:207]
buffer_load_dwordx4 v13, s[20:23], s32 offen offset:1024 lds
v_mfma_f32_32x32x16_bf16 v[208:223], v[40:43], v[48:51], v[208:223]
buffer_load_dwordx4 v13, s[20:23], s32 offen offset:2048 lds
s_add_u32 s32, s32, 12288
s_waitcnt lgkmcnt(4)
v_mfma_f32_32x32x16_bf16 v[128:143], v[52:55], v[64:67], v[128:143]
s_waitcnt vmcnt(13)
s_barrier
ds_read_b64_tr_b16 v[32:33], v16 offset:0
ds_read_b64_tr_b16 v[34:35], v16 offset:768
ds_read_b64 v[44:45], v17 offset:0
ds_read_b64 v[46:47], v17 offset:1024
v_mfma_f32_32x32x16_bf16 v[144:159], v[52:55], v[68:71], v[144:159]
ds_read_b64 v[48:49], v73 offset:0
ds_read_b64 v[50:51], v73 offset:1024
ds_read_b64_tr_b16 v[36:37], v16 offset:32
ds_read_b64_tr_b16 v[38:39], v16 offset:800
v_mfma_f32_32x32x16_bf16 v[160:175], v[56:59], v[64:67], v[160:175]
ds_read_b64_tr_b16 v[40:41], v16 offset:64
ds_read_b64_tr_b16 v[42:43], v16 offset:832
s_waitcnt lgkmcnt(10)
v_mfma_f32_16x16x32_bf16 v[84:87], v[76:79], v[76:79], v[84:87]
v_mfma_f32_32x32x16_bf16 v[176:191], v[56:59], v[68:71], v[176:191]
v_mfma_f32_16x16x32_bf16 v[92:95], v[100:103], v[76:79], v[92:95]
v_mfma_f32_32x32x16_bf16 v[192:207], v[60:63], v[64:67], v[192:207]
v_mfma_f32_16x16x32_bf16 v[88:91], v[80:83], v[80:83], v[88:91]
s_add_u32 m0, s35, 123264
s_nop 0
buffer_load_dwordx4 v13, s[20:23], s33 offen lds
s_add_u32 s3, s33, 15360
v_mfma_f32_32x32x16_bf16 v[208:223], v[60:63], v[68:71], v[208:223]
v_mfma_f32_16x16x32_bf16 v[96:99], v[100:103], v[80:83], v[96:99]
buffer_load_dwordx4 v13, s[20:23], s3 offen offset:1024 lds
s_add_u32 s33, s33, 131072
s_waitcnt lgkmcnt(0)
v_mfma_f32_32x32x16_bf16 v[128:143], v[32:35], v[44:47], v[128:143]
ds_read_b64_tr_b16 v[52:53], v16 offset:3072
ds_read_b64_tr_b16 v[54:55], v16 offset:3840
ds_read_b64 v[64:65], v17 offset:4096
ds_read_b64 v[66:67], v17 offset:5120
v_mfma_f32_32x32x16_bf16 v[144:159], v[32:35], v[48:51], v[144:159]
ds_read_b64 v[68:69], v73 offset:4096
ds_read_b64 v[70:71], v73 offset:5120
ds_read_b64_tr_b16 v[56:57], v16 offset:3104
ds_read_b64_tr_b16 v[58:59], v16 offset:3872
v_mfma_f32_32x32x16_bf16 v[160:175], v[36:39], v[44:47], v[160:175]
ds_read_b64_tr_b16 v[60:61], v16 offset:3136
ds_read_b64_tr_b16 v[62:63], v16 offset:3904
ds_read_b64 v[76:77], v105 offset:0
ds_read_b64 v[78:79], v105 offset:1024
v_mfma_f32_32x32x16_bf16 v[176:191], v[36:39], v[48:51], v[176:191]
ds_read_b64 v[80:81], v105 offset:128
ds_read_b64 v[82:83], v105 offset:1152
s_add_u32 m0, s34, 0
s_nop 0
buffer_load_dwordx4 v13, s[20:23], s32 offen lds
v_mfma_f32_32x32x16_bf16 v[192:207], v[40:43], v[44:47], v[192:207]
buffer_load_dwordx4 v13, s[20:23], s32 offen offset:1024 lds
v_mfma_f32_32x32x16_bf16 v[208:223], v[40:43], v[48:51], v[208:223]
buffer_load_dwordx4 v13, s[20:23], s32 offen offset:2048 lds
s_add_u32 s32, s32, 12288
s_waitcnt lgkmcnt(4)
v_mfma_f32_32x32x16_bf16 v[128:143], v[52:55], v[64:67], v[128:143]
s_waitcnt vmcnt(13)
s_barrier
ds_read_b64_tr_b16 v[32:33], v16 offset:20544
ds_read_b64_tr_b16 v[34:35], v16 offset:21312
ds_read_b64 v[44:45], v17 offset:20544
ds_read_b64 v[46:47], v17 offset:21568
v_mfma_f32_32x32x16_bf16 v[144:159], v[52:55], v[68:71], v[144:159]
ds_read_b64 v[48:49], v73 offset:20544
ds_read_b64 v[50:51], v73 offset:21568
ds_read_b64_tr_b16 v[36:37], v16 offset:20576
ds_read_b64_tr_b16 v[38:39], v16 offset:21344
v_mfma_f32_32x32x16_bf16 v[160:175], v[56:59], v[64:67], v[160:175]
ds_read_b64_tr_b16 v[40:41], v16 offset:20608
ds_read_b64_tr_b16 v[42:43], v16 offset:21376
s_waitcnt lgkmcnt(10)
v_mfma_f32_16x16x32_bf16 v[84:87], v[76:79], v[76:79], v[84:87]
v_mfma_f32_32x32x16_bf16 v[176:191], v[56:59], v[68:71], v[176:191]
v_mfma_f32_16x16x32_bf16 v[92:95], v[100:103], v[76:79], v[92:95]
v_mfma_f32_32x32x16_bf16 v[192:207], v[60:63], v[64:67], v[192:207]
v_mfma_f32_16x16x32_bf16 v[88:91], v[80:83], v[80:83], v[88:91]
s_add_u32 m0, s35, 0
s_nop 0
buffer_load_dwordx4 v13, s[20:23], s33 offen lds
s_add_u32 s3, s33, 15360
v_mfma_f32_32x32x16_bf16 v[208:223], v[60:63], v[68:71], v[208:223]
v_mfma_f32_16x16x32_bf16 v[96:99], v[100:103], v[80:83], v[96:99]
buffer_load_dwordx4 v13, s[20:23], s3 offen offset:1024 lds
s_add_u32 s33, s33, 131072
s_waitcnt lgkmcnt(0)
v_mfma_f32_32x32x16_bf16 v[128:143], v[32:35], v[44:47], v[128:143]
ds_read_b64_tr_b16 v[52:53], v16 offset:23616
ds_read_b64_tr_b16 v[54:55], v16 offset:24384
ds_read_b64 v[64:65], v17 offset:24640
ds_read_b64 v[66:67], v17 offset:25664
v_mfma_f32_32x32x16_bf16 v[144:159], v[32:35], v[48:51], v[144:159]
ds_read_b64 v[68:69], v73 offset:24640
ds_read_b64 v[70:71], v73 offset:25664
ds_read_b64_tr_b16 v[56:57], v16 offset:23648
ds_read_b64_tr_b16 v[58:59], v16 offset:24416
v_mfma_f32_32x32x16_bf16 v[160:175], v[36:39], v[44:47], v[160:175]
ds_read_b64_tr_b16 v[60:61], v16 offset:23680
ds_read_b64_tr_b16 v[62:63], v16 offset:24448
ds_read_b64 v[76:77], v105 offset:20544
ds_read_b64 v[78:79], v105 offset:21568
v_mfma_f32_32x32x16_bf16 v[176:191], v[36:39], v[48:51], v[176:191]
ds_read_b64 v[80:81], v105 offset:20672
ds_read_b64 v[82:83], v105 offset:21696
s_add_u32 m0, s34, 20544
s_nop 0
buffer_load_dwordx4 v13, s[20:23], s32 offen lds
v_mfma_f32_32x32x16_bf16 v[192:207], v[40:43], v[44:47], v[192:207]
buffer_load_dwordx4 v13, s[20:23], s32 offen offset:1024 lds
v_mfma_f32_32x32x16_bf16 v[208:223], v[40:43], v[48:51], v[208:223]
buffer_load_dwordx4 v13, s[20:23], s32 offen offset:2048 lds
s_add_u32 s32, s32, 12288
s_waitcnt lgkmcnt(4)
v_mfma_f32_32x32x16_bf16 v[128:143], v[52:55], v[64:67], v[128:143]
s_waitcnt vmcnt(13)
s_barrier
ds_read_b64_tr_b16 v[32:33], v16 offset:41088
ds_read_b64_tr_b16 v[34:35], v16 offset:41856
ds_read_b64 v[44:45], v17 offset:41088
ds_read_b64 v[46:47], v17 offset:42112
v_mfma_f32_32x32x16_bf16 v[144:159], v[52:55], v[68:71], v[144:159]
ds_read_b64 v[48:49], v73 offset:41088
ds_read_b64 v[50:51], v73 offset:42112
ds_read_b64_tr_b16 v[36:37], v16 offset:41120
ds_read_b64_tr_b16 v[38:39], v16 offset:41888
v_mfma_f32_32x32x16_bf16 v[160:175], v[56:59], v[64:67], v[160:175]
ds_read_b64_tr_b16 v[40:41], v16 offset:41152
ds_read_b64_tr_b16 v[42:43], v16 offset:41920
s_waitcnt lgkmcnt(10)
v_mfma_f32_16x16x32_bf16 v[84:87], v[76:79], v[76:79], v[84:87]
v_mfma_f32_32x32x16_bf16 v[176:191], v[56:59], v[68:71], v[176:191]
v_mfma_f32_16x16x32_bf16 v[92:95], v[100:103], v[76:79], v[92:95]
v_mfma_f32_32x32x16_bf16 v[192:207], v[60:63], v[64:67], v[192:207]
v_mfma_f32_16x16x32_bf16 v[88:91], v[80:83], v[80:83], v[88:91]
s_add_u32 m0, s35, 20544
s_nop 0
buffer_load_dwordx4 v13, s[20:23], s33 offen lds
s_add_u32 s3, s33, 15360
v_mfma_f32_32x32x16_bf16 v[208:223], v[60:63], v[68:71], v[208:223]
v_mfma_f32_16x16x32_bf16 v[96:99], v[100:103], v[80:83], v[96:99]
buffer_load_dwordx4 v13, s[20:23], s3 offen offset:1024 lds
s_add_u32 s33, s33, 131072
s_waitcnt lgkmcnt(0)
v_mfma_f32_32x32x16_bf16 v[128:143], v[32:35], v[44:47], v[128:143]
ds_read_b64_tr_b16 v[52:53], v16 offset:44160
ds_read_b64_tr_b16 v[54:55], v16 offset:44928
ds_read_b64 v[64:65], v17 offset:45184
ds_read_b64 v[66:67], v17 offset:46208
v_mfma_f32_32x32x16_bf16 v[144:159], v[32:35], v[48:51], v[144:159]
ds_read_b64 v[68:69], v73 offset:45184
ds_read_b64 v[70:71], v73 offset:46208
ds_read_b64_tr_b16 v[56:57], v16 offset:44192
ds_read_b64_tr_b16 v[58:59], v16 offset:44960
v_mfma_f32_32x32x16_bf16 v[160:175], v[36:39], v[44:47], v[160:175]
ds_read_b64_tr_b16 v[60:61], v16 offset:44224
ds_read_b64_tr_b16 v[62:63], v16 offset:44992
ds_read_b64 v[76:77], v105 offset:41088
ds_read_b64 v[78:79], v105 offset:42112
v_mfma_f32_32x32x16_bf16 v[176:191], v[36:39], v[48:51], v[176:191]
ds_read_b64 v[80:81], v105 offset:41216
ds_read_b64 v[82:83], v105 offset:42240
s_add_u32 m0, s34, 41088
s_nop 0
buffer_load_dwordx4 v13, s[20:23], s32 offen lds
v_mfma_f32_32x32x16_bf16 v[192:207], v[40:43], v[44:47], v[192:207]
buffer_load_dwordx4 v13, s[20:23], s32 offen offset:1024 lds
v_mfma_f32_32x32x16_bf16 v[208:223], v[40:43], v[48:51], v[208:223]
buffer_load_dwordx4 v13, s[20:23], s32 offen offset:2048 lds
s_add_u32 s32, s32, 12288
s_waitcnt lgkmcnt(4)
v_mfma_f32_32x32x16_bf16 v[128:143], v[52:55], v[64:67], v[128:143]
s_waitcnt vmcnt(13)
s_barrier
ds_read_b64_tr_b16 v[32:33], v18 offset:0
ds_read_b64_tr_b16 v[34:35], v18 offset:768
ds_read_b64 v[44:45], v19 offset:0
ds_read_b64 v[46:47], v19 offset:1024
v_mfma_f32_32x32x16_bf16 v[144:159], v[52:55], v[68:71], v[144:159]
ds_read_b64 v[48:49], v74 offset:0
ds_read_b64 v[50:51], v74 offset:1024
ds_read_b64_tr_b16 v[36:37], v18 offset:32
ds_read_b64_tr_b16 v[38:39], v18 offset:800
v_mfma_f32_32x32x16_bf16 v[160:175], v[56:59], v[64:67], v[160:175]
ds_read_b64_tr_b16 v[40:41], v18 offset:64
ds_read_b64_tr_b16 v[42:43], v18 offset:832
s_waitcnt lgkmcnt(10)
v_mfma_f32_16x16x32_bf16 v[84:87], v[76:79], v[76:79], v[84:87]
v_mfma_f32_32x32x16_bf16 v[176:191], v[56:59], v[68:71], v[176:191]
v_mfma_f32_16x16x32_bf16 v[92:95], v[100:103], v[76:79], v[92:95]
v_mfma_f32_32x32x16_bf16 v[192:207], v[60:63], v[64:67], v[192:207]
v_mfma_f32_16x16x32_bf16 v[88:91], v[80:83], v[80:83], v[88:91]
s_add_u32 m0, s35, 41088
s_nop 0
buffer_load_dwordx4 v13, s[20:23], s33 offen lds
s_add_u32 s3, s33, 15360
v_mfma_f32_32x32x16_bf16 v[208:223], v[60:63], v[68:71], v[208:223]
v_mfma_f32_16x16x32_bf16 v[96:99], v[100:103], v[80:83], v[96:99]
buffer_load_dwordx4 v13, s[20:23], s3 offen offset:1024 lds
s_add_u32 s33, s33, 131072
s_waitcnt lgkmcnt(0)
v_mfma_f32_32x32x16_bf16 v[128:143], v[32:35], v[44:47], v[128:143]
ds_read_b64_tr_b16 v[52:53], v18 offset:3072
ds_read_b64_tr_b16 v[54:55], v18 offset:3840
ds_read_b64 v[64:65], v19 offset:4096
ds_read_b64 v[66:67], v19 offset:5120
v_mfma_f32_32x32x16_bf16 v[144:159], v[32:35], v[48:51], v[144:159]
ds_read_b64 v[68:69], v74 offset:4096
ds_read_b64 v[70:71], v74 offset:5120
ds_read_b64_tr_b16 v[56:57], v18 offset:3104
ds_read_b64_tr_b16 v[58:59], v18 offset:3872
v_mfma_f32_32x32x16_bf16 v[160:175], v[36:39], v[44:47], v[160:175]
ds_read_b64_tr_b16 v[60:61], v18 offset:3136
ds_read_b64_tr_b16 v[62:63], v18 offset:3904
ds_read_b64 v[76:77], v106 offset:0
ds_read_b64 v[78:79], v106 offset:1024
v_mfma_f32_32x32x16_bf16 v[176:191], v[36:39], v[48:51], v[176:191]
ds_read_b64 v[80:81], v106 offset:128
ds_read_b64 v[82:83], v106 offset:1152
s_add_u32 m0, s34, 61632
s_nop 0
buffer_load_dwordx4 v13, s[20:23], s32 offen lds
v_mfma_f32_32x32x16_bf16 v[192:207], v[40:43], v[44:47], v[192:207]
buffer_load_dwordx4 v13, s[20:23], s32 offen offset:1024 lds
v_mfma_f32_32x32x16_bf16 v[208:223], v[40:43], v[48:51], v[208:223]
buffer_load_dwordx4 v13, s[20:23], s32 offen offset:2048 lds
s_add_u32 s32, s32, 12288
s_waitcnt lgkmcnt(4)
v_mfma_f32_32x32x16_bf16 v[128:143], v[52:55], v[64:67], v[128:143]
s_waitcnt vmcnt(13)
s_barrier
ds_read_b64_tr_b16 v[32:33], v14 offset:0
ds_read_b64_tr_b16 v[34:35], v14 offset:768
ds_read_b64 v[44:45], v15 offset:0
ds_read_b64 v[46:47], v15 offset:1024
v_mfma_f32_32x32x16_bf16 v[144:159], v[52:55], v[68:71], v[144:159]
ds_read_b64 v[48:49], v72 offset:0
ds_read_b64 v[50:51], v72 offset:1024
ds_read_b64_tr_b16 v[36:37], v14 offset:32
ds_read_b64_tr_b16 v[38:39], v14 offset:800
v_mfma_f32_32x32x16_bf16 v[160:175], v[56:59], v[64:67], v[160:175]
ds_read_b64_tr_b16 v[40:41], v14 offset:64
ds_read_b64_tr_b16 v[42:43], v14 offset:832
s_waitcnt lgkmcnt(10)
v_mfma_f32_16x16x32_bf16 v[84:87], v[76:79], v[76:79], v[84:87]
v_mfma_f32_32x32x16_bf16 v[176:191], v[56:59], v[68:71], v[176:191]
v_mfma_f32_16x16x32_bf16 v[92:95], v[100:103], v[76:79], v[92:95]
v_mfma_f32_32x32x16_bf16 v[192:207], v[60:63], v[64:67], v[192:207]
v_mfma_f32_16x16x32_bf16 v[88:91], v[80:83], v[80:83], v[88:91]
s_add_u32 m0, s35, 61632
s_nop 0
buffer_load_dwordx4 v13, s[20:23], s33 offen lds
s_add_u32 s3, s33, 15360
v_mfma_f32_32x32x16_bf16 v[208:223], v[60:63], v[68:71], v[208:223]
v_mfma_f32_16x16x32_bf16 v[96:99], v[100:103], v[80:83], v[96:99]
buffer_load_dwordx4 v13, s[20:23], s3 offen offset:1024 lds
s_add_u32 s33, s33, 131072
s_waitcnt lgkmcnt(0)
v_mfma_f32_32x32x16_bf16 v[128:143], v[32:35], v[44:47], v[128:143]
ds_read_b64_tr_b16 v[52:53], v14 offset:3072
ds_read_b64_tr_b16 v[54:55], v14 offset:3840
ds_read_b64 v[64:65], v15 offset:4096
ds_read_b64 v[66:67], v15 offset:5120
v_mfma_f32_32x32x16_bf16 v[144:159], v[32:35], v[48:51], v[144:159]
ds_read_b64 v[68:69], v72 offset:4096
ds_read_b64 v[70:71], v72 offset:5120
ds_read_b64_tr_b16 v[56:57], v14 offset:3104
ds_read_b64_tr_b16 v[58:59], v14 offset:3872
v_mfma_f32_32x32x16_bf16 v[160:175], v[36:39], v[44:47], v[160:175]
ds_read_b64_tr_b16 v[60:61], v14 offset:3136
ds_read_b64_tr_b16 v[62:63], v14 offset:3904
ds_read_b64 v[76:77], v104 offset:0
ds_read_b64 v[78:79], v104 offset:1024
s_add_u32 m0, s34, 82176
s_nop 0
buffer_load_dwordx4 v13, s[20:23], s32 offen lds
v_mfma_f32_32x32x16_bf16 v[176:191], v[36:39], v[48:51], v[176:191]
ds_read_b64 v[80:81], v104 offset:128
ds_read_b64 v[82:83], v104 offset:1152
buffer_load_dwordx4 v13, s[20:23], s32 offen offset:1024 lds
v_mfma_f32_32x32x16_bf16 v[192:207], v[40:43], v[44:47], v[192:207]
buffer_load_dwordx4 v13, s[20:23], s32 offen offset:2048 lds
s_add_u32 s32, s32, 12288
v_mfma_f32_32x32x16_bf16 v[208:223], v[40:43], v[48:51], v[208:223]
s_add_u32 m0, s35, 82176
s_nop 0
buffer_load_dwordx4 v13, s[20:23], s33 offen lds
s_add_u32 s3, s33, 15360
s_waitcnt lgkmcnt(4)
v_mfma_f32_32x32x16_bf16 v[128:143], v[52:55], v[64:67], v[128:143]
s_waitcnt vmcnt(14)
s_barrier
ds_read_b64_tr_b16 v[32:33], v14 offset:20544
ds_read_b64_tr_b16 v[34:35], v14 offset:21312
ds_read_b64 v[44:45], v15 offset:20544
ds_read_b64 v[46:47], v15 offset:21568
v_mfma_f32_32x32x16_bf16 v[144:159], v[52:55], v[68:71], v[144:159]
ds_read_b64 v[48:49], v72 offset:20544
ds_read_b64 v[50:51], v72 offset:21568
ds_read_b64_tr_b16 v[36:37], v14 offset:20576
ds_read_b64_tr_b16 v[38:39], v14 offset:21344
v_mfma_f32_32x32x16_bf16 v[160:175], v[56:59], v[64:67], v[160:175]
ds_read_b64_tr_b16 v[40:41], v14 offset:20608
ds_read_b64_tr_b16 v[42:43], v14 offset:21376
s_waitcnt lgkmcnt(10)
v_mfma_f32_16x16x32_bf16 v[84:87], v[76:79], v[76:79], v[84:87]
buffer_load_dwordx4 v13, s[20:23], s3 offen offset:1024 lds
s_add_u32 s33, s33, 131072
v_mfma_f32_32x32x16_bf16 v[176:191], v[56:59], v[68:71], v[176:191]
v_mfma_f32_16x16x32_bf16 v[92:95], v[100:103], v[76:79], v[92:95]
buffer_load_dwordx4 v[20:23], v75, s[20:23], s40 offen offset:0
v_mfma_f32_32x32x16_bf16 v[192:207], v[60:63], v[64:67], v[192:207]
v_mfma_f32_16x16x32_bf16 v[88:91], v[80:83], v[80:83], v[88:91]
buffer_load_dwordx4 v[24:27], v75, s[20:23], s40 offen offset:256
v_mfma_f32_32x32x16_bf16 v[208:223], v[60:63], v[68:71], v[208:223]
v_mfma_f32_16x16x32_bf16 v[96:99], v[100:103], v[80:83], v[96:99]
buffer_load_dwordx4 v[28:31], v75, s[20:23], s40 offen offset:512
s_waitcnt lgkmcnt(0)
v_mfma_f32_32x32x16_bf16 v[128:143], v[32:35], v[44:47], v[128:143]
ds_read_b64_tr_b16 v[52:53], v14 offset:23616
ds_read_b64_tr_b16 v[54:55], v14 offset:24384
ds_read_b64 v[64:65], v15 offset:24640
ds_read_b64 v[66:67], v15 offset:25664
v_mfma_f32_32x32x16_bf16 v[144:159], v[32:35], v[48:51], v[144:159]
ds_read_b64 v[68:69], v72 offset:24640
ds_read_b64 v[70:71], v72 offset:25664
ds_read_b64_tr_b16 v[56:57], v14 offset:23648
ds_read_b64_tr_b16 v[58:59], v14 offset:24416
v_mfma_f32_32x32x16_bf16 v[160:175], v[36:39], v[44:47], v[160:175]
ds_read_b64_tr_b16 v[60:61], v14 offset:23680
ds_read_b64_tr_b16 v[62:63], v14 offset:24448
ds_read_b64 v[76:77], v104 offset:20544
ds_read_b64 v[78:79], v104 offset:21568
v_mfma_f32_32x32x16_bf16 v[176:191], v[36:39], v[48:51], v[176:191]
ds_read_b64 v[80:81], v104 offset:20672
ds_read_b64 v[82:83], v104 offset:21696
s_add_u32 m0, s34, 102720
s_nop 0
buffer_load_dwordx4 v13, s[20:23], s32 offen lds
v_mfma_f32_32x32x16_bf16 v[192:207], v[40:43], v[44:47], v[192:207]
buffer_load_dwordx4 v13, s[20:23], s32 offen offset:1024 lds
v_mfma_f32_32x32x16_bf16 v[208:223], v[40:43], v[48:51], v[208:223]
buffer_load_dwordx4 v13, s[20:23], s32 offen offset:2048 lds
s_add_u32 s32, s32, 12288
s_waitcnt lgkmcnt(4)
v_mfma_f32_32x32x16_bf16 v[128:143], v[52:55], v[64:67], v[128:143]
s_waitcnt vmcnt(16)
s_barrier
ds_read_b64_tr_b16 v[32:33], v14 offset:41088
ds_read_b64_tr_b16 v[34:35], v14 offset:41856
ds_read_b64 v[44:45], v15 offset:41088
ds_read_b64 v[46:47], v15 offset:42112
v_mfma_f32_32x32x16_bf16 v[144:159], v[52:55], v[68:71], v[144:159]
ds_read_b64 v[48:49], v72 offset:41088
ds_read_b64 v[50:51], v72 offset:42112
ds_read_b64_tr_b16 v[36:37], v14 offset:41120
ds_read_b64_tr_b16 v[38:39], v14 offset:41888
v_mfma_f32_32x32x16_bf16 v[160:175], v[56:59], v[64:67], v[160:175]
ds_read_b64_tr_b16 v[40:41], v14 offset:41152
ds_read_b64_tr_b16 v[42:43], v14 offset:41920
s_waitcnt lgkmcnt(10)
v_mfma_f32_16x16x32_bf16 v[84:87], v[76:79], v[76:79], v[84:87]
v_mfma_f32_32x32x16_bf16 v[176:191], v[56:59], v[68:71], v[176:191]
v_mfma_f32_16x16x32_bf16 v[92:95], v[100:103], v[76:79], v[92:95]
v_mfma_f32_32x32x16_bf16 v[192:207], v[60:63], v[64:67], v[192:207]
v_mfma_f32_16x16x32_bf16 v[88:91], v[80:83], v[80:83], v[88:91]
s_add_u32 m0, s35, 102720
s_nop 0
buffer_load_dwordx4 v13, s[20:23], s33 offen lds
s_add_u32 s3, s33, 15360
v_mfma_f32_32x32x16_bf16 v[208:223], v[60:63], v[68:71], v[208:223]
v_mfma_f32_16x16x32_bf16 v[96:99], v[100:103], v[80:83], v[96:99]
buffer_load_dwordx4 v13, s[20:23], s3 offen offset:1024 lds
s_add_u32 s33, s33, 131072
s_waitcnt lgkmcnt(0)
v_mfma_f32_32x32x16_bf16 v[128:143], v[32:35], v[44:47], v[128:143]
ds_read_b64_tr_b16 v[52:53], v14 offset:44160
ds_read_b64_tr_b16 v[54:55], v14 offset:44928
ds_read_b64 v[64:65], v15 offset:45184
ds_read_b64 v[66:67], v15 offset:46208
v_mfma_f32_32x32x16_bf16 v[144:159], v[32:35], v[48:51], v[144:159]
ds_read_b64 v[68:69], v72 offset:45184
ds_read_b64 v[70:71], v72 offset:46208
ds_read_b64_tr_b16 v[56:57], v14 offset:44192
ds_read_b64_tr_b16 v[58:59], v14 offset:44960
v_mfma_f32_32x32x16_bf16 v[160:175], v[36:39], v[44:47], v[160:175]
ds_read_b64_tr_b16 v[60:61], v14 offset:44224
ds_read_b64_tr_b16 v[62:63], v14 offset:44992
ds_read_b64 v[76:77], v104 offset:41088
ds_read_b64 v[78:79], v104 offset:42112
v_mfma_f32_32x32x16_bf16 v[176:191], v[36:39], v[48:51], v[176:191]
ds_read_b64 v[80:81], v104 offset:41216
ds_read_b64 v[82:83], v104 offset:42240
v_mfma_f32_32x32x16_bf16 v[192:207], v[40:43], v[44:47], v[192:207]
v_mfma_f32_32x32x16_bf16 v[208:223], v[40:43], v[48:51], v[208:223]
s_waitcnt lgkmcnt(4)
v_mfma_f32_32x32x16_bf16 v[128:143], v[52:55], v[64:67], v[128:143]
s_waitcnt vmcnt(13)
s_barrier
ds_read_b64_tr_b16 v[32:33], v16 offset:0
ds_read_b64_tr_b16 v[34:35], v16 offset:768
ds_read_b64 v[44:45], v17 offset:0
ds_read_b64 v[46:47], v17 offset:1024
v_mfma_f32_32x32x16_bf16 v[144:159], v[52:55], v[68:71], v[144:159]
ds_read_b64 v[48:49], v73 offset:0
ds_read_b64 v[50:51], v73 offset:1024
ds_read_b64_tr_b16 v[36:37], v16 offset:32
ds_read_b64_tr_b16 v[38:39], v16 offset:800
v_mfma_f32_32x32x16_bf16 v[160:175], v[56:59], v[64:67], v[160:175]
ds_read_b64_tr_b16 v[40:41], v16 offset:64
ds_read_b64_tr_b16 v[42:43], v16 offset:832
s_waitcnt lgkmcnt(10)
v_mfma_f32_16x16x32_bf16 v[84:87], v[76:79], v[76:79], v[84:87]
v_mfma_f32_32x32x16_bf16 v[176:191], v[56:59], v[68:71], v[176:191]
v_mfma_f32_16x16x32_bf16 v[92:95], v[100:103], v[76:79], v[92:95]
v_mfma_f32_32x32x16_bf16 v[192:207], v[60:63], v[64:67], v[192:207]
v_mfma_f32_16x16x32_bf16 v[88:91], v[80:83], v[80:83], v[88:91]
v_mfma_f32_32x32x16_bf16 v[208:223], v[60:63], v[68:71], v[208:223]
v_mfma_f32_16x16x32_bf16 v[96:99], v[100:103], v[80:83], v[96:99]
s_waitcnt lgkmcnt(0)
v_mfma_f32_32x32x16_bf16 v[128:143], v[32:35], v[44:47], v[128:143]
ds_read_b64_tr_b16 v[52:53], v16 offset:3072
ds_read_b64_tr_b16 v[54:55], v16 offset:3840
ds_read_b64 v[64:65], v17 offset:4096
ds_read_b64 v[66:67], v17 offset:5120
v_mfma_f32_32x32x16_bf16 v[144:159], v[32:35], v[48:51], v[144:159]
ds_read_b64 v[68:69], v73 offset:4096
ds_read_b64 v[70:71], v73 offset:5120
ds_read_b64_tr_b16 v[56:57], v16 offset:3104
ds_read_b64_tr_b16 v[58:59], v16 offset:3872
v_mfma_f32_32x32x16_bf16 v[160:175], v[36:39], v[44:47], v[160:175]
ds_read_b64_tr_b16 v[60:61], v16 offset:3136
ds_read_b64_tr_b16 v[62:63], v16 offset:3904
ds_read_b64 v[76:77], v105 offset:0
ds_read_b64 v[78:79], v105 offset:1024
v_mfma_f32_32x32x16_bf16 v[176:191], v[36:39], v[48:51], v[176:191]
ds_read_b64 v[80:81], v105 offset:128
ds_read_b64 v[82:83], v105 offset:1152
v_mfma_f32_32x32x16_bf16 v[192:207], v[40:43], v[44:47], v[192:207]
v_mfma_f32_32x32x16_bf16 v[208:223], v[40:43], v[48:51], v[208:223]
s_waitcnt lgkmcnt(4)
v_mfma_f32_32x32x16_bf16 v[128:143], v[52:55], v[64:67], v[128:143]
s_waitcnt vmcnt(0)
s_barrier
ds_read_b64_tr_b16 v[32:33], v16 offset:20544
ds_read_b64_tr_b16 v[34:35], v16 offset:21312
ds_read_b64 v[44:45], v17 offset:20544
ds_read_b64 v[46:47], v17 offset:21568
v_mfma_f32_32x32x16_bf16 v[144:159], v[52:55], v[68:71], v[144:159]
ds_read_b64 v[48:49], v73 offset:20544
ds_read_b64 v[50:51], v73 offset:21568
ds_read_b64_tr_b16 v[36:37], v16 offset:20576
ds_read_b64_tr_b16 v[38:39], v16 offset:21344
v_mfma_f32_32x32x16_bf16 v[160:175], v[56:59], v[64:67], v[160:175]
ds_read_b64_tr_b16 v[40:41], v16 offset:20608
ds_read_b64_tr_b16 v[42:43], v16 offset:21376
s_waitcnt lgkmcnt(10)
v_mfma_f32_16x16x32_bf16 v[84:87], v[76:79], v[76:79], v[84:87]
v_mfma_f32_32x32x16_bf16 v[176:191], v[56:59], v[68:71], v[176:191]
v_mfma_f32_16x16x32_bf16 v[92:95], v[100:103], v[76:79], v[92:95]
v_mfma_f32_32x32x16_bf16 v[192:207], v[60:63], v[64:67], v[192:207]
v_mfma_f32_16x16x32_bf16 v[88:91], v[80:83], v[80:83], v[88:91]
v_mfma_f32_32x32x16_bf16 v[208:223], v[60:63], v[68:71], v[208:223]
v_mfma_f32_16x16x32_bf16 v[96:99], v[100:103], v[80:83], v[96:99]
s_waitcnt lgkmcnt(0)
v_mfma_f32_32x32x16_bf16 v[128:143], v[32:35], v[44:47], v[128:143]
ds_read_b64_tr_b16 v[52:53], v16 offset:23616
ds_read_b64_tr_b16 v[54:55], v16 offset:24384
ds_read_b64 v[64:65], v17 offset:24640
ds_read_b64 v[66:67], v17 offset:25664
v_mfma_f32_32x32x16_bf16 v[144:159], v[32:35], v[48:51], v[144:159]
ds_read_b64 v[68:69], v73 offset:24640
ds_read_b64 v[70:71], v73 offset:25664
ds_read_b64_tr_b16 v[56:57], v16 offset:23648
ds_read_b64_tr_b16 v[58:59], v16 offset:24416
v_mfma_f32_32x32x16_bf16 v[160:175], v[36:39], v[44:47], v[160:175]
ds_read_b64_tr_b16 v[60:61], v16 offset:23680
ds_read_b64_tr_b16 v[62:63], v16 offset:24448
ds_read_b64 v[76:77], v105 offset:20544
ds_read_b64 v[78:79], v105 offset:21568
v_mfma_f32_32x32x16_bf16 v[176:191], v[36:39], v[48:51], v[176:191]
ds_read_b64 v[80:81], v105 offset:20672
ds_read_b64 v[82:83], v105 offset:21696
v_mfma_f32_32x32x16_bf16 v[192:207], v[40:43], v[44:47], v[192:207]
ds_read_b64 v[108:109], v105 offset:41088
ds_read_b64 v[110:111], v105 offset:42112
v_mfma_f32_32x32x16_bf16 v[208:223], v[40:43], v[48:51], v[208:223]
ds_read_b64 v[112:113], v105 offset:41216
ds_read_b64 v[114:115], v105 offset:42240
s_waitcnt lgkmcnt(8)
v_mfma_f32_32x32x16_bf16 v[128:143], v[52:55], v[64:67], v[128:143]
s_waitcnt vmcnt(0)
s_barrier
ds_read_b64_tr_b16 v[32:33], v16 offset:41088
ds_read_b64_tr_b16 v[34:35], v16 offset:41856
ds_read_b64 v[44:45], v17 offset:41088
ds_read_b64 v[46:47], v17 offset:42112
v_mfma_f32_32x32x16_bf16 v[144:159], v[52:55], v[68:71], v[144:159]
ds_read_b64 v[48:49], v73 offset:41088
ds_read_b64 v[50:51], v73 offset:42112
ds_read_b64_tr_b16 v[36:37], v16 offset:41120
ds_read_b64_tr_b16 v[38:39], v16 offset:41888
s_waitcnt lgkmcnt(8)
v_mfma_f32_16x16x32_bf16 v[84:87], v[76:79], v[76:79], v[84:87]
v_mfma_f32_32x32x16_bf16 v[160:175], v[56:59], v[64:67], v[160:175]
ds_read_b64_tr_b16 v[40:41], v16 offset:41152
ds_read_b64_tr_b16 v[42:43], v16 offset:41920
v_mfma_f32_16x16x32_bf16 v[92:95], v[100:103], v[76:79], v[92:95]
v_mfma_f32_16x16x32_bf16 v[88:91], v[80:83], v[80:83], v[88:91]
v_mfma_f32_32x32x16_bf16 v[176:191], v[56:59], v[68:71], v[176:191]
v_mfma_f32_16x16x32_bf16 v[96:99], v[100:103], v[80:83], v[96:99]
v_mfma_f32_16x16x32_bf16 v[84:87], v[108:111], v[108:111], v[84:87]
v_mfma_f32_32x32x16_bf16 v[192:207], v[60:63], v[64:67], v[192:207]
v_mfma_f32_16x16x32_bf16 v[92:95], v[100:103], v[108:111], v[92:95]
v_mfma_f32_16x16x32_bf16 v[88:91], v[112:115], v[112:115], v[88:91]
v_mfma_f32_32x32x16_bf16 v[208:223], v[60:63], v[68:71], v[208:223]
v_mfma_f32_16x16x32_bf16 v[96:99], v[100:103], v[112:115], v[96:99]
s_waitcnt lgkmcnt(0)
v_mfma_f32_32x32x16_bf16 v[128:143], v[32:35], v[44:47], v[128:143]
ds_read_b64_tr_b16 v[52:53], v16 offset:44160
ds_read_b64_tr_b16 v[54:55], v16 offset:44928
ds_read_b64 v[64:65], v17 offset:45184
ds_read_b64 v[66:67], v17 offset:46208
v_mfma_f32_32x32x16_bf16 v[144:159], v[32:35], v[48:51], v[144:159]
ds_read_b64 v[68:69], v73 offset:45184
ds_read_b64 v[70:71], v73 offset:46208
ds_read_b64_tr_b16 v[56:57], v16 offset:44192
ds_read_b64_tr_b16 v[58:59], v16 offset:44960
v_cndmask_b32 v84, v84, v85, s[42:43]
v_cndmask_b32 v86, v86, v87, s[46:47]
v_mul_f32 v92, 0x3acccccd, v92
v_cndmask_b32 v88, v88, v89, s[42:43]
v_cndmask_b32 v90, v90, v91, s[46:47]
v_mul_f32 v96, 0x3acccccd, v96
v_cndmask_b32 v84, v84, v86, s[44:45]
v_mfma_f32_32x32x16_bf16 v[160:175], v[36:39], v[44:47], v[160:175]
ds_read_b64_tr_b16 v[60:61], v16 offset:44224
ds_read_b64_tr_b16 v[62:63], v16 offset:44992
v_cndmask_b32 v88, v88, v90, s[44:45]
v_cvt_pk_bf16_f32 v4, -v92, -v92
v_mul_f32 v84, 0x3acccccd, v84
v_cvt_pk_bf16_f32 v76, -v96, -v96
v_mul_f32 v88, 0x3acccccd, v88
v_fma_f32 v84, -v92, v92, v84
v_fma_f32 v88, -v96, v96, v88
v_mfma_f32_32x32x16_bf16 v[176:191], v[36:39], v[48:51], v[176:191]
v_max_f32 v84, 0, v84
v_max_f32 v88, 0, v88
v_add_f32 v84, 0x3727c5ac, v84
v_add_f32 v88, 0x3727c5ac, v88
v_sqrt_f32 v84, v84
v_sqrt_f32 v88, v88
v_cvt_pk_bf16_f32 v5, v84, v84
v_mfma_f32_32x32x16_bf16 v[192:207], v[40:43], v[44:47], v[192:207]
v_cvt_pk_bf16_f32 v77, v88, v88
v_and_b32 v84, 0xffff0000, v5
v_and_b32 v88, 0xffff0000, v77
v_rcp_f32 v6, v84
v_rcp_f32 v78, v88
v_fma_f32 v7, -v84, v6, 1.0
v_fma_f32 v79, -v88, v78, 1.0
v_mfma_f32_32x32x16_bf16 v[208:223], v[40:43], v[48:51], v[208:223]
v_fma_f32 v6, v7, v6, v6
v_fma_f32 v78, v79, v78, v78
s_mov_b64 exec, s[48:49]
ds_write_b128 v2, v[4:7]
ds_write_b128 v2, v[76:79] offset:256
s_mov_b64 exec, -1
s_waitcnt lgkmcnt(0)
v_mfma_f32_32x32x16_bf16 v[128:143], v[52:55], v[64:67], v[128:143]
s_barrier
ds_read_b128 v[116:119], v12
ds_read_b128 v[120:123], v107
v_mfma_f32_32x32x16_bf16 v[144:159], v[52:55], v[68:71], v[144:159]
v_mfma_f32_32x32x16_bf16 v[160:175], v[56:59], v[64:67], v[160:175]
s_waitcnt lgkmcnt(0)
v_cndmask_b32 v108, 0, v116, s[50:51]
v_cndmask_b32 v110, 0, v117, s[50:51]
v_mov_b32 v109, v108
v_mov_b32 v111, v110
v_cndmask_b32 v112, 0, v120, s[50:51]
v_mfma_f32_32x32x16_bf16 v[176:191], v[56:59], v[68:71], v[176:191]
v_cndmask_b32 v114, 0, v121, s[50:51]
v_mov_b32 v113, v112
v_mov_b32 v115, v114
v_mul_f32 v124, 0xbfb8aa3b, v118
v_and_b32 v126, 0xffff0000, v117
v_mfma_f32_32x32x16_bf16 v[192:207], v[60:63], v[64:67], v[192:207]
v_mul_f32 v126, v126, v126
v_mul_f32 v125, 0xbfb8aa3b, v122
v_and_b32 v127, 0xffff0000, v121
v_mul_f32 v127, v127, v127
v_mfma_f32_32x32x16_bf16 v[208:223], v[60:63], v[68:71], v[208:223]
v_mfma_f32_32x32x16_bf16 v[128:143], v[20:23], v[108:111], v[128:143]
v_mfma_f32_32x32x16_bf16 v[144:159], v[20:23], v[112:115], v[144:159]
v_mfma_f32_32x32x16_bf16 v[160:175], v[24:27], v[108:111], v[160:175]
s_nop 9
v_mul_f32 v40, v128, v124
v_mul_f32 v41, v129, v124
v_exp_f32 v40, v40
v_exp_f32 v41, v41
v_mul_f32 v42, v128, v136
v_mul_f32 v43, v129, v137
v_fma_f32 v40, v40, v126, v126
v_fma_f32 v41, v41, v126, v126
v_rcp_f32 v40, v40
v_rcp_f32 v41, v41
v_mul_f32 v40, v40, v42
v_mul_f32 v41, v41, v43
v_cvt_pk_bf16_f32 v32, v40, v41
v_mfma_f32_32x32x16_bf16 v[176:191], v[24:27], v[112:115], v[176:191]
v_mul_f32 v44, v130, v124
v_mul_f32 v45, v131, v124
v_exp_f32 v44, v44
v_exp_f32 v45, v45
v_mul_f32 v46, v130, v138
v_mul_f32 v47, v131, v139
v_fma_f32 v44, v44, v126, v126
v_fma_f32 v45, v45, v126, v126
v_rcp_f32 v44, v44
v_rcp_f32 v45, v45
v_mul_f32 v44, v44, v46
v_mul_f32 v45, v45, v47
v_cvt_pk_bf16_f32 v33, v44, v45
v_mfma_f32_32x32x16_bf16 v[192:207], v[28:31], v[108:111], v[192:207]
v_mul_f32 v40, v132, v124
v_mul_f32 v41, v133, v124
v_exp_f32 v40, v40
v_exp_f32 v41, v41
v_mul_f32 v42, v132, v140
v_mul_f32 v43, v133, v141
v_fma_f32 v40, v40, v126, v126
v_fma_f32 v41, v41, v126, v126
v_rcp_f32 v40, v40
v_rcp_f32 v41, v41
v_mul_f32 v40, v40, v42
v_mul_f32 v41, v41, v43
v_cvt_pk_bf16_f32 v34, v40, v41
v_mfma_f32_32x32x16_bf16 v[208:223], v[28:31], v[112:115], v[208:223]
v_mul_f32 v44, v134, v124
v_mul_f32 v45, v135, v124
v_exp_f32 v44, v44
v_exp_f32 v45, v45
v_mul_f32 v46, v134, v142
v_mul_f32 v47, v135, v143
v_fma_f32 v44, v44, v126, v126
v_fma_f32 v45, v45, v126, v126
v_rcp_f32 v44, v44
v_rcp_f32 v45, v45
v_mul_f32 v44, v44, v46
v_mul_f32 v45, v45, v47
v_cvt_pk_bf16_f32 v35, v44, v45
v_permlane32_swap_b32 v32, v34
s_nop 0
v_permlane32_swap_b32 v33, v35
s_add_u32 s3, s39, 0
buffer_store_dwordx4 v[32:35], v11, s[20:23], s3 offen sc0 sc1
v_mul_f32 v40, v144, v125
v_mul_f32 v41, v145, v125
v_exp_f32 v40, v40
v_exp_f32 v41, v41
v_mul_f32 v42, v144, v152
v_mul_f32 v43, v145, v153
v_fma_f32 v40, v40, v127, v127
v_fma_f32 v41, v41, v127, v127
v_rcp_f32 v40, v40
v_rcp_f32 v41, v41
v_mul_f32 v40, v40, v42
v_mul_f32 v41, v41, v43
v_cvt_pk_bf16_f32 v36, v40, v41
v_mul_f32 v44, v146, v125
v_mul_f32 v45, v147, v125
v_exp_f32 v44, v44
v_exp_f32 v45, v45
v_mul_f32 v46, v146, v154
v_mul_f32 v47, v147, v155
v_fma_f32 v44, v44, v127, v127
v_fma_f32 v45, v45, v127, v127
v_rcp_f32 v44, v44
v_rcp_f32 v45, v45
v_mul_f32 v44, v44, v46
v_mul_f32 v45, v45, v47
v_cvt_pk_bf16_f32 v37, v44, v45
v_mul_f32 v40, v148, v125
v_mul_f32 v41, v149, v125
v_exp_f32 v40, v40
v_exp_f32 v41, v41
v_mul_f32 v42, v148, v156
v_mul_f32 v43, v149, v157
v_fma_f32 v40, v40, v127, v127
v_fma_f32 v41, v41, v127, v127
v_rcp_f32 v40, v40
v_rcp_f32 v41, v41
v_mul_f32 v40, v40, v42
v_mul_f32 v41, v41, v43
v_cvt_pk_bf16_f32 v38, v40, v41
v_mul_f32 v44, v150, v125
v_mul_f32 v45, v151, v125
v_exp_f32 v44, v44
v_exp_f32 v45, v45
v_mul_f32 v46, v150, v158
v_mul_f32 v47, v151, v159
v_fma_f32 v44, v44, v127, v127
v_fma_f32 v45, v45, v127, v127
v_rcp_f32 v44, v44
v_rcp_f32 v45, v45
v_mul_f32 v44, v44, v46
v_mul_f32 v45, v45, v47
v_cvt_pk_bf16_f32 v39, v44, v45
v_permlane32_swap_b32 v36, v38
s_nop 0
v_permlane32_swap_b32 v37, v39
s_add_u32 s3, s41, 0
buffer_store_dwordx4 v[36:39], v11, s[20:23], s3 offen sc0 sc1
v_mul_f32 v40, v160, v124
v_mul_f32 v41, v161, v124
v_exp_f32 v40, v40
v_exp_f32 v41, v41
v_mul_f32 v42, v160, v168
v_mul_f32 v43, v161, v169
v_fma_f32 v40, v40, v126, v126
v_fma_f32 v41, v41, v126, v126
v_rcp_f32 v40, v40
v_rcp_f32 v41, v41
v_mul_f32 v40, v40, v42
v_mul_f32 v41, v41, v43
v_cvt_pk_bf16_f32 v32, v40, v41
v_mul_f32 v44, v162, v124
v_mul_f32 v45, v163, v124
v_exp_f32 v44, v44
v_exp_f32 v45, v45
v_mul_f32 v46, v162, v170
v_mul_f32 v47, v163, v171
v_fma_f32 v44, v44, v126, v126
v_fma_f32 v45, v45, v126, v126
v_rcp_f32 v44, v44
v_rcp_f32 v45, v45
v_mul_f32 v44, v44, v46
v_mul_f32 v45, v45, v47
v_cvt_pk_bf16_f32 v33, v44, v45
v_mul_f32 v40, v164, v124
v_mul_f32 v41, v165, v124
v_exp_f32 v40, v40
v_exp_f32 v41, v41
v_mul_f32 v42, v164, v172
v_mul_f32 v43, v165, v173
v_fma_f32 v40, v40, v126, v126
v_fma_f32 v41, v41, v126, v126
v_rcp_f32 v40, v40
v_rcp_f32 v41, v41
v_mul_f32 v40, v40, v42
v_mul_f32 v41, v41, v43
v_cvt_pk_bf16_f32 v34, v40, v41
v_mul_f32 v44, v166, v124
v_mul_f32 v45, v167, v124
v_exp_f32 v44, v44
v_exp_f32 v45, v45
v_mul_f32 v46, v166, v174
v_mul_f32 v47, v167, v175
v_fma_f32 v44, v44, v126, v126
v_fma_f32 v45, v45, v126, v126
v_rcp_f32 v44, v44
v_rcp_f32 v45, v45
v_mul_f32 v44, v44, v46
v_mul_f32 v45, v45, v47
v_cvt_pk_bf16_f32 v35, v44, v45
v_permlane32_swap_b32 v32, v34
s_nop 0
v_permlane32_swap_b32 v33, v35
s_add_u32 s3, s39, 65536
buffer_store_dwordx4 v[32:35], v11, s[20:23], s3 offen sc0 sc1
v_mul_f32 v40, v176, v125
v_mul_f32 v41, v177, v125
v_exp_f32 v40, v40
v_exp_f32 v41, v41
v_mul_f32 v42, v176, v184
v_mul_f32 v43, v177, v185
v_fma_f32 v40, v40, v127, v127
v_fma_f32 v41, v41, v127, v127
v_rcp_f32 v40, v40
v_rcp_f32 v41, v41
v_mul_f32 v40, v40, v42
v_mul_f32 v41, v41, v43
v_cvt_pk_bf16_f32 v36, v40, v41
v_mul_f32 v44, v178, v125
v_mul_f32 v45, v179, v125
v_exp_f32 v44, v44
v_exp_f32 v45, v45
v_mul_f32 v46, v178, v186
v_mul_f32 v47, v179, v187
v_fma_f32 v44, v44, v127, v127
v_fma_f32 v45, v45, v127, v127
v_rcp_f32 v44, v44
v_rcp_f32 v45, v45
v_mul_f32 v44, v44, v46
v_mul_f32 v45, v45, v47
v_cvt_pk_bf16_f32 v37, v44, v45
v_mul_f32 v40, v180, v125
v_mul_f32 v41, v181, v125
v_exp_f32 v40, v40
v_exp_f32 v41, v41
v_mul_f32 v42, v180, v188
v_mul_f32 v43, v181, v189
v_fma_f32 v40, v40, v127, v127
v_fma_f32 v41, v41, v127, v127
v_rcp_f32 v40, v40
v_rcp_f32 v41, v41
v_mul_f32 v40, v40, v42
v_mul_f32 v41, v41, v43
v_cvt_pk_bf16_f32 v38, v40, v41
v_mul_f32 v44, v182, v125
v_mul_f32 v45, v183, v125
v_exp_f32 v44, v44
v_exp_f32 v45, v45
v_mul_f32 v46, v182, v190
v_mul_f32 v47, v183, v191
v_fma_f32 v44, v44, v127, v127
v_fma_f32 v45, v45, v127, v127
v_rcp_f32 v44, v44
v_rcp_f32 v45, v45
v_mul_f32 v44, v44, v46
v_mul_f32 v45, v45, v47
v_cvt_pk_bf16_f32 v39, v44, v45
v_permlane32_swap_b32 v36, v38
s_nop 0
v_permlane32_swap_b32 v37, v39
s_add_u32 s3, s41, 65536
buffer_store_dwordx4 v[36:39], v11, s[20:23], s3 offen sc0 sc1
v_mul_f32 v40, v192, v124
v_mul_f32 v41, v193, v124
v_exp_f32 v40, v40
v_exp_f32 v41, v41
v_mul_f32 v42, v192, v200
v_mul_f32 v43, v193, v201
v_fma_f32 v40, v40, v126, v126
v_fma_f32 v41, v41, v126, v126
v_rcp_f32 v40, v40
v_rcp_f32 v41, v41
v_mul_f32 v40, v40, v42
v_mul_f32 v41, v41, v43
v_cvt_pk_bf16_f32 v32, v40, v41
v_mul_f32 v44, v194, v124
v_mul_f32 v45, v195, v124
v_exp_f32 v44, v44
v_exp_f32 v45, v45
v_mul_f32 v46, v194, v202
v_mul_f32 v47, v195, v203
v_fma_f32 v44, v44, v126, v126
v_fma_f32 v45, v45, v126, v126
v_rcp_f32 v44, v44
v_rcp_f32 v45, v45
v_mul_f32 v44, v44, v46
v_mul_f32 v45, v45, v47
v_cvt_pk_bf16_f32 v33, v44, v45
v_mul_f32 v40, v196, v124
v_mul_f32 v41, v197, v124
v_exp_f32 v40, v40
v_exp_f32 v41, v41
v_mul_f32 v42, v196, v204
v_mul_f32 v43, v197, v205
v_fma_f32 v40, v40, v126, v126
v_fma_f32 v41, v41, v126, v126
v_rcp_f32 v40, v40
v_rcp_f32 v41, v41
v_mul_f32 v40, v40, v42
v_mul_f32 v41, v41, v43
v_cvt_pk_bf16_f32 v34, v40, v41
v_mul_f32 v44, v198, v124
v_mul_f32 v45, v199, v124
v_exp_f32 v44, v44
v_exp_f32 v45, v45
v_mul_f32 v46, v198, v206
v_mul_f32 v47, v199, v207
v_fma_f32 v44, v44, v126, v126
v_fma_f32 v45, v45, v126, v126
v_rcp_f32 v44, v44
v_rcp_f32 v45, v45
v_mul_f32 v44, v44, v46
v_mul_f32 v45, v45, v47
v_cvt_pk_bf16_f32 v35, v44, v45
v_permlane32_swap_b32 v32, v34
s_nop 0
v_permlane32_swap_b32 v33, v35
s_add_u32 s3, s39, 131072
buffer_store_dwordx4 v[32:35], v11, s[20:23], s3 offen sc0 sc1
v_mul_f32 v40, v208, v125
v_mul_f32 v41, v209, v125
v_exp_f32 v40, v40
v_exp_f32 v41, v41
v_mul_f32 v42, v208, v216
v_mul_f32 v43, v209, v217
v_fma_f32 v40, v40, v127, v127
v_fma_f32 v41, v41, v127, v127
v_rcp_f32 v40, v40
v_rcp_f32 v41, v41
v_mul_f32 v40, v40, v42
v_mul_f32 v41, v41, v43
v_cvt_pk_bf16_f32 v36, v40, v41
v_mul_f32 v44, v210, v125
v_mul_f32 v45, v211, v125
v_exp_f32 v44, v44
v_exp_f32 v45, v45
v_mul_f32 v46, v210, v218
v_mul_f32 v47, v211, v219
v_fma_f32 v44, v44, v127, v127
v_fma_f32 v45, v45, v127, v127
v_rcp_f32 v44, v44
v_rcp_f32 v45, v45
v_mul_f32 v44, v44, v46
v_mul_f32 v45, v45, v47
v_cvt_pk_bf16_f32 v37, v44, v45
v_mul_f32 v40, v212, v125
v_mul_f32 v41, v213, v125
v_exp_f32 v40, v40
v_exp_f32 v41, v41
v_mul_f32 v42, v212, v220
v_mul_f32 v43, v213, v221
v_fma_f32 v40, v40, v127, v127
v_fma_f32 v41, v41, v127, v127
v_rcp_f32 v40, v40
v_rcp_f32 v41, v41
v_mul_f32 v40, v40, v42
v_mul_f32 v41, v41, v43
v_cvt_pk_bf16_f32 v38, v40, v41
v_mul_f32 v44, v214, v125
v_mul_f32 v45, v215, v125
v_exp_f32 v44, v44
v_exp_f32 v45, v45
v_mul_f32 v46, v214, v222
v_mul_f32 v47, v215, v223
v_fma_f32 v44, v44, v127, v127
v_fma_f32 v45, v45, v127, v127
v_rcp_f32 v44, v44
v_rcp_f32 v45, v45
v_mul_f32 v44, v44, v46
v_mul_f32 v45, v45, v47
v_cvt_pk_bf16_f32 v39, v44, v45
v_permlane32_swap_b32 v36, v38
s_nop 0
v_permlane32_swap_b32 v37, v39
s_add_u32 s3, s41, 131072
buffer_store_dwordx4 v[36:39], v11, s[20:23], s3 offen sc0 sc1
s_waitcnt vmcnt(0)
KD_END:
s_endpgm
kd_kernel_end:
.globl ke_kernel
.p2align 8
.type ke_kernel,@function
ke_kernel:
s_getpc_b64 s[4:5]
s_mov_b32 s6, ke_kernel_end-ke_kernel-64
v_lshlrev_b32 v1, 7, v0
v_min_u32 v1, s6, v1
v_mov_b32 v3, s5
v_add_co_u32 v2, vcc, s4, v1
s_nop 1
v_addc_co_u32 v3, vcc, 0, v3, vcc
global_load_dword v207, v[2:3], off
s_cmp_ge_u32 s2, 256
s_cbranch_scc1 KE_END
s_load_dwordx2 s[6:7], s[0:1], 104
s_load_dwordx2 s[8:9], s[0:1], 120
s_and_b32 s26, s2, 7
s_lshr_b32 s27, s2, 3
s_lshr_b32 s28, s26, 1
s_lshl_b32 s28, s28, 3
s_and_b32 s29, s27, 7
s_add_u32 s28, s28, s29
s_and_b32 s29, s26, 1
s_lshl_b32 s29, s29, 2
s_lshr_b32 s30, s27, 3
s_add_u32 s29, s29, s30
v_and_b32 v1, 63, v0
v_lshrrev_b32 v2, 6, v0
v_lshlrev_b32 v10, 4, v1
v_readfirstlane_b32 s31, v2
s_mul_i32 s32, s29, 245760
s_mul_i32 s3, s31, 61440
s_add_u32 s32, s32, s3
s_add_u32 s32, s32, 22020096
s_mul_i32 s34, s31, 25600
s_mul_i32 s33, s31, 1572864
s_lshl_b32 s3, s28, 10
s_add_u32 s33, s33, s3
s_add_u32 s33, s33, 6291456
v_lshrrev_b32 v3, 4, v1
v_and_b32 v4, 15, v1
v_lshlrev_b32 v5, 15, v3
v_lshl_add_u32 v5, v4, 4, v5
s_add_u32 s3, s31, 0
s_and_b32 s3, s3, 3
s_lshl_b32 s3, s3, 8
v_add_u32 v12, s3, v5
s_add_u32 s3, s31, 1
s_and_b32 s3, s3, 3
s_lshl_b32 s3, s3, 8
v_add_u32 v13, s3, v5
s_add_u32 s3, s31, 2
s_and_b32 s3, s3, 3
s_lshl_b32 s3, s3, 8
v_add_u32 v14, s3, v5
s_add_u32 s3, s31, 3
s_and_b32 s3, s3, 3
s_lshl_b32 s3, s3, 8
v_add_u32 v15, s3, v5
s_waitcnt lgkmcnt(0)
s_mov_b32 s16, s6
s_mov_b32 s17, s7
s_mov_b32 s18, 2621440
s_mov_b32 s19, 0x00020000
s_mov_b32 s20, s8
s_mov_b32 s21, s9
s_mov_b32 s22, 268435456
s_mov_b32 s23, 0x00020000
s_add_u32 m0, s34, 0
s_nop 0
buffer_load_dwordx4 v10, s[20:23], s32 offen lds
buffer_load_dwordx4 v10, s[20:23], s32 offen offset:1024 lds
buffer_load_dwordx4 v10, s[20:23], s32 offen offset:2048 lds
buffer_load_dwordx4 v10, s[20:23], s32 offen offset:3072 lds
s_add_u32 m0, s34, 4096
s_add_u32 s3, s32, 4096
buffer_load_dwordx4 v10, s[20:23], s3 offen lds
s_add_u32 s32, s32, 5120
buffer_load_dwordx4 v[112:115], v12, s[20:23], s33 offen
buffer_load_dwordx4 v[116:119], v13, s[20:23], s33 offen
buffer_load_dwordx4 v[120:123], v14, s[20:23], s33 offen
buffer_load_dwordx4 v[124:127], v15, s[20:23], s33 offen
s_add_u32 s33, s33, 131072
s_add_u32 m0, s34, 5120
s_nop 0
buffer_load_dwordx4 v10, s[20:23], s32 offen lds
buffer_load_dwordx4 v10, s[20:23], s32 offen offset:1024 lds
buffer_load_dwordx4 v10, s[20:23], s32 offen offset:2048 lds
buffer_load_dwordx4 v10, s[20:23], s32 offen offset:3072 lds
s_add_u32 m0, s34, 9216
s_add_u32 s3, s32, 4096
buffer_load_dwordx4 v10, s[20:23], s3 offen lds
s_add_u32 s32, s32, 5120
buffer_load_dwordx4 v[128:131], v12, s[20:23], s33 offen
buffer_load_dwordx4 v[132:135], v13, s[20:23], s33 offen
buffer_load_dwordx4 v[136:139], v14, s[20:23], s33 offen
buffer_load_dwordx4 v[140:143], v15, s[20:23], s33 offen
s_add_u32 s33, s33, 131072
v_lshrrev_b32 v5, 1, v3
v_lshlrev_b32 v5, 4, v5
v_and_b32 v6, 1, v3
v_lshl_add_u32 v5, v6, 2, v5
v_bfe_u32 v6, v1, 2, 2
v_add_u32 v5, v5, v6
v_mul_u32_u24 v5, 160, v5
v_and_b32 v6, 3, v1
v_lshl_add_u32 v5, v6, 3, v5
v_add_u32 v16, s34, v5
v_lshlrev_b32 v17, 14, v3
v_lshl_add_u32 v17, v4, 3, v17
v_lshlrev_b32 v18, 4, v3
v_mul_u32_u24 v19, 1280, v4
v_lshl_add_u32 v19, v3, 3, v19
v_and_b32 v5, 1, v3
v_lshlrev_b32 v5, 5, v5
v_lshrrev_b32 v6, 1, v3
v_lshl_add_u32 v5, v6, 4, v5
v_mul_u32_u24 v8, 1280, v4
v_add_u32 v8, v8, v5
s_add_u32 m0, s34, 10240
s_nop 0
buffer_load_dwordx4 v10, s[20:23], s32 offen lds
buffer_load_dwordx4 v10, s[20:23], s32 offen offset:1024 lds
buffer_load_dwordx4 v10, s[20:23], s32 offen offset:2048 lds
buffer_load_dwordx4 v10, s[20:23], s32 offen offset:3072 lds
s_add_u32 m0, s34, 14336
s_add_u32 s3, s32, 4096
buffer_load_dwordx4 v10, s[20:23], s3 offen lds
s_add_u32 s32, s32, 5120
buffer_load_dwordx4 v[144:147], v12, s[20:23], s33 offen
buffer_load_dwordx4 v[148:151], v13, s[20:23], s33 offen
buffer_load_dwordx4 v[152:155], v14, s[20:23], s33 offen
buffer_load_dwordx4 v[156:159], v15, s[20:23], s33 offen
s_add_u32 s33, s33, 131072
s_add_u32 m0, s34, 15360
s_nop 0
buffer_load_dwordx4 v10, s[20:23], s32 offen lds
buffer_load_dwordx4 v10, s[20:23], s32 offen offset:1024 lds
buffer_load_dwordx4 v10, s[20:23], s32 offen offset:2048 lds
buffer_load_dwordx4 v10, s[20:23], s32 offen offset:3072 lds
s_add_u32 m0, s34, 19456
s_add_u32 s3, s32, 4096
buffer_load_dwordx4 v10, s[20:23], s3 offen lds
s_add_u32 s32, s32, 5120
buffer_load_dwordx4 v[160:163], v12, s[20:23], s33 offen
buffer_load_dwordx4 v[164:167], v13, s[20:23], s33 offen
buffer_load_dwordx4 v[168:171], v14, s[20:23], s33 offen
buffer_load_dwordx4 v[172:175], v15, s[20:23], s33 offen
s_add_u32 s33, s33, 131072
s_waitcnt vmcnt(27)
ds_read_b64_tr_b16 v[208:209], v16 offset:0
ds_read_b64_tr_b16 v[210:211], v16 offset:1280
ds_read_b64_tr_b16 v[212:213], v16 offset:32
ds_read_b64_tr_b16 v[214:215], v16 offset:1312
ds_read_b64_tr_b16 v[216:217], v16 offset:64
ds_read_b64_tr_b16 v[218:219], v16 offset:1344
ds_read_b64_tr_b16 v[220:221], v16 offset:96
ds_read_b64_tr_b16 v[222:223], v16 offset:1376
ds_read_b64_tr_b16 v[224:225], v16 offset:128
ds_read_b64_tr_b16 v[226:227], v16 offset:1408
s_waitcnt lgkmcnt(0)
v_mfma_f32_16x16x32_bf16 v[32:35], v[208:211], v[112:115], 0
s_add_u32 m0, s34, 20480
s_nop 0
buffer_load_dwordx4 v10, s[20:23], s32 offen lds
v_mfma_f32_16x16x32_bf16 v[36:39], v[208:211], v[116:119], 0
buffer_load_dwordx4 v10, s[20:23], s32 offen offset:1024 lds
v_mfma_f32_16x16x32_bf16 v[40:43], v[208:211], v[120:123], 0
buffer_load_dwordx4 v10, s[20:23], s32 offen offset:2048 lds
v_mfma_f32_16x16x32_bf16 v[44:47], v[208:211], v[124:127], 0
buffer_load_dwordx4 v10, s[20:23], s32 offen offset:3072 lds
v_mfma_f32_16x16x32_bf16 v[48:51], v[212:215], v[112:115], 0
s_add_u32 m0, s34, 24576
s_add_u32 s3, s32, 4096
buffer_load_dwordx4 v10, s[20:23], s3 offen lds
s_add_u32 s32, s32, 5120
v_mfma_f32_16x16x32_bf16 v[52:55], v[212:215], v[116:119], 0
buffer_load_dwordx4 v[176:179], v12, s[20:23], s33 offen
v_mfma_f32_16x16x32_bf16 v[56:59], v[212:215], v[120:123], 0
buffer_load_dwordx4 v[180:183], v13, s[20:23], s33 offen
v_mfma_f32_16x16x32_bf16 v[60:63], v[212:215], v[124:127], 0
buffer_load_dwordx4 v[184:187], v14, s[20:23], s33 offen
v_mfma_f32_16x16x32_bf16 v[64:67], v[216:219], v[112:115], 0
buffer_load_dwordx4 v[188:191], v15, s[20:23], s33 offen
s_add_u32 s33, s33, 131072
v_mfma_f32_16x16x32_bf16 v[68:71], v[216:219], v[116:119], 0
s_waitcnt vmcnt(27)
v_mfma_f32_16x16x32_bf16 v[72:75], v[216:219], v[120:123], 0
ds_read_b64_tr_b16 v[228:229], v16 offset:5120
v_mfma_f32_16x16x32_bf16 v[76:79], v[216:219], v[124:127], 0
ds_read_b64_tr_b16 v[230:231], v16 offset:6400
v_mfma_f32_16x16x32_bf16 v[80:83], v[220:223], v[112:115], 0
ds_read_b64_tr_b16 v[232:233], v16 offset:5152
v_mfma_f32_16x16x32_bf16 v[84:87], v[220:223], v[116:119], 0
ds_read_b64_tr_b16 v[234:235], v16 offset:6432
v_mfma_f32_16x16x32_bf16 v[88:91], v[220:223], v[120:123], 0
ds_read_b64_tr_b16 v[236:237], v16 offset:5184
ds_read_b64_tr_b16 v[238:239], v16 offset:6464
v_mfma_f32_16x16x32_bf16 v[92:95], v[220:223], v[124:127], 0
ds_read_b64_tr_b16 v[240:241], v16 offset:5216
ds_read_b64_tr_b16 v[242:243], v16 offset:6496
v_mfma_f32_16x16x32_bf16 v[96:99], v[224:227], v[112:115], 0
ds_read_b64_tr_b16 v[244:245], v16 offset:5248
ds_read_b64_tr_b16 v[246:247], v16 offset:6528
v_mfma_f32_16x16x32_bf16 v[100:103], v[224:227], v[116:119], 0
v_mfma_f32_16x16x32_bf16 v[104:107], v[224:227], v[120:123], 0
v_mfma_f32_16x16x32_bf16 v[108:111], v[224:227], v[124:127], 0
s_waitcnt lgkmcnt(0)
v_mfma_f32_16x16x32_bf16 v[32:35], v[228:231], v[128:131], v[32:35]
s_add_u32 m0, s34, 0
s_nop 0
buffer_load_dwordx4 v10, s[20:23], s32 offen lds
v_mfma_f32_16x16x32_bf16 v[36:39], v[228:231], v[132:135], v[36:39]
buffer_load_dwordx4 v10, s[20:23], s32 offen offset:1024 lds
v_mfma_f32_16x16x32_bf16 v[40:43], v[228:231], v[136:139], v[40:43]
buffer_load_dwordx4 v10, s[20:23], s32 offen offset:2048 lds
v_mfma_f32_16x16x32_bf16 v[44:47], v[228:231], v[140:143], v[44:47]
buffer_load_dwordx4 v10, s[20:23], s32 offen offset:3072 lds
v_mfma_f32_16x16x32_bf16 v[48:51], v[232:235], v[128:131], v[48:51]
s_add_u32 m0, s34, 4096
s_add_u32 s3, s32, 4096
buffer_load_dwordx4 v10, s[20:23], s3 offen lds
s_add_u32 s32, s32, 5120
v_mfma_f32_16x16x32_bf16 v[52:55], v[232:235], v[132:135], v[52:55]
buffer_load_dwordx4 v[112:115], v12, s[20:23], s33 offen
v_mfma_f32_16x16x32_bf16 v[56:59], v[232:235], v[136:139], v[56:59]
buffer_load_dwordx4 v[116:119], v13, s[20:23], s33 offen
v_mfma_f32_16x16x32_bf16 v[60:63], v[232:235], v[140:143], v[60:63]
buffer_load_dwordx4 v[120:123], v14, s[20:23], s33 offen
v_mfma_f32_16x16x32_bf16 v[64:67], v[236:239], v[128:131], v[64:67]
buffer_load_dwordx4 v[124:127], v15, s[20:23], s33 offen
s_add_u32 s33, s33, 131072
v_mfma_f32_16x16x32_bf16 v[68:71], v[236:239], v[132:135], v[68:71]
s_waitcnt vmcnt(27)
v_mfma_f32_16x16x32_bf16 v[72:75], v[236:239], v[136:139], v[72:75]
ds_read_b64_tr_b16 v[208:209], v16 offset:10240
v_mfma_f32_16x16x32_bf16 v[76:79], v[236:239], v[140:143], v[76:79]
ds_read_b64_tr_b16 v[210:211], v16 offset:11520
v_mfma_f32_16x16x32_bf16 v[80:83], v[240:243], v[128:131], v[80:83]
ds_read_b64_tr_b16 v[212:213], v16 offset:10272
v_mfma_f32_16x16x32_bf16 v[84:87], v[240:243], v[132:135], v[84:87]
ds_read_b64_tr_b16 v[214:215], v16 offset:11552
v_mfma_f32_16x16x32_bf16 v[88:91], v[240:243], v[136:139], v[88:91]
ds_read_b64_tr_b16 v[216:217], v16 offset:10304
ds_read_b64_tr_b16 v[218:219], v16 offset:11584
v_mfma_f32_16x16x32_bf16 v[92:95], v[240:243], v[140:143], v[92:95]
ds_read_b64_tr_b16 v[220:221], v16 offset:10336
ds_read_b64_tr_b16 v[222:223], v16 offset:11616
v_mfma_f32_16x16x32_bf16 v[96:99], v[244:247], v[128:131], v[96:99]
ds_read_b64_tr_b16 v[224:225], v16 offset:10368
ds_read_b64_tr_b16 v[226:227], v16 offset:11648
v_mfma_f32_16x16x32_bf16 v[100:103], v[244:247], v[132:135], v[100:103]
v_mfma_f32_16x16x32_bf16 v[104:107], v[244:247], v[136:139], v[104:107]
v_mfma_f32_16x16x32_bf16 v[108:111], v[244:247], v[140:143], v[108:111]
s_waitcnt lgkmcnt(0)
v_mfma_f32_16x16x32_bf16 v[32:35], v[208:211], v[144:147], v[32:35]
s_add_u32 m0, s34, 5120
s_nop 0
buffer_load_dwordx4 v10, s[20:23], s32 offen lds
v_mfma_f32_16x16x32_bf16 v[36:39], v[208:211], v[148:151], v[36:39]
buffer_load_dwordx4 v10, s[20:23], s32 offen offset:1024 lds
v_mfma_f32_16x16x32_bf16 v[40:43], v[208:211], v[152:155], v[40:43]
buffer_load_dwordx4 v10, s[20:23], s32 offen offset:2048 lds
v_mfma_f32_16x16x32_bf16 v[44:47], v[208:211], v[156:159], v[44:47]
buffer_load_dwordx4 v10, s[20:23], s32 offen offset:3072 lds
v_mfma_f32_16x16x32_bf16 v[48:51], v[212:215], v[144:147], v[48:51]
s_add_u32 m0, s34, 9216
s_add_u32 s3, s32, 4096
buffer_load_dwordx4 v10, s[20:23], s3 offen lds
s_add_u32 s32, s32, 5120
v_mfma_f32_16x16x32_bf16 v[52:55], v[212:215], v[148:151], v[52:55]
buffer_load_dwordx4 v[128:131], v12, s[20:23], s33 offen
v_mfma_f32_16x16x32_bf16 v[56:59], v[212:215], v[152:155], v[56:59]
buffer_load_dwordx4 v[132:135], v13, s[20:23], s33 offen
v_mfma_f32_16x16x32_bf16 v[60:63], v[212:215], v[156:159], v[60:63]
buffer_load_dwordx4 v[136:139], v14, s[20:23], s33 offen
v_mfma_f32_16x16x32_bf16 v[64:67], v[216:219], v[144:147], v[64:67]
buffer_load_dwordx4 v[140:143], v15, s[20:23], s33 offen
s_add_u32 s33, s33, 131072
v_mfma_f32_16x16x32_bf16 v[68:71], v[216:219], v[148:151], v[68:71]
s_waitcnt vmcnt(27)
v_mfma_f32_16x16x32_bf16 v[72:75], v[216:219], v[152:155], v[72:75]
ds_read_b64_tr_b16 v[228:229], v16 offset:15360
v_mfma_f32_16x16x32_bf16 v[76:79], v[216:219], v[156:159], v[76:79]
ds_read_b64_tr_b16 v[230:231], v16 offset:16640
v_mfma_f32_16x16x32_bf16 v[80:83], v[220:223], v[144:147], v[80:83]
ds_read_b64_tr_b16 v[232:233], v16 offset:15392
v_mfma_f32_16x16x32_bf16 v[84:87], v[220:223], v[148:151], v[84:87]
ds_read_b64_tr_b16 v[234:235], v16 offset:16672
v_mfma_f32_16x16x32_bf16 v[88:91], v[220:223], v[152:155], v[88:91]
ds_read_b64_tr_b16 v[236:237], v16 offset:15424
ds_read_b64_tr_b16 v[238:239], v16 offset:16704
v_mfma_f32_16x16x32_bf16 v[92:95], v[220:223], v[156:159], v[92:95]
ds_read_b64_tr_b16 v[240:241], v16 offset:15456
ds_read_b64_tr_b16 v[242:243], v16 offset:16736
v_mfma_f32_16x16x32_bf16 v[96:99], v[224:227], v[144:147], v[96:99]
ds_read_b64_tr_b16 v[244:245], v16 offset:15488
ds_read_b64_tr_b16 v[246:247], v16 offset:16768
v_mfma_f32_16x16x32_bf16 v[100:103], v[224:227], v[148:151], v[100:103]
v_mfma_f32_16x16x32_bf16 v[104:107], v[224:227], v[152:155], v[104:107]
v_mfma_f32_16x16x32_bf16 v[108:111], v[224:227], v[156:159], v[108:111]
s_waitcnt lgkmcnt(0)
v_mfma_f32_16x16x32_bf16 v[32:35], v[228:231], v[160:163], v[32:35]
s_add_u32 m0, s34, 10240
s_nop 0
buffer_load_dwordx4 v10, s[20:23], s32 offen lds
v_mfma_f32_16x16x32_bf16 v[36:39], v[228:231], v[164:167], v[36:39]
buffer_load_dwordx4 v10, s[20:23], s32 offen offset:1024 lds
v_mfma_f32_16x16x32_bf16 v[40:43], v[228:231], v[168:171], v[40:43]
buffer_load_dwordx4 v10, s[20:23], s32 offen offset:2048 lds
v_mfma_f32_16x16x32_bf16 v[44:47], v[228:231], v[172:175], v[44:47]
buffer_load_dwordx4 v10, s[20:23], s32 offen offset:3072 lds
v_mfma_f32_16x16x32_bf16 v[48:51], v[232:235], v[160:163], v[48:51]
s_add_u32 m0, s34, 14336
s_add_u32 s3, s32, 4096
buffer_load_dwordx4 v10, s[20:23], s3 offen lds
s_add_u32 s32, s32, 5120
v_mfma_f32_16x16x32_bf16 v[52:55], v[232:235], v[164:167], v[52:55]
buffer_load_dwordx4 v[144:147], v12, s[20:23], s33 offen
v_mfma_f32_16x16x32_bf16 v[56:59], v[232:235], v[168:171], v[56:59]
buffer_load_dwordx4 v[148:151], v13, s[20:23], s33 offen
v_mfma_f32_16x16x32_bf16 v[60:63], v[232:235], v[172:175], v[60:63]
buffer_load_dwordx4 v[152:155], v14, s[20:23], s33 offen
v_mfma_f32_16x16x32_bf16 v[64:67], v[236:239], v[160:163], v[64:67]
buffer_load_dwordx4 v[156:159], v15, s[20:23], s33 offen
s_add_u32 s33, s33, 131072
v_mfma_f32_16x16x32_bf16 v[68:71], v[236:239], v[164:167], v[68:71]
s_waitcnt vmcnt(27)
v_mfma_f32_16x16x32_bf16 v[72:75], v[236:239], v[168:171], v[72:75]
ds_read_b64_tr_b16 v[208:209], v16 offset:20480
v_mfma_f32_16x16x32_bf16 v[76:79], v[236:239], v[172:175], v[76:79]
ds_read_b64_tr_b16 v[210:211], v16 offset:21760
v_mfma_f32_16x16x32_bf16 v[80:83], v[240:243], v[160:163], v[80:83]
ds_read_b64_tr_b16 v[212:213], v16 offset:20512
v_mfma_f32_16x16x32_bf16 v[84:87], v[240:243], v[164:167], v[84:87]
ds_read_b64_tr_b16 v[214:215], v16 offset:21792
v_mfma_f32_16x16x32_bf16 v[88:91], v[240:243], v[168:171], v[88:91]
ds_read_b64_tr_b16 v[216:217], v16 offset:20544
ds_read_b64_tr_b16 v[218:219], v16 offset:21824
v_mfma_f32_16x16x32_bf16 v[92:95], v[240:243], v[172:175], v[92:95]
ds_read_b64_tr_b16 v[220:221], v16 offset:20576
ds_read_b64_tr_b16 v[222:223], v16 offset:21856
v_mfma_f32_16x16x32_bf16 v[96:99], v[244:247], v[160:163], v[96:99]
ds_read_b64_tr_b16 v[224:225], v16 offset:20608
ds_read_b64_tr_b16 v[226:227], v16 offset:21888
v_mfma_f32_16x16x32_bf16 v[100:103], v[244:247], v[164:167], v[100:103]
v_mfma_f32_16x16x32_bf16 v[104:107], v[244:247], v[168:171], v[104:107]
v_mfma_f32_16x16x32_bf16 v[108:111], v[244:247], v[172:175], v[108:111]
s_waitcnt lgkmcnt(0)
v_mfma_f32_16x16x32_bf16 v[32:35], v[208:211], v[176:179], v[32:35]
s_add_u32 m0, s34, 15360
s_nop 0
buffer_load_dwordx4 v10, s[20:23], s32 offen lds
v_mfma_f32_16x16x32_bf16 v[36:39], v[208:211], v[180:183], v[36:39]
buffer_load_dwordx4 v10, s[20:23], s32 offen offset:1024 lds
v_mfma_f32_16x16x32_bf16 v[40:43], v[208:211], v[184:187], v[40:43]
buffer_load_dwordx4 v10, s[20:23], s32 offen offset:2048 lds
v_mfma_f32_16x16x32_bf16 v[44:47], v[208:211], v[188:191], v[44:47]
buffer_load_dwordx4 v10, s[20:23], s32 offen offset:3072 lds
v_mfma_f32_16x16x32_bf16 v[48:51], v[212:215], v[176:179], v[48:51]
s_add_u32 m0, s34, 19456
s_add_u32 s3, s32, 4096
buffer_load_dwordx4 v10, s[20:23], s3 offen lds
s_add_u32 s32, s32, 5120
v_mfma_f32_16x16x32_bf16 v[52:55], v[212:215], v[180:183], v[52:55]
buffer_load_dwordx4 v[160:163], v12, s[20:23], s33 offen
v_mfma_f32_16x16x32_bf16 v[56:59], v[212:215], v[184:187], v[56:59]
buffer_load_dwordx4 v[164:167], v13, s[20:23], s33 offen
v_mfma_f32_16x16x32_bf16 v[60:63], v[212:215], v[188:191], v[60:63]
buffer_load_dwordx4 v[168:171], v14, s[20:23], s33 offen
v_mfma_f32_16x16x32_bf16 v[64:67], v[216:219], v[176:179], v[64:67]
buffer_load_dwordx4 v[172:175], v15, s[20:23], s33 offen
s_add_u32 s33, s33, 131072
v_mfma_f32_16x16x32_bf16 v[68:71], v[216:219], v[180:183], v[68:71]
s_waitcnt vmcnt(27)
v_mfma_f32_16x16x32_bf16 v[72:75], v[216:219], v[184:187], v[72:75]
ds_read_b64_tr_b16 v[228:229], v16 offset:0
v_mfma_f32_16x16x32_bf16 v[76:79], v[216:219], v[188:191], v[76:79]
ds_read_b64_tr_b16 v[230:231], v16 offset:1280
v_mfma_f32_16x16x32_bf16 v[80:83], v[220:223], v[176:179], v[80:83]
ds_read_b64_tr_b16 v[232:233], v16 offset:32
v_mfma_f32_16x16x32_bf16 v[84:87], v[220:223], v[180:183], v[84:87]
ds_read_b64_tr_b16 v[234:235], v16 offset:1312
v_mfma_f32_16x16x32_bf16 v[88:91], v[220:223], v[184:187], v[88:91]
ds_read_b64_tr_b16 v[236:237], v16 offset:64
ds_read_b64_tr_b16 v[238:239], v16 offset:1344
v_mfma_f32_16x16x32_bf16 v[92:95], v[220:223], v[188:191], v[92:95]
ds_read_b64_tr_b16 v[240:241], v16 offset:96
ds_read_b64_tr_b16 v[242:243], v16 offset:1376
v_mfma_f32_16x16x32_bf16 v[96:99], v[224:227], v[176:179], v[96:99]
ds_read_b64_tr_b16 v[244:245], v16 offset:128
ds_read_b64_tr_b16 v[246:247], v16 offset:1408
v_mfma_f32_16x16x32_bf16 v[100:103], v[224:227], v[180:183], v[100:103]
v_mfma_f32_16x16x32_bf16 v[104:107], v[224:227], v[184:187], v[104:107]
v_mfma_f32_16x16x32_bf16 v[108:111], v[224:227], v[188:191], v[108:111]
s_waitcnt lgkmcnt(0)
v_mfma_f32_16x16x32_bf16 v[32:35], v[228:231], v[112:115], v[32:35]
s_add_u32 m0, s34, 20480
s_nop 0
buffer_load_dwordx4 v10, s[20:23], s32 offen lds
v_mfma_f32_16x16x32_bf16 v[36:39], v[228:231], v[116:119], v[36:39]
buffer_load_dwordx4 v10, s[20:23], s32 offen offset:1024 lds
v_mfma_f32_16x16x32_bf16 v[40:43], v[228:231], v[120:123], v[40:43]
buffer_load_dwordx4 v10, s[20:23], s32 offen offset:2048 lds
v_mfma_f32_16x16x32_bf16 v[44:47], v[228:231], v[124:127], v[44:47]
buffer_load_dwordx4 v10, s[20:23], s32 offen offset:3072 lds
v_mfma_f32_16x16x32_bf16 v[48:51], v[232:235], v[112:115], v[48:51]
s_add_u32 m0, s34, 24576
s_add_u32 s3, s32, 4096
buffer_load_dwordx4 v10, s[20:23], s3 offen lds
s_add_u32 s32, s32, 5120
v_mfma_f32_16x16x32_bf16 v[52:55], v[232:235], v[116:119], v[52:55]
buffer_load_dwordx4 v[176:179], v12, s[20:23], s33 offen
v_mfma_f32_16x16x32_bf16 v[56:59], v[232:235], v[120:123], v[56:59]
buffer_load_dwordx4 v[180:183], v13, s[20:23], s33 offen
v_mfma_f32_16x16x32_bf16 v[60:63], v[232:235], v[124:127], v[60:63]
buffer_load_dwordx4 v[184:187], v14, s[20:23], s33 offen
v_mfma_f32_16x16x32_bf16 v[64:67], v[236:239], v[112:115], v[64:67]
buffer_load_dwordx4 v[188:191], v15, s[20:23], s33 offen
s_add_u32 s33, s33, 131072
v_mfma_f32_16x16x32_bf16 v[68:71], v[236:239], v[116:119], v[68:71]
s_waitcnt vmcnt(27)
v_mfma_f32_16x16x32_bf16 v[72:75], v[236:239], v[120:123], v[72:75]
ds_read_b64_tr_b16 v[208:209], v16 offset:5120
v_mfma_f32_16x16x32_bf16 v[76:79], v[236:239], v[124:127], v[76:79]
ds_read_b64_tr_b16 v[210:211], v16 offset:6400
v_mfma_f32_16x16x32_bf16 v[80:83], v[240:243], v[112:115], v[80:83]
ds_read_b64_tr_b16 v[212:213], v16 offset:5152
v_mfma_f32_16x16x32_bf16 v[84:87], v[240:243], v[116:119], v[84:87]
ds_read_b64_tr_b16 v[214:215], v16 offset:6432
v_mfma_f32_16x16x32_bf16 v[88:91], v[240:243], v[120:123], v[88:91]
ds_read_b64_tr_b16 v[216:217], v16 offset:5184
ds_read_b64_tr_b16 v[218:219], v16 offset:6464
v_mfma_f32_16x16x32_bf16 v[92:95], v[240:243], v[124:127], v[92:95]
ds_read_b64_tr_b16 v[220:221], v16 offset:5216
ds_read_b64_tr_b16 v[222:223], v16 offset:6496
v_mfma_f32_16x16x32_bf16 v[96:99], v[244:247], v[112:115], v[96:99]
ds_read_b64_tr_b16 v[224:225], v16 offset:5248
ds_read_b64_tr_b16 v[226:227], v16 offset:6528
v_mfma_f32_16x16x32_bf16 v[100:103], v[244:247], v[116:119], v[100:103]
v_mfma_f32_16x16x32_bf16 v[104:107], v[244:247], v[120:123], v[104:107]
v_mfma_f32_16x16x32_bf16 v[108:111], v[244:247], v[124:127], v[108:111]
s_waitcnt lgkmcnt(0)
v_mfma_f32_16x16x32_bf16 v[32:35], v[208:211], v[128:131], v[32:35]
s_add_u32 m0, s34, 0
s_nop 0
buffer_load_dwordx4 v10, s[20:23], s32 offen lds
v_mfma_f32_16x16x32_bf16 v[36:39], v[208:211], v[132:135], v[36:39]
buffer_load_dwordx4 v10, s[20:23], s32 offen offset:1024 lds
v_mfma_f32_16x16x32_bf16 v[40:43], v[208:211], v[136:139], v[40:43]
buffer_load_dwordx4 v10, s[20:23], s32 offen offset:2048 lds
v_mfma_f32_16x16x32_bf16 v[44:47], v[208:211], v[140:143], v[44:47]
buffer_load_dwordx4 v10, s[20:23], s32 offen offset:3072 lds
v_mfma_f32_16x16x32_bf16 v[48:51], v[212:215], v[128:131], v[48:51]
s_add_u32 m0, s34, 4096
s_add_u32 s3, s32, 4096
buffer_load_dwordx4 v10, s[20:23], s3 offen lds
s_add_u32 s32, s32, 5120
v_mfma_f32_16x16x32_bf16 v[52:55], v[212:215], v[132:135], v[52:55]
buffer_load_dwordx4 v[112:115], v12, s[20:23], s33 offen
v_mfma_f32_16x16x32_bf16 v[56:59], v[212:215], v[136:139], v[56:59]
buffer_load_dwordx4 v[116:119], v13, s[20:23], s33 offen
v_mfma_f32_16x16x32_bf16 v[60:63], v[212:215], v[140:143], v[60:63]
buffer_load_dwordx4 v[120:123], v14, s[20:23], s33 offen
v_mfma_f32_16x16x32_bf16 v[64:67], v[216:219], v[128:131], v[64:67]
buffer_load_dwordx4 v[124:127], v15, s[20:23], s33 offen
s_add_u32 s33, s33, 131072
v_mfma_f32_16x16x32_bf16 v[68:71], v[216:219], v[132:135], v[68:71]
s_waitcnt vmcnt(27)
v_mfma_f32_16x16x32_bf16 v[72:75], v[216:219], v[136:139], v[72:75]
ds_read_b64_tr_b16 v[228:229], v16 offset:10240
v_mfma_f32_16x16x32_bf16 v[76:79], v[216:219], v[140:143], v[76:79]
ds_read_b64_tr_b16 v[230:231], v16 offset:11520
v_mfma_f32_16x16x32_bf16 v[80:83], v[220:223], v[128:131], v[80:83]
ds_read_b64_tr_b16 v[232:233], v16 offset:10272
v_mfma_f32_16x16x32_bf16 v[84:87], v[220:223], v[132:135], v[84:87]
ds_read_b64_tr_b16 v[234:235], v16 offset:11552
v_mfma_f32_16x16x32_bf16 v[88:91], v[220:223], v[136:139], v[88:91]
ds_read_b64_tr_b16 v[236:237], v16 offset:10304
ds_read_b64_tr_b16 v[238:239], v16 offset:11584
v_mfma_f32_16x16x32_bf16 v[92:95], v[220:223], v[140:143], v[92:95]
ds_read_b64_tr_b16 v[240:241], v16 offset:10336
ds_read_b64_tr_b16 v[242:243], v16 offset:11616
v_mfma_f32_16x16x32_bf16 v[96:99], v[224:227], v[128:131], v[96:99]
ds_read_b64_tr_b16 v[244:245], v16 offset:10368
ds_read_b64_tr_b16 v[246:247], v16 offset:11648
v_mfma_f32_16x16x32_bf16 v[100:103], v[224:227], v[132:135], v[100:103]
v_mfma_f32_16x16x32_bf16 v[104:107], v[224:227], v[136:139], v[104:107]
v_mfma_f32_16x16x32_bf16 v[108:111], v[224:227], v[140:143], v[108:111]
s_waitcnt lgkmcnt(0)
v_mfma_f32_16x16x32_bf16 v[32:35], v[228:231], v[144:147], v[32:35]
s_add_u32 m0, s34, 5120
s_nop 0
buffer_load_dwordx4 v10, s[20:23], s32 offen lds
v_mfma_f32_16x16x32_bf16 v[36:39], v[228:231], v[148:151], v[36:39]
buffer_load_dwordx4 v10, s[20:23], s32 offen offset:1024 lds
v_mfma_f32_16x16x32_bf16 v[40:43], v[228:231], v[152:155], v[40:43]
buffer_load_dwordx4 v10, s[20:23], s32 offen offset:2048 lds
v_mfma_f32_16x16x32_bf16 v[44:47], v[228:231], v[156:159], v[44:47]
buffer_load_dwordx4 v10, s[20:23], s32 offen offset:3072 lds
v_mfma_f32_16x16x32_bf16 v[48:51], v[232:235], v[144:147], v[48:51]
s_add_u32 m0, s34, 9216
s_add_u32 s3, s32, 4096
buffer_load_dwordx4 v10, s[20:23], s3 offen lds
s_add_u32 s32, s32, 5120
v_mfma_f32_16x16x32_bf16 v[52:55], v[232:235], v[148:151], v[52:55]
buffer_load_dwordx4 v[128:131], v12, s[20:23], s33 offen
v_mfma_f32_16x16x32_bf16 v[56:59], v[232:235], v[152:155], v[56:59]
buffer_load_dwordx4 v[132:135], v13, s[20:23], s33 offen
v_mfma_f32_16x16x32_bf16 v[60:63], v[232:235], v[156:159], v[60:63]
buffer_load_dwordx4 v[136:139], v14, s[20:23], s33 offen
v_mfma_f32_16x16x32_bf16 v[64:67], v[236:239], v[144:147], v[64:67]
buffer_load_dwordx4 v[140:143], v15, s[20:23], s33 offen
s_add_u32 s33, s33, 131072
v_mfma_f32_16x16x32_bf16 v[68:71], v[236:239], v[148:151], v[68:71]
s_waitcnt vmcnt(27)
v_mfma_f32_16x16x32_bf16 v[72:75], v[236:239], v[152:155], v[72:75]
ds_read_b64_tr_b16 v[208:209], v16 offset:15360
v_mfma_f32_16x16x32_bf16 v[76:79], v[236:239], v[156:159], v[76:79]
ds_read_b64_tr_b16 v[210:211], v16 offset:16640
v_mfma_f32_16x16x32_bf16 v[80:83], v[240:243], v[144:147], v[80:83]
ds_read_b64_tr_b16 v[212:213], v16 offset:15392
v_mfma_f32_16x16x32_bf16 v[84:87], v[240:243], v[148:151], v[84:87]
ds_read_b64_tr_b16 v[214:215], v16 offset:16672
v_mfma_f32_16x16x32_bf16 v[88:91], v[240:243], v[152:155], v[88:91]
ds_read_b64_tr_b16 v[216:217], v16 offset:15424
ds_read_b64_tr_b16 v[218:219], v16 offset:16704
v_mfma_f32_16x16x32_bf16 v[92:95], v[240:243], v[156:159], v[92:95]
ds_read_b64_tr_b16 v[220:221], v16 offset:15456
ds_read_b64_tr_b16 v[222:223], v16 offset:16736
v_mfma_f32_16x16x32_bf16 v[96:99], v[244:247], v[144:147], v[96:99]
ds_read_b64_tr_b16 v[224:225], v16 offset:15488
ds_read_b64_tr_b16 v[226:227], v16 offset:16768
v_mfma_f32_16x16x32_bf16 v[100:103], v[244:247], v[148:151], v[100:103]
v_mfma_f32_16x16x32_bf16 v[104:107], v[244:247], v[152:155], v[104:107]
v_mfma_f32_16x16x32_bf16 v[108:111], v[244:247], v[156:159], v[108:111]
s_mul_i32 s3, s29, 327680
s_lshl_b32 s35, s28, 9
s_add_u32 s3, s3, s35
s_lshl_b32 s35, s31, 7
s_add_u32 s3, s3, s35
s_add_u32 s35, s3, 65536
s_mul_i32 s36, s29, 320
s_add_u32 s36, s36, 12800
s_waitcnt lgkmcnt(0)
v_mfma_f32_16x16x32_bf16 v[32:35], v[208:211], v[160:163], v[32:35]
buffer_load_dwordx2 v[192:193], v17, s[20:23], s35 offen
s_add_u32 s35, s35, 65536
v_mfma_f32_16x16x32_bf16 v[36:39], v[208:211], v[164:167], v[36:39]
buffer_load_dwordx4 v[20:23], v18, s[20:23], s36 offen offset:0
v_mfma_f32_16x16x32_bf16 v[40:43], v[208:211], v[168:171], v[40:43]
buffer_load_dwordx2 v[194:195], v17, s[20:23], s35 offen
s_add_u32 s35, s35, 65536
v_mfma_f32_16x16x32_bf16 v[44:47], v[208:211], v[172:175], v[44:47]
buffer_load_dwordx4 v[24:27], v18, s[20:23], s36 offen offset:64
v_mfma_f32_16x16x32_bf16 v[48:51], v[212:215], v[160:163], v[48:51]
buffer_load_dwordx2 v[196:197], v17, s[20:23], s35 offen
s_add_u32 s35, s35, 65536
v_mfma_f32_16x16x32_bf16 v[52:55], v[212:215], v[164:167], v[52:55]
buffer_load_dwordx4 v[28:31], v18, s[20:23], s36 offen offset:128
v_mfma_f32_16x16x32_bf16 v[56:59], v[212:215], v[168:171], v[56:59]
buffer_load_dwordx2 v[198:199], v17, s[20:23], s35 offen
s_add_u32 s35, s35, 65536
v_mfma_f32_16x16x32_bf16 v[60:63], v[212:215], v[172:175], v[60:63]
buffer_load_dwordx4 v[248:251], v18, s[20:23], s36 offen offset:192
v_mfma_f32_16x16x32_bf16 v[64:67], v[216:219], v[160:163], v[64:67]
buffer_load_dwordx2 v[200:201], v17, s[20:23], s35 offen
s_add_u32 s35, s35, 65536
v_mfma_f32_16x16x32_bf16 v[68:71], v[216:219], v[164:167], v[68:71]
buffer_load_dwordx4 v[252:255], v18, s[20:23], s36 offen offset:256
v_mfma_f32_16x16x32_bf16 v[72:75], v[216:219], v[168:171], v[72:75]
s_waitcnt vmcnt(28)
v_mfma_f32_16x16x32_bf16 v[76:79], v[216:219], v[172:175], v[76:79]
ds_read_b64_tr_b16 v[228:229], v16 offset:20480
v_mfma_f32_16x16x32_bf16 v[80:83], v[220:223], v[160:163], v[80:83]
ds_read_b64_tr_b16 v[230:231], v16 offset:21760
v_mfma_f32_16x16x32_bf16 v[84:87], v[220:223], v[164:167], v[84:87]
ds_read_b64_tr_b16 v[232:233], v16 offset:20512
v_mfma_f32_16x16x32_bf16 v[88:91], v[220:223], v[168:171], v[88:91]
ds_read_b64_tr_b16 v[234:235], v16 offset:21792
ds_read_b64_tr_b16 v[236:237], v16 offset:20544
v_mfma_f32_16x16x32_bf16 v[92:95], v[220:223], v[172:175], v[92:95]
ds_read_b64_tr_b16 v[238:239], v16 offset:21824
ds_read_b64_tr_b16 v[240:241], v16 offset:20576
v_mfma_f32_16x16x32_bf16 v[96:99], v[224:227], v[160:163], v[96:99]
ds_read_b64_tr_b16 v[242:243], v16 offset:21856
ds_read_b64_tr_b16 v[244:245], v16 offset:20608
v_mfma_f32_16x16x32_bf16 v[100:103], v[224:227], v[164:167], v[100:103]
ds_read_b64_tr_b16 v[246:247], v16 offset:21888
v_mfma_f32_16x16x32_bf16 v[104:107], v[224:227], v[168:171], v[104:107]
v_mfma_f32_16x16x32_bf16 v[108:111], v[224:227], v[172:175], v[108:111]
s_waitcnt lgkmcnt(0)
v_mfma_f32_16x16x32_bf16 v[32:35], v[228:231], v[176:179], v[32:35]
v_mfma_f32_16x16x32_bf16 v[36:39], v[228:231], v[180:183], v[36:39]
v_mfma_f32_16x16x32_bf16 v[40:43], v[228:231], v[184:187], v[40:43]
v_mfma_f32_16x16x32_bf16 v[44:47], v[228:231], v[188:191], v[44:47]
v_mfma_f32_16x16x32_bf16 v[48:51], v[232:235], v[176:179], v[48:51]
v_mfma_f32_16x16x32_bf16 v[52:55], v[232:235], v[180:183], v[52:55]
v_mfma_f32_16x16x32_bf16 v[56:59], v[232:235], v[184:187], v[56:59]
v_mfma_f32_16x16x32_bf16 v[60:63], v[232:235], v[188:191], v[60:63]
v_mfma_f32_16x16x32_bf16 v[64:67], v[236:239], v[176:179], v[64:67]
s_waitcnt vmcnt(19)
v_mfma_f32_16x16x32_bf16 v[68:71], v[236:239], v[180:183], v[68:71]
ds_read_b64_tr_b16 v[208:209], v16 offset:0
v_mfma_f32_16x16x32_bf16 v[72:75], v[236:239], v[184:187], v[72:75]
ds_read_b64_tr_b16 v[210:211], v16 offset:1280
v_mfma_f32_16x16x32_bf16 v[76:79], v[236:239], v[188:191], v[76:79]
ds_read_b64_tr_b16 v[212:213], v16 offset:32
v_mfma_f32_16x16x32_bf16 v[80:83], v[240:243], v[176:179], v[80:83]
ds_read_b64_tr_b16 v[214:215], v16 offset:1312
v_mfma_f32_16x16x32_bf16 v[84:87], v[240:243], v[180:183], v[84:87]
ds_read_b64_tr_b16 v[216:217], v16 offset:64
v_mfma_f32_16x16x32_bf16 v[88:91], v[240:243], v[184:187], v[88:91]
ds_read_b64_tr_b16 v[218:219], v16 offset:1344
ds_read_b64_tr_b16 v[220:221], v16 offset:96
v_mfma_f32_16x16x32_bf16 v[92:95], v[240:243], v[188:191], v[92:95]
ds_read_b64_tr_b16 v[222:223], v16 offset:1376
ds_read_b64_tr_b16 v[224:225], v16 offset:128
v_mfma_f32_16x16x32_bf16 v[96:99], v[244:247], v[176:179], v[96:99]
ds_read_b64_tr_b16 v[226:227], v16 offset:1408
v_mfma_f32_16x16x32_bf16 v[100:103], v[244:247], v[180:183], v[100:103]
v_mfma_f32_16x16x32_bf16 v[104:107], v[244:247], v[184:187], v[104:107]
v_mfma_f32_16x16x32_bf16 v[108:111], v[244:247], v[188:191], v[108:111]
s_waitcnt lgkmcnt(0)
v_mfma_f32_16x16x32_bf16 v[32:35], v[208:211], v[112:115], v[32:35]
v_mfma_f32_16x16x32_bf16 v[36:39], v[208:211], v[116:119], v[36:39]
v_mfma_f32_16x16x32_bf16 v[40:43], v[208:211], v[120:123], v[40:43]
v_mfma_f32_16x16x32_bf16 v[44:47], v[208:211], v[124:127], v[44:47]
v_mfma_f32_16x16x32_bf16 v[48:51], v[212:215], v[112:115], v[48:51]
v_mfma_f32_16x16x32_bf16 v[52:55], v[212:215], v[116:119], v[52:55]
v_mfma_f32_16x16x32_bf16 v[56:59], v[212:215], v[120:123], v[56:59]
v_mfma_f32_16x16x32_bf16 v[60:63], v[212:215], v[124:127], v[60:63]
v_mfma_f32_16x16x32_bf16 v[64:67], v[216:219], v[112:115], v[64:67]
s_waitcnt vmcnt(10)
v_mfma_f32_16x16x32_bf16 v[68:71], v[216:219], v[116:119], v[68:71]
ds_read_b64_tr_b16 v[228:229], v16 offset:5120
v_mfma_f32_16x16x32_bf16 v[72:75], v[216:219], v[120:123], v[72:75]
ds_read_b64_tr_b16 v[230:231], v16 offset:6400
v_mfma_f32_16x16x32_bf16 v[76:79], v[216:219], v[124:127], v[76:79]
ds_read_b64_tr_b16 v[232:233], v16 offset:5152
v_mfma_f32_16x16x32_bf16 v[80:83], v[220:223], v[112:115], v[80:83]
ds_read_b64_tr_b16 v[234:235], v16 offset:6432
v_mfma_f32_16x16x32_bf16 v[84:87], v[220:223], v[116:119], v[84:87]
ds_read_b64_tr_b16 v[236:237], v16 offset:5184
v_mfma_f32_16x16x32_bf16 v[88:91], v[220:223], v[120:123], v[88:91]
ds_read_b64_tr_b16 v[238:239], v16 offset:6464
ds_read_b64_tr_b16 v[240:241], v16 offset:5216
v_mfma_f32_16x16x32_bf16 v[92:95], v[220:223], v[124:127], v[92:95]
ds_read_b64_tr_b16 v[242:243], v16 offset:6496
ds_read_b64_tr_b16 v[244:245], v16 offset:5248
v_mfma_f32_16x16x32_bf16 v[96:99], v[224:227], v[112:115], v[96:99]
ds_read_b64_tr_b16 v[246:247], v16 offset:6528
v_mfma_f32_16x16x32_bf16 v[100:103], v[224:227], v[116:119], v[100:103]
v_mfma_f32_16x16x32_bf16 v[104:107], v[224:227], v[120:123], v[104:107]
v_mfma_f32_16x16x32_bf16 v[108:111], v[224:227], v[124:127], v[108:111]
s_waitcnt lgkmcnt(0)
v_add_u32 v11, s34, v10
v_mfma_f32_16x16x32_bf16 v[36:39], v[228:231], v[132:135], v[36:39]
v_mfma_f32_16x16x32_bf16 v[52:55], v[232:235], v[132:135], v[52:55]
v_mfma_f32_16x16x32_bf16 v[68:71], v[236:239], v[132:135], v[68:71]
v_mfma_f32_16x16x32_bf16 v[84:87], v[240:243], v[132:135], v[84:87]
v_mfma_f32_16x16x32_bf16 v[100:103], v[244:247], v[132:135], v[100:103]
v_mfma_f32_16x16x32_bf16 v[40:43], v[228:231], v[136:139], v[40:43]
v_mfma_f32_16x16x32_bf16 v[56:59], v[232:235], v[136:139], v[56:59]
v_mfma_f32_16x16x32_bf16 v[72:75], v[236:239], v[136:139], v[72:75]
s_nop 0
ds_write_b128 v11, v[36:39] offset:0
v_mfma_f32_16x16x32_bf16 v[88:91], v[240:243], v[136:139], v[88:91]
ds_write_b128 v11, v[52:55] offset:1024
v_mfma_f32_16x16x32_bf16 v[104:107], v[244:247], v[136:139], v[104:107]
ds_write_b128 v11, v[68:71] offset:2048
v_mfma_f32_16x16x32_bf16 v[44:47], v[228:231], v[140:143], v[44:47]
ds_write_b128 v11, v[84:87] offset:3072
v_mfma_f32_16x16x32_bf16 v[60:63], v[232:235], v[140:143], v[60:63]
ds_write_b128 v11, v[100:103] offset:4096
v_mfma_f32_16x16x32_bf16 v[76:79], v[236:239], v[140:143], v[76:79]
ds_write_b128 v11, v[40:43] offset:5120
v_mfma_f32_16x16x32_bf16 v[92:95], v[240:243], v[140:143], v[92:95]
ds_write_b128 v11, v[56:59] offset:6144
v_mfma_f32_16x16x32_bf16 v[108:111], v[244:247], v[140:143], v[108:111]
ds_write_b128 v11, v[72:75] offset:7168
v_mfma_f32_16x16x32_bf16 v[32:35], v[228:231], v[128:131], v[32:35]
ds_write_b128 v11, v[88:91] offset:8192
v_mfma_f32_16x16x32_bf16 v[48:51], v[232:235], v[128:131], v[48:51]
ds_write_b128 v11, v[104:107] offset:9216
v_mfma_f32_16x16x32_bf16 v[64:67], v[236:239], v[128:131], v[64:67]
ds_write_b128 v11, v[44:47] offset:10240
v_mfma_f32_16x16x32_bf16 v[80:83], v[240:243], v[128:131], v[80:83]
ds_write_b128 v11, v[60:63] offset:11264
v_mfma_f32_16x16x32_bf16 v[96:99], v[244:247], v[128:131], v[96:99]
ds_write_b128 v11, v[76:79] offset:12288
ds_write_b128 v11, v[92:95] offset:13312
ds_write_b128 v11, v[108:111] offset:14336
s_sub_u32 s3, s31, 1
s_and_b32 s3, s3, 3
s_mul_i32 s3, s3, 25600
v_add_u32 v2, s3, v10
s_sub_u32 s3, s31, 2
s_and_b32 s3, s3, 3
s_mul_i32 s3, s3, 25600
v_add_u32 v3, s3, v10
s_sub_u32 s3, s31, 3
s_and_b32 s3, s3, 3
s_mul_i32 s3, s3, 25600
v_add_u32 v4, s3, v10
s_waitcnt lgkmcnt(0)
s_barrier
ds_read_b128 v[112:115], v2 offset:0
ds_read_b128 v[116:119], v3 offset:5120
ds_read_b128 v[120:123], v4 offset:10240
ds_read_b128 v[124:127], v2 offset:1024
ds_read_b128 v[128:131], v3 offset:6144
ds_read_b128 v[132:135], v4 offset:11264
ds_read_b128 v[136:139], v2 offset:2048
ds_read_b128 v[140:143], v3 offset:7168
ds_read_b128 v[144:147], v4 offset:12288
ds_read_b128 v[148:151], v2 offset:3072
ds_read_b128 v[152:155], v3 offset:8192
ds_read_b128 v[156:159], v4 offset:13312
ds_read_b128 v[160:163], v2 offset:4096
ds_read_b128 v[164:167], v3 offset:9216
ds_read_b128 v[168:171], v4 offset:14336
s_lshl_b32 s3, s28, 6
s_lshl_b32 s37, s31, 4
s_add_u32 s3, s3, s37
s_mul_i32 s3, s3, 1280
s_mul_i32 s37, s29, 160
s_add_u32 s37, s37, s3
s_waitcnt vmcnt(0)
s_waitcnt lgkmcnt(12)
v_add_f32 v32, v32, v112
v_add_f32 v116, v116, v120
v_add_f32 v33, v33, v113
v_add_f32 v117, v117, v121
v_add_f32 v34, v34, v114
v_add_f32 v118, v118, v122
v_add_f32 v35, v35, v115
v_add_f32 v119, v119, v123
v_add_f32 v32, v32, v116
v_add_f32 v33, v33, v117
v_add_f32 v34, v34, v118
v_add_f32 v35, v35, v119
v_lshlrev_b32 v4, 16, v192
v_and_b32 v5, 0xffff0000, v192
v_fma_f32 v4, v32, v20, v4
v_fma_f32 v5, v33, v21, v5
v_cvt_pk_bf16_f32 v208, v4, v5
v_lshlrev_b32 v6, 16, v193
v_and_b32 v7, 0xffff0000, v193
v_fma_f32 v6, v34, v22, v6
v_fma_f32 v7, v35, v23, v7
v_cvt_pk_bf16_f32 v209, v6, v7
s_waitcnt lgkmcnt(9)
v_add_f32 v48, v48, v124
v_add_f32 v128, v128, v132
v_add_f32 v49, v49, v125
v_add_f32 v129, v129, v133
v_add_f32 v50, v50, v126
v_add_f32 v130, v130, v134
v_add_f32 v51, v51, v127
v_add_f32 v131, v131, v135
v_add_f32 v48, v48, v128
v_add_f32 v49, v49, v129
v_add_f32 v50, v50, v130
v_add_f32 v51, v51, v131
v_lshlrev_b32 v4, 16, v194
v_and_b32 v5, 0xffff0000, v194
v_fma_f32 v4, v48, v24, v4
v_fma_f32 v5, v49, v25, v5
v_cvt_pk_bf16_f32 v210, v4, v5
v_lshlrev_b32 v6, 16, v195
v_and_b32 v7, 0xffff0000, v195
v_fma_f32 v6, v50, v26, v6
v_fma_f32 v7, v51, v27, v7
v_cvt_pk_bf16_f32 v211, v6, v7
v_permlane16_swap_b32 v208, v210
s_nop 0
v_permlane16_swap_b32 v209, v211
buffer_store_dwordx4 v[208:211], v8, s[16:19], s37 offen offset:0
s_waitcnt lgkmcnt(6)
v_add_f32 v64, v64, v136
v_add_f32 v140, v140, v144
v_add_f32 v65, v65, v137
v_add_f32 v141, v141, v145
v_add_f32 v66, v66, v138
v_add_f32 v142, v142, v146
v_add_f32 v67, v67, v139
v_add_f32 v143, v143, v147
v_add_f32 v64, v64, v140
v_add_f32 v65, v65, v141
v_add_f32 v66, v66, v142
v_add_f32 v67, v67, v143
v_lshlrev_b32 v4, 16, v196
v_and_b32 v5, 0xffff0000, v196
v_fma_f32 v4, v64, v28, v4
v_fma_f32 v5, v65, v29, v5
v_cvt_pk_bf16_f32 v212, v4, v5
v_lshlrev_b32 v6, 16, v197
v_and_b32 v7, 0xffff0000, v197
v_fma_f32 v6, v66, v30, v6
v_fma_f32 v7, v67, v31, v7
v_cvt_pk_bf16_f32 v213, v6, v7
s_waitcnt lgkmcnt(3)
v_add_f32 v80, v80, v148
v_add_f32 v152, v152, v156
v_add_f32 v81, v81, v149
v_add_f32 v153, v153, v157
v_add_f32 v82, v82, v150
v_add_f32 v154, v154, v158
v_add_f32 v83, v83, v151
v_add_f32 v155, v155, v159
v_add_f32 v80, v80, v152
v_add_f32 v81, v81, v153
v_add_f32 v82, v82, v154
v_add_f32 v83, v83, v155
v_lshlrev_b32 v4, 16, v198
v_and_b32 v5, 0xffff0000, v198
v_fma_f32 v4, v80, v248, v4
v_fma_f32 v5, v81, v249, v5
v_cvt_pk_bf16_f32 v214, v4, v5
v_lshlrev_b32 v6, 16, v199
v_and_b32 v7, 0xffff0000, v199
v_fma_f32 v6, v82, v250, v6
v_fma_f32 v7, v83, v251, v7
v_cvt_pk_bf16_f32 v215, v6, v7
v_permlane16_swap_b32 v212, v214
s_nop 0
v_permlane16_swap_b32 v213, v215
buffer_store_dwordx4 v[212:215], v8, s[16:19], s37 offen offset:64
s_waitcnt lgkmcnt(0)
v_add_f32 v96, v96, v160
v_add_f32 v164, v164, v168
v_add_f32 v97, v97, v161
v_add_f32 v165, v165, v169
v_add_f32 v98, v98, v162
v_add_f32 v166, v166, v170
v_add_f32 v99, v99, v163
v_add_f32 v167, v167, v171
v_add_f32 v96, v96, v164
v_add_f32 v97, v97, v165
v_add_f32 v98, v98, v166
v_add_f32 v99, v99, v167
v_lshlrev_b32 v4, 16, v200
v_and_b32 v5, 0xffff0000, v200
v_fma_f32 v4, v96, v252, v4
v_fma_f32 v5, v97, v253, v5
v_cvt_pk_bf16_f32 v216, v4, v5
v_lshlrev_b32 v6, 16, v201
v_and_b32 v7, 0xffff0000, v201
v_fma_f32 v6, v98, v254, v6
v_fma_f32 v7, v99, v255, v7
v_cvt_pk_bf16_f32 v217, v6, v7
buffer_store_dwordx2 v[216:217], v19, s[16:19], s37 offen offset:128
s_waitcnt vmcnt(0)
KE_END:
s_endpgm
ke_kernel_end:
ALL_END:
.section .rodata,"a"
.p2align 6
.amdhsa_kernel ka_kernel
  .amdhsa_next_free_vgpr 256
  .amdhsa_next_free_sgpr 102
  .amdhsa_accum_offset 256
  .amdhsa_group_segment_fixed_size 0
  .amdhsa_kernarg_size 128
  .amdhsa_user_sgpr_count 2
  .amdhsa_user_sgpr_kernarg_segment_ptr 1
  .amdhsa_system_sgpr_workgroup_id_x 1
.end_amdhsa_kernel
.p2align 6
.amdhsa_kernel kb_kernel
  .amdhsa_next_free_vgpr 256
  .amdhsa_next_free_sgpr 102
  .amdhsa_accum_offset 256
  .amdhsa_group_segment_fixed_size 0
  .amdhsa_kernarg_size 128
  .amdhsa_user_sgpr_count 2
  .amdhsa_user_sgpr_kernarg_segment_ptr 1
  .amdhsa_system_sgpr_workgroup_id_x 1
.end_amdhsa_kernel
.p2align 6
.amdhsa_kernel kd_kernel
  .amdhsa_next_free_vgpr 256
  .amdhsa_next_free_sgpr 102
  .amdhsa_accum_offset 256
  .amdhsa_group_segment_fixed_size 0
  .amdhsa_kernarg_size 128
  .amdhsa_user_sgpr_count 2
  .amdhsa_user_sgpr_kernarg_segment_ptr 1
  .amdhsa_system_sgpr_workgroup_id_x 1
.end_amdhsa_kernel
.p2align 6
.amdhsa_kernel ke_kernel
  .amdhsa_next_free_vgpr 256
  .amdhsa_next_free_sgpr 102
  .amdhsa_accum_offset 256
  .amdhsa_group_segment_fixed_size 0
  .amdhsa_kernarg_size 128
  .amdhsa_user_sgpr_count 2
  .amdhsa_user_sgpr_kernarg_segment_ptr 1
  .amdhsa_system_sgpr_workgroup_id_x 1
.end_amdhsa_kernel
```
